```python
import torch

def _softmax(x, axis=-1):
    return torch.softmax(x, dim=axis)
def _gelu(x):
    return torch.nn.functional.gelu(x, approximate="tanh")
def _silu(x):
    return torch.nn.functional.silu(x)
def _sigmoid(x):
    return torch.sigmoid(x)
def _layernorm(x, axis=-1, eps=1e-5):
    m = x.mean(dim=axis, keepdim=True)
    v = x.var(dim=axis, keepdim=True, unbiased=False)
    return (x - m) / torch.sqrt(v + eps)
def _scatter_add(tgt, idx, src, axis=0):
    return tgt.clone().index_add_(axis, idx, src)
def _segment_sum(src, seg, n):
    out = torch.zeros((n,) + src.shape[1:], dtype=src.dtype)
    return out.index_add_(0, seg, src)
def _pad(x, pw):
    flat = tuple(v for pair in reversed(pw) for v in pair)
    return torch.nn.functional.pad(x, flat)

kernel_name = 'gated_mix__linear_attn_block__dense_activation_mish__prompt'

def setup_inputs():

    _w = (lambda a: (lambda t: t.to(torch.bfloat16) if t.is_floating_point() else t)(torch.as_tensor(a)))
    def _A_setup():
        B, S, D = 1, 2048, 576
        return {
            "x": _w((lambda *s: torch.randn(*s, dtype=torch.bfloat16) * 0.05)(B, S, D)),
            "wqkv": _w((lambda *s: torch.randn(*s, dtype=torch.bfloat16) * 0.8)(D, 3 * D)),
            "wo": _w((lambda *s: torch.randn(*s, dtype=torch.bfloat16) * 0.05)(D, D)),
        }
    _A_in = _A_setup()

    def _B_setup():
        B, S, D, F = 1, 2048, 576, 4608
        return {
            "x": _w((lambda *s: torch.randn(*s, dtype=torch.bfloat16) * 0.05)(B, S, D)),
            "w1": _w((lambda *s: torch.randn(*s, dtype=torch.bfloat16) * 12.8)(D, F) * (D ** -0.5)),
            "b1": _w((lambda *s: torch.randn(*s, dtype=torch.bfloat16) * 0.2)(F)),
            "w2": _w((lambda *s: torch.randn(*s, dtype=torch.bfloat16) * 0.05)(F, D) * (F ** -0.5)),
        }
    _B_in = _B_setup()

    return {
        "A_x": _A_in["x"],
        "A_wqkv": _A_in["wqkv"],
        "A_wo": _A_in["wo"],
        "B_x": _B_in["x"],
        "B_w1": _B_in["w1"],
        "B_b1": _B_in["b1"],
        "B_w2": _B_in["w2"],
        "gate_w": _w((lambda *s: torch.randn(*s, dtype=torch.bfloat16) * 0.05)(576) * 16.0),
    }

def reference(A_x, A_wqkv, A_wo, B_x, B_w1, B_b1, B_w2, gate_w):
    def _A_ref(x, wqkv, wo):
        B, S, D = x.shape
        H = 32; Dh = D // H
        qkv = (lambda x, *d: x.permute(*d))((x @ wqkv).reshape(B, S, 3, H, Dh), 2, 0, 3, 1, 4)
        q, k, v = qkv[0], qkv[1], qkv[2]
        phi = lambda t: torch.where(t > 0, t + 1, torch.exp(t)) + 1e-6
        pq, pk = phi(q), phi(k)
        kv = torch.einsum("bhsd,bhse->bhde", pk, v)
        z = torch.einsum("bhsd->bhd", pk)
        num = torch.einsum("bhqd,bhde->bhqe", pq, kv)
        den = torch.einsum("bhqd,bhd->bhq", pq, z)[..., None] + 1e-6
        o = num / den
        return (lambda x, *d: x.permute(*d))(o, 0, 2, 1, 3).reshape(B, S, D) @ wo

    def _B_ref(x, w1, b1, w2):
        h = torch.einsum("bsd,df->bsf", x, w1) + b1
        sp = torch.log1p(torch.exp(-torch.abs(h))) + torch.where(h > 0, h, torch.zeros_like(h))
        act = h * torch.tanh(sp)
        return torch.einsum("bsf,fd->bsd", act, w2)

    x = A_x
    g = _sigmoid((x * gate_w).sum(-1, keepdims=True))
    a = _A_ref(x, A_wqkv, A_wo)
    b = _B_ref(x, B_w1, B_b1, B_w2)
    return g * a + (1 - g) * b
```

```asm
; @launch grid=(256,1,1) block=(512,1,1) lds=163840
.amdgcn_target "amdgcn-amd-amdhsa--gfx950"
.text
.globl gated_mix__linear_attn_block__dense_activation_mish__prompt_kernel
.p2align 8
.type gated_mix__linear_attn_block__dense_activation_mish__prompt_kernel,@function
gated_mix__linear_attn_block__dense_activation_mish__prompt_kernel:
    s_cmp_ge_u32 s2, 256
    s_cbranch_scc1 L_k1_end
    s_load_dwordx4 s[36:39], s[0:1], 0
    s_load_dwordx2 s[40:41], s[0:1], 16
    s_load_dwordx4 s[44:47], s[0:1], 32
    s_load_dwordx4 s[48:51], s[0:1], 48
    s_load_dwordx4 s[52:55], s[0:1], 64
    s_load_dwordx2 s[74:75], s[0:1], 80
    s_getpc_b64 s[42:43]
L_pf:
    s_lshr_b32 s4, s2, 3
    s_mul_i32 s4, s4, 16
    v_and_b32 v2, 31, v0
    v_add_u32 v2, s4, v2
    v_lshlrev_b32 v2, 7, v2
    v_min_u32 v2, L_code_end-L_pf-4, v2
    v_cmp_gt_u32 vcc, 64, v0
    s_cbranch_vccz L_pf_skip
    global_load_dword v103, v2, s[42:43]
L_pf_skip:
    v_lshrrev_b32 v2, 6, v0
    v_and_b32 v1, 63, v0
    v_readfirstlane_b32 s28, v2
    s_lshl_b32 s4, s2, 3
    v_add_u32 v2, s4, v2
    v_mad_u32_u24 v3, v2, 9, v1
    v_lshlrev_b32 v3, 7, v3
    v_mad_u32_u24 v5, v2, 3, v1
    v_lshlrev_b32 v5, 7, v5
    s_waitcnt lgkmcnt(0)
    s_mov_b64 exec, 0x1ff
    global_load_dword v102, v3, s[36:37]
    s_mov_b64 exec, 7
    global_load_dword v102, v5, s[38:39]
    s_mov_b64 exec, -1
    s_bfe_u32 s5, s2, 0x20003
    s_lshr_b32 s4, s2, 5
    s_and_b32 s6, s2, 4
    s_lshl_b32 s6, s6, 1
    s_add_u32 s30, s6, s4
    s_and_b32 s3, s2, 3
    s_lshl_b32 s29, s28, 10
    s_setprio 1
    s_cmp_eq_u32 s5, 3
    s_cbranch_scc1 L_attn
    s_mul_i32 s31, s3, 3
    s_add_u32 s31, s31, s5
    v_lshrrev_b32 v48, 3, v1
    s_lshl_b32 s34, s30, 7
    s_lshl_b32 s35, s28, 4
    s_add_u32 s34, s34, s35
    v_add_u32 v49, s34, v48
    v_mul_u32_u24 v49, 1152, v49
    v_and_b32 v50, 7, v1
    v_lshrrev_b32 v81, 4, v1
    v_xor_b32 v50, v50, v81
    v_lshl_add_u32 v80, v50, 4, v49
    v_xor_b32 v81, 64, v80
    v_add_u32 v81, 9216, v81
    s_lshl_b32 s35, s28, 11
    s_mul_i32 s33, s31, 768
    s_lshl_b32 s34, s28, 3
    v_add_u32 v2, s34, v48
    v_mul_u32_u24 v2, 9216, v2
    v_and_b32 v50, 7, v1
    v_bfe_u32 v48, v1, 4, 1
    s_and_b32 s34, s28, 1
    s_lshl_b32 s34, s34, 2
    v_lshl_or_b32 v48, v48, 1, s34
    v_xor_b32 v48, v48, v50
    v_lshl_add_u32 v2, v48, 4, v2
    v_add_u32 v2, s33, v2
    s_mul_i32 s76, s30, 12
    s_add_u32 s76, s76, s31
    s_lshl_b32 s76, s76, 3
    s_add_u32 s76, s76, s28
    s_lshl_b32 s84, s30, 3
    s_add_u32 s84, s84, s28
    s_mul_i32 s84, s84, 9
    v_add_u32 v14, s84, v1
    v_lshrrev_b32 v48, 1, v14
    v_mul_u32_u24 v48, 8960, v48
    v_lshl_add_u32 v15, v14, 7, s33
    v_add_u32 v15, v15, v48
    s_mul_i32 s84, s31, 442368
    v_lshl_add_u32 v14, v14, 7, s84
    s_lshl_b32 s84, s76, 9
    v_lshl_add_u32 v13, v1, 7, s84
    s_mov_b32 s16, s38
    s_mov_b32 s17, s39
    s_mov_b32 s18, 1990656
    s_mov_b32 s19, 0x20000
    s_mov_b32 s10, 2359296
    s_mov_b32 s11, 0x20000
    s_mov_b32 s14, 5308416
    s_mov_b32 s15, 0x20000
    s_waitcnt lgkmcnt(0)
    s_mov_b64 s[8:9], s[36:37]
    s_mov_b64 s[12:13], s[44:45]
    s_add_u32 m0, s35, 2048
    s_nop 0
    buffer_load_dwordx4 v80, s[8:11], 0 offen offset:0 lds
    s_add_u32 m0, s35, 3072
    s_nop 0
    buffer_load_dwordx4 v81, s[8:11], 0 offen offset:0 lds
    s_add_u32 m0, s29, 149504
    s_nop 0
    buffer_load_dwordx4 v2, s[12:15], 0 offen offset:0 lds
    s_barrier
    s_mov_b32 m0, 157696
    s_mov_b64 exec, 0x1ff
    buffer_load_dword v15, s[12:15], 0 offen offset:0  lds
    s_mov_b64 exec, -1
    s_mov_b32 s26, 9216
    s_mov_b32 s27, 0x20000
    v_lshlrev_b32 v35, 1, v0
    s_mov_b64 s[24:25], s[46:47]
    buffer_load_ushort v37, v35, s[24:27], s33 offen
    s_mov_b32 s57, 589824
    s_add_u32 m0, s35, 18304
    s_nop 0
    buffer_load_dwordx4 v80, s[8:11], 0 offen offset:128 lds
    s_add_u32 m0, s35, 19328
    s_nop 0
    buffer_load_dwordx4 v81, s[8:11], 0 offen offset:128 lds
    s_add_u32 m0, s29, 34816
    s_nop 0
    buffer_load_dwordx4 v2, s[12:15], s57 offen offset:0 lds
    s_barrier
    s_and_b32 s6, s28, 3
    s_lshr_b32 s7, s28, 2
    v_lshrrev_b32 v48, 4, v1
    v_bfe_u32 v49, v1, 2, 2
    v_and_b32 v50, 3, v1
    v_bfe_u32 v51, v1, 3, 2
    s_lshl_b32 s83, s7, 1
    v_xor_b32 v51, s83, v51
    v_lshlrev_b32 v51, 5, v51
    v_lshl_add_u32 v51, v50, 3, v51
    v_lshl_add_u32 v51, v49, 7, v51
    v_lshl_add_u32 v104, v48, 10, v51
    v_xor_b32 v105, 32, v104
    v_add_u32 v106, 65536, v104
    v_add_u32 v107, 65536, v105
    v_add_u32 v108, 131072, v104
    v_add_u32 v109, 131072, v105
    s_lshl_b32 s83, s6, 12
    v_and_b32 v51, 15, v1
    v_lshrrev_b32 v50, 1, v51
    v_xor_b32 v50, v50, v48
    v_lshl_add_u32 v51, v51, 7, s83
    v_lshl_add_u32 v72, v50, 4, v51
    v_xor_b32 v73, 64, v72
    v_add_u32 v74, 65536, v72
    v_add_u32 v75, 65536, v73
    v_add_u32 v76, 131072, v72
    v_add_u32 v77, 131072, v73
    s_mov_b32 s58, 1179648
    s_add_u32 m0, s35, 50944
    s_nop 0
    buffer_load_dwordx4 v80, s[8:11], 0 offen offset:256 lds
    s_add_u32 m0, s35, 51968
    s_nop 0
    buffer_load_dwordx4 v81, s[8:11], 0 offen offset:256 lds
    s_add_u32 m0, s29, 43008
    s_nop 0
    buffer_load_dwordx4 v2, s[12:15], s58 offen offset:0 lds
    s_barrier
    s_mov_b32 s59, 1769472
    s_add_u32 m0, s35, 67200
    s_nop 0
    buffer_load_dwordx4 v80, s[8:11], 0 offen offset:384 lds
    s_add_u32 m0, s35, 68224
    s_nop 0
    buffer_load_dwordx4 v81, s[8:11], 0 offen offset:384 lds
    s_add_u32 m0, s29, 83968
    s_nop 0
    buffer_load_dwordx4 v2, s[12:15], s59 offen offset:0 lds
    s_waitcnt vmcnt(6)
    s_barrier
    ds_read_b128 a[0:3], v72 offset:2048
    ds_read_b128 a[8:11], v73 offset:2048
    ds_read_b64_tr_b16 v[48:49], v108 offset:18432
    ds_read_b64_tr_b16 v[50:51], v108 offset:18944
    ds_read_b128 a[4:7], v72 offset:4096
    ds_read_b128 a[12:15], v73 offset:4096
    ds_read_b64_tr_b16 v[52:53], v108 offset:22528
    ds_read_b64_tr_b16 v[54:55], v108 offset:23040
    s_waitcnt lgkmcnt(0)
    s_mov_b32 s60, 2359296
    s_add_u32 m0, s35, 99840
    v_mfma_f32_16x16x32_bf16 v[16:19], v[48:51], a[0:3], 0
    ds_read_b64_tr_b16 v[56:57], v109 offset:18432
    ds_read_b64_tr_b16 v[58:59], v109 offset:18944
    buffer_load_dwordx4 v80, s[8:11], 0 offen offset:512 lds
    s_add_u32 m0, s35, 100864
    v_mfma_f32_16x16x32_bf16 v[16:19], v[52:55], a[8:11], v[16:19]
    ds_read_b64_tr_b16 v[60:61], v109 offset:22528
    ds_read_b64_tr_b16 v[62:63], v109 offset:23040
    buffer_load_dwordx4 v81, s[8:11], 0 offen offset:512 lds
    s_add_u32 m0, s29, 92160
    v_mfma_f32_16x16x32_bf16 v[20:23], v[48:51], a[4:7], 0
    ds_read_b128 a[16:19], v72 offset:18432
    ds_read_b128 a[24:27], v73 offset:18432
    buffer_load_dwordx4 v2, s[12:15], s60 offen offset:0 lds
    s_add_u32 s82, s31, s3
    s_mov_b32 s20, s74
    s_mov_b32 s21, s75
    s_mov_b32 s61, 2949120
    s_add_u32 m0, s35, 116096
    v_mfma_f32_16x16x32_bf16 v[20:23], v[52:55], a[12:15], v[20:23]
    ds_read_b64_tr_b16 v[64:65], v104 offset:34816
    ds_read_b64_tr_b16 v[66:67], v104 offset:35328
    buffer_load_dwordx4 v80, s[8:11], 0 offen offset:640 lds
    s_mov_b32 s22, 268435456
    s_mov_b32 s23, 0x20000
    s_waitcnt lgkmcnt(4)
    s_add_u32 m0, s35, 117120
    v_mfma_f32_16x16x32_bf16 v[24:27], v[56:59], a[0:3], 0
    ds_read_b128 a[20:23], v72 offset:20480
    ds_read_b128 a[28:31], v73 offset:20480
    buffer_load_dwordx4 v81, s[8:11], 0 offen offset:640 lds
    s_mov_b32 s24, s54
    s_mov_b32 s25, s55
    s_add_u32 m0, s29, 133120
    v_mfma_f32_16x16x32_bf16 v[24:27], v[60:63], a[8:11], v[24:27]
    ds_read_b64_tr_b16 v[68:69], v104 offset:38912
    ds_read_b64_tr_b16 v[70:71], v104 offset:39424
    buffer_load_dwordx4 v2, s[12:15], s61 offen offset:0 lds
    s_mov_b32 s26, 256
    s_mov_b32 s27, 0x20000
    v_mfma_f32_16x16x32_bf16 v[28:31], v[56:59], a[4:7], 0
    ds_read_b64_tr_b16 v[48:49], v105 offset:34816
    ds_read_b64_tr_b16 v[50:51], v105 offset:35328
    s_mul_i32 s43, s30, 34816
    s_add_u32 s43, s43, 69206016
    s_mul_i32 s42, s28, 1088
    v_mfma_f32_16x16x32_bf16 v[28:31], v[60:63], a[12:15], v[28:31]
    ds_read_b64_tr_b16 v[52:53], v105 offset:38912
    ds_read_b64_tr_b16 v[54:55], v105 offset:39424
    s_add_u32 s42, s42, s82
    s_lshl_b32 s42, s42, 2
    s_waitcnt lgkmcnt(4)
    v_mfma_f32_16x16x32_bf16 v[16:19], v[64:67], a[16:19], v[16:19]
    s_add_u32 s42, s42, s43
    s_lshr_b32 s44, s82, 1
    s_mul_i32 s46, s44, 4352
    v_mfma_f32_16x16x32_bf16 v[16:19], v[68:71], a[24:27], v[16:19]
    s_add_u32 s43, s43, s46
    s_mov_b32 s80, 0x3fb8aa3b
    s_waitcnt vmcnt(6) lgkmcnt(0)
    s_barrier
    s_mov_b32 s62, 3538944
    s_add_u32 m0, s35, 1280
    v_mfma_f32_16x16x32_bf16 v[20:23], v[64:67], a[20:23], v[20:23]
    ds_read_b128 a[32:35], v72 offset:51200
    ds_read_b128 a[40:43], v73 offset:51200
    buffer_load_dwordx4 v80, s[8:11], 0 offen offset:768 lds
    s_mov_b32 s81, 0x3f3504f3
    v_lshrrev_b32 v32, 4, v1
    s_mul_i32 s84, s5, 384
    s_add_u32 m0, s35, 2304
    v_mfma_f32_16x16x32_bf16 v[20:23], v[68:71], a[28:31], v[20:23]
    ds_read_b64_tr_b16 v[56:57], v104 offset:43008
    ds_read_b64_tr_b16 v[58:59], v104 offset:43520
    buffer_load_dwordx4 v81, s[8:11], 0 offen offset:768 lds
    s_mul_i32 s34, s28, 9216
    s_add_u32 s84, s84, s34
    s_add_u32 m0, s29, 34816
    v_mfma_f32_16x16x32_bf16 v[24:27], v[48:51], a[16:19], v[24:27]
    ds_read_b128 a[36:39], v72 offset:53248
    ds_read_b128 a[44:47], v73 offset:53248
    buffer_load_dwordx4 v2, s[12:15], s62 offen offset:0 lds
    v_lshrrev_b32 v33, 3, v1
    v_mul_u32_u24 v3, 1152, v33
    s_mov_b32 s63, 4128768
    s_add_u32 m0, s35, 17536
    v_mfma_f32_16x16x32_bf16 v[24:27], v[52:55], a[24:27], v[24:27]
    ds_read_b64_tr_b16 v[60:61], v104 offset:47104
    ds_read_b64_tr_b16 v[62:63], v104 offset:47616
    buffer_load_dwordx4 v80, s[8:11], 0 offen offset:896 lds
    v_lshrrev_b32 v33, 4, v1
    v_lshlrev_b32 v33, 1, v33
    s_add_u32 m0, s35, 18560
    v_mfma_f32_16x16x32_bf16 v[28:31], v[48:51], a[20:23], v[28:31]
    ds_read_b64_tr_b16 v[64:65], v105 offset:43008
    ds_read_b64_tr_b16 v[66:67], v105 offset:43520
    buffer_load_dwordx4 v81, s[8:11], 0 offen offset:896 lds
    v_and_b32 v34, 7, v1
    v_xor_b32 v33, v33, v34
    v_lshl_add_u32 v3, v33, 4, v3
    s_add_u32 m0, s29, 141312
    v_mfma_f32_16x16x32_bf16 v[28:31], v[52:55], a[28:31], v[28:31]
    ds_read_b64_tr_b16 v[68:69], v105 offset:47104
    buffer_load_dwordx4 v2, s[12:15], s63 offen offset:0 lds
    v_add_u32 v3, s84, v3
    s_mul_i32 s68, s3, 1327104
    s_waitcnt lgkmcnt(3)
    v_mfma_f32_16x16x32_bf16 v[16:19], v[56:59], a[32:35], v[16:19]
    ds_read_b64_tr_b16 v[70:71], v105 offset:47616
    ds_read_b128 a[48:51], v74 offset:2048
    s_mul_i32 s69, s3, 165888
    s_add_u32 s70, s69, 73728
    s_add_u32 s84, s69, 147456
    v_mfma_f32_16x16x32_bf16 v[16:19], v[60:63], a[40:43], v[16:19]
    ds_read_b128 a[56:59], v75 offset:2048
    ds_read_b64_tr_b16 v[48:49], v106 offset:18432
    s_cmp_lt_u32 s28, 2
    s_cselect_b32 s71, s84, 1073741824
    s_bitcmp1_b32 s28, 0
    s_mov_b32 s84, 327680
    s_cselect_b32 s73, 1073741824, s84
    v_mfma_f32_16x16x32_bf16 v[20:23], v[56:59], a[36:39], v[20:23]
    ds_read_b64_tr_b16 v[50:51], v106 offset:18944
    ds_read_b128 a[52:55], v74 offset:4096
    v_lshl_add_u32 v6, v1, 4, s83
    s_lshl_b32 s84, s30, 2
    s_add_u32 s84, s84, s3
    v_mfma_f32_16x16x32_bf16 v[20:23], v[60:63], a[44:47], v[20:23]
    ds_read_b128 a[60:63], v75 offset:4096
    ds_read_b64_tr_b16 v[52:53], v106 offset:22528
    s_mul_i32 s84, s84, 344064
    s_add_u32 s84, s84, 83886080
    s_waitcnt lgkmcnt(7)
    v_mfma_f32_16x16x32_bf16 v[24:27], v[64:67], a[32:35], v[24:27]
    ds_read_b64_tr_b16 v[54:55], v106 offset:23040
    ds_read_b64_tr_b16 v[56:57], v107 offset:18432
    s_add_u32 s34, s84, s35
    v_lshl_add_u32 v4, v1, 4, s34
    v_mfma_f32_16x16x32_bf16 v[24:27], v[68:71], a[40:43], v[24:27]
    ds_read_b64_tr_b16 v[58:59], v107 offset:18944
    s_mul_i32 s34, s5, 98304
    s_add_u32 s84, s84, s34
    v_mfma_f32_16x16x32_bf16 v[28:31], v[64:67], a[36:39], v[28:31]
    ds_read_b64_tr_b16 v[60:61], v107 offset:22528
    s_lshl_b32 s34, s7, 11
    s_add_u32 s84, s84, s34
    v_add_u32 v5, s84, v6
    v_mfma_f32_16x16x32_bf16 v[28:31], v[68:71], a[44:47], v[28:31]
    ds_read_b64_tr_b16 v[62:63], v107 offset:23040
    s_lshr_b32 s84, s28, 1
    v_bfe_u32 v33, v1, 3, 2
    s_waitcnt lgkmcnt(4)
    v_mfma_f32_16x16x32_bf16 v[16:19], v[48:51], a[48:51], v[16:19]
    v_xor_b32 v33, s84, v33
    v_lshlrev_b32 v33, 5, v33
    v_and_b32 v34, 3, v1
    v_mfma_f32_16x16x32_bf16 v[16:19], v[52:55], a[56:59], v[16:19]
    v_lshl_add_u32 v33, v34, 3, v33
    v_lshrrev_b32 v34, 2, v1
    s_waitcnt vmcnt(6) lgkmcnt(0)
    s_barrier
    s_mov_b32 s64, 4718592
    s_add_u32 m0, s35, 50176
    v_mfma_f32_16x16x32_bf16 v[20:23], v[48:51], a[52:55], v[20:23]
    ds_read_b128 a[64:67], v74 offset:34816
    ds_read_b128 a[72:75], v75 offset:34816
    buffer_load_dwordx4 v80, s[8:11], 0 offen offset:1024 lds
    v_lshl_add_u32 v12, v34, 7, v33
    s_and_b32 s84, s28, 1
    s_lshl_b32 s84, s84, 13
    s_add_u32 m0, s35, 51200
    v_mfma_f32_16x16x32_bf16 v[20:23], v[52:55], a[60:63], v[20:23]
    ds_read_b64_tr_b16 v[64:65], v106 offset:26624
    ds_read_b64_tr_b16 v[66:67], v106 offset:27136
    buffer_load_dwordx4 v81, s[8:11], 0 offen offset:1024 lds
    v_lshl_add_u32 v6, v1, 4, s84
    v_add_u32 v7, 65536, v6
    s_add_u32 m0, s29, 43008
    v_mfma_f32_16x16x32_bf16 v[24:27], v[56:59], a[48:51], v[24:27]
    ds_read_b128 a[68:71], v74 offset:36864
    ds_read_b128 a[76:79], v75 offset:36864
    buffer_load_dwordx4 v2, s[12:15], s64 offen offset:0 lds
    v_add_u32 v8, 131072, v6
    s_lshl_b32 s84, s30, 2
    s_add_u32 m0, s29, 83840
    v_mfma_f32_16x16x32_bf16 v[24:27], v[60:63], a[56:59], v[24:27]
    ds_read_b64_tr_b16 v[68:69], v106 offset:30720
    ds_read_b64_tr_b16 v[70:71], v106 offset:31232
    buffer_load_dwordx4 v2, s[12:15], 0 offen offset:128 lds
    s_add_u32 s84, s84, s3
    s_mul_i32 s84, s84, 147456
    s_mov_b32 s77, 786432
    s_mov_b32 m0, 157696
    s_mov_b64 exec, 0xf
    buffer_load_dword v13, s[16:19], s77 offen offset:0  lds
    s_mov_b64 exec, -1
    s_add_u32 m0, s29, 149376
    v_mfma_f32_16x16x32_bf16 v[28:31], v[56:59], a[52:55], v[28:31]
    ds_read_b64_tr_b16 v[48:49], v107 offset:26624
    ds_read_b64_tr_b16 v[50:51], v107 offset:27136
    buffer_load_dwordx4 v2, s[12:15], s57 offen offset:128 lds
    s_mul_i32 s34, s5, 49152
    s_add_u32 s84, s84, s34
    s_add_u32 s84, s84, s35
    s_add_u32 m0, s29, 67456
    v_mfma_f32_16x16x32_bf16 v[28:31], v[60:63], a[60:63], v[28:31]
    ds_read_b64_tr_b16 v[52:53], v107 offset:30720
    buffer_load_dwordx4 v2, s[12:15], s58 offen offset:128 lds
    v_and_b32 v33, 31, v1
    v_lshl_add_u32 v11, v33, 5, s84
    s_waitcnt lgkmcnt(3)
    v_mfma_f32_16x16x32_bf16 v[16:19], v[64:67], a[64:67], v[16:19]
    ds_read_b64_tr_b16 v[54:55], v107 offset:31232
    ds_read_b128 a[80:83], v74 offset:51200
    v_lshrrev_b32 v33, 5, v1
    v_lshl_add_u32 v11, v33, 4, v11
    s_lshl_b32 s84, s7, 7
    s_add_u32 m0, s29, 75648
    v_mfma_f32_16x16x32_bf16 v[16:19], v[68:71], a[72:75], v[16:19]
    ds_read_b128 a[88:91], v75 offset:51200
    ds_read_b64_tr_b16 v[56:57], v108 offset:2048
    buffer_load_dwordx4 v2, s[12:15], s59 offen offset:128 lds
    v_lshl_add_u32 v10, v32, 4, s84
    s_lshl_b32 s65, s30, 2
    v_mfma_f32_16x16x32_bf16 v[20:23], v[64:67], a[68:71], v[20:23]
    ds_read_b64_tr_b16 v[58:59], v108 offset:2560
    ds_read_b128 a[84:87], v74 offset:53248
    s_lshl_b32 s67, s30, 3
    s_add_u32 s65, s65, s3
    s_mul_i32 s65, s65, 4352
    v_mfma_f32_16x16x32_bf16 v[20:23], v[68:71], a[76:79], v[20:23]
    ds_read_b128 a[92:95], v75 offset:53248
    ds_read_b64_tr_b16 v[60:61], v108 offset:6144
    s_add_u32 s65, s65, 70254592
    s_lshl_b32 s66, s5, 2
    s_waitcnt lgkmcnt(7)
    v_mfma_f32_16x16x32_bf16 v[24:27], v[48:51], a[64:67], v[24:27]
    ds_read_b64_tr_b16 v[62:63], v108 offset:6656
    ds_read_b64_tr_b16 v[64:65], v109 offset:2048
    s_add_u32 s66, s66, s65
    v_lshlrev_b32 v110, 2, v1
    v_mfma_f32_16x16x32_bf16 v[24:27], v[52:55], a[72:75], v[24:27]
    ds_read_b64_tr_b16 v[66:67], v109 offset:2560
    s_sub_u32 s84, s66, s42
    v_mul_lo_u32 v111, v1, s84
    v_mfma_f32_16x16x32_bf16 v[28:31], v[48:51], a[68:71], v[28:31]
    ds_read_b64_tr_b16 v[68:69], v109 offset:6144
    s_cmp_eq_u32 s28, 0
    s_cselect_b32 s34, 3, 1
    v_lshlrev_b32 v35, 2, v0
    v_mfma_f32_16x16x32_bf16 v[28:31], v[52:55], a[76:79], v[28:31]
    ds_read_b64_tr_b16 v[70:71], v109 offset:6656
    v_lshlrev_b32 v37, 16, v37
    ds_write_b32 v35, v37
    s_waitcnt lgkmcnt(5)
    v_mfma_f32_16x16x32_bf16 v[16:19], v[56:59], a[80:83], v[16:19]
    v_mfma_f32_16x16x32_bf16 v[16:19], v[60:63], a[88:91], v[16:19]
    s_waitcnt vmcnt(5) lgkmcnt(0)
    s_barrier
    s_add_u32 m0, s29, 92032
    v_mfma_f32_16x16x32_bf16 v[20:23], v[56:59], a[84:87], v[20:23]
    ds_read_b128 a[96:99], v72 offset:2048
    ds_read_b128 a[104:107], v73 offset:2048
    buffer_load_dwordx4 v2, s[12:15], s60 offen offset:128 lds
    s_add_u32 m0, s29, 132992
    v_mfma_f32_16x16x32_bf16 v[20:23], v[60:63], a[92:95], v[20:23]
    ds_read_b64_tr_b16 v[48:49], v104 offset:34816
    ds_read_b64_tr_b16 v[50:51], v104 offset:35328
    buffer_load_dwordx4 v2, s[12:15], s61 offen offset:128 lds
    s_add_u32 m0, s29, 100224
    v_mfma_f32_16x16x32_bf16 v[24:27], v[64:67], a[80:83], v[24:27]
    ds_read_b128 a[100:103], v72 offset:4096
    ds_read_b128 a[108:111], v73 offset:4096
    buffer_load_dwordx4 v2, s[12:15], s62 offen offset:128 lds
    s_add_u32 m0, s29, 108416
    v_mfma_f32_16x16x32_bf16 v[24:27], v[68:71], a[88:91], v[24:27]
    ds_read_b64_tr_b16 v[52:53], v104 offset:38912
    ds_read_b64_tr_b16 v[54:55], v104 offset:39424
    buffer_load_dwordx4 v2, s[12:15], s63 offen offset:128 lds
    s_add_u32 m0, s29, 116608
    v_mfma_f32_16x16x32_bf16 v[28:31], v[64:67], a[84:87], v[28:31]
    ds_read_b64_tr_b16 v[56:57], v105 offset:34816
    ds_read_b64_tr_b16 v[58:59], v105 offset:35328
    buffer_load_dwordx4 v2, s[12:15], s64 offen offset:128 lds
    s_add_u32 m0, s29, 124672
    v_mfma_f32_16x16x32_bf16 v[28:31], v[68:71], a[92:95], v[28:31]
    ds_read_b64_tr_b16 v[60:61], v105 offset:38912
    buffer_load_dwordx4 v2, s[12:15], 0 offen offset:256 lds
    s_waitcnt lgkmcnt(3)
    v_mfma_f32_16x16x32_bf16 v[16:19], v[48:51], a[96:99], v[16:19]
    ds_read_b64_tr_b16 v[62:63], v105 offset:39424
    ds_read_b128 a[112:115], v72 offset:18432
    v_mfma_f32_16x16x32_bf16 v[16:19], v[52:55], a[104:107], v[16:19]
    ds_read_b128 a[120:123], v73 offset:18432
    ds_read_b64_tr_b16 v[64:65], v108 offset:10240
    v_mfma_f32_16x16x32_bf16 v[20:23], v[48:51], a[100:103], v[20:23]
    ds_read_b64_tr_b16 v[66:67], v108 offset:10752
    ds_read_b128 a[116:119], v72 offset:20480
    v_mfma_f32_16x16x32_bf16 v[20:23], v[52:55], a[108:111], v[20:23]
    ds_read_b128 a[124:127], v73 offset:20480
    ds_read_b64_tr_b16 v[68:69], v108 offset:14336
    s_waitcnt lgkmcnt(7)
    v_mfma_f32_16x16x32_bf16 v[24:27], v[56:59], a[96:99], v[24:27]
    ds_read_b64_tr_b16 v[70:71], v108 offset:14848
    ds_read_b64_tr_b16 v[48:49], v109 offset:10240
    v_mfma_f32_16x16x32_bf16 v[24:27], v[60:63], a[104:107], v[24:27]
    ds_read_b64_tr_b16 v[50:51], v109 offset:10752
    v_mfma_f32_16x16x32_bf16 v[28:31], v[56:59], a[100:103], v[28:31]
    ds_read_b64_tr_b16 v[52:53], v109 offset:14336
    v_mfma_f32_16x16x32_bf16 v[28:31], v[60:63], a[108:111], v[28:31]
    ds_read_b64_tr_b16 v[54:55], v109 offset:14848
    s_waitcnt lgkmcnt(4)
    v_mfma_f32_16x16x32_bf16 v[16:19], v[64:67], a[112:115], v[16:19]
    ds_read_b128 a[128:131], v72 offset:51200
    ds_read_b128 a[136:139], v73 offset:51200
    v_mfma_f32_16x16x32_bf16 v[16:19], v[68:71], a[120:123], v[16:19]
    ds_read_b64_tr_b16 v[56:57], v104 offset:43008
    ds_read_b64_tr_b16 v[58:59], v104 offset:43520
    v_mfma_f32_16x16x32_bf16 v[20:23], v[64:67], a[116:119], v[20:23]
    ds_read_b128 a[132:135], v72 offset:53248
    ds_read_b128 a[140:143], v73 offset:53248
    ds_read_b128 v[96:99], v10 offset:0
    v_mfma_f32_16x16x32_bf16 v[20:23], v[68:71], a[124:127], v[20:23]
    ds_read_b64_tr_b16 v[60:61], v104 offset:47104
    ds_read_b64_tr_b16 v[62:63], v104 offset:47616
    ds_read_b128 v[100:103], v10 offset:64
    s_waitcnt lgkmcnt(10)
    v_mfma_f32_16x16x32_bf16 v[24:27], v[48:51], a[112:115], v[24:27]
    ds_read_b64_tr_b16 v[64:65], v105 offset:43008
    ds_read_b128 v[88:91], v10 offset:256
    ds_read_b128 v[92:95], v10 offset:320
    v_mfma_f32_16x16x32_bf16 v[24:27], v[52:55], a[120:123], v[24:27]
    ds_read_b64_tr_b16 v[66:67], v105 offset:43520
    v_mov_b32 v9, 0
    s_mov_b32 exec_lo, s34
    s_mov_b32 exec_hi, 0
    buffer_store_dword v9, v111, s[20:23], s42 offen sc1
    s_mov_b64 exec, -1
    s_mov_b32 m0, 157440
    s_mov_b64 exec, 0x1ff
    buffer_load_dword v15, s[12:15], 0 offen offset:256  lds
    s_mov_b64 exec, -1
    s_mov_b32 s77, 1572864
    s_mov_b32 m0, 157696
    s_mov_b64 exec, 0xf
    buffer_load_dword v13, s[16:19], s77 offen offset:0  lds
    s_mov_b64 exec, -1
    s_mov_b64 s[16:17], s[48:49]
    s_mov_b32 s18, 5308416
    v_mfma_f32_16x16x32_bf16 v[28:31], v[48:51], a[116:119], v[28:31]
    ds_read_b64_tr_b16 v[68:69], v105 offset:47104
    v_mfma_f32_16x16x32_bf16 v[28:31], v[52:55], a[124:127], v[28:31]
    ds_read_b64_tr_b16 v[70:71], v105 offset:47616
    s_waitcnt lgkmcnt(7)
    v_mfma_f32_16x16x32_bf16 v[16:19], v[56:59], a[128:131], v[16:19]
    v_mfma_f32_16x16x32_bf16 v[16:19], v[60:63], a[136:139], v[16:19]
    s_waitcnt vmcnt(9) lgkmcnt(0)
    s_barrier
    v_mfma_f32_16x16x32_bf16 v[20:23], v[56:59], a[132:135], v[20:23]
    ds_read_b64_tr_b16 v[48:49], v106 offset:18432
    ds_read_b64_tr_b16 v[50:51], v106 offset:18944
    s_add_u32 m0, s29, 141056
    v_mfma_f32_16x16x32_bf16 v[20:23], v[60:63], a[140:143], v[20:23]
    ds_read_b64_tr_b16 v[52:53], v106 offset:22528
    buffer_load_dwordx4 v2, s[12:15], s57 offen offset:256 lds
    v_mfma_f32_16x16x32_bf16 v[24:27], v[64:67], a[128:131], v[24:27]
    ds_read_b64_tr_b16 v[54:55], v106 offset:23040
    ds_read_b64_tr_b16 v[56:57], v107 offset:18432
    s_add_u32 m0, s29, 1792
    v_mfma_f32_16x16x32_bf16 v[24:27], v[68:71], a[136:139], v[24:27]
    ds_read_b64_tr_b16 v[58:59], v107 offset:18944
    buffer_load_dwordx4 v2, s[12:15], s58 offen offset:256 lds
    v_mfma_f32_16x16x32_bf16 v[28:31], v[64:67], a[132:135], v[28:31]
    ds_read_b64_tr_b16 v[60:61], v107 offset:22528
    s_add_u32 m0, s29, 9984
    v_mfma_f32_16x16x32_bf16 v[28:31], v[68:71], a[140:143], v[28:31]
    ds_read_b64_tr_b16 v[62:63], v107 offset:23040
    buffer_load_dwordx4 v2, s[12:15], s59 offen offset:256 lds
    s_waitcnt lgkmcnt(4)
    v_mfma_f32_16x16x32_bf16 v[32:35], v[48:51], a[0:3], v[88:91]
    ds_read_b64_tr_b16 v[64:65], v108 offset:18432
    v_mfma_f32_16x16x32_bf16 v[32:35], v[52:55], a[8:11], v[32:35]
    ds_read_b64_tr_b16 v[66:67], v108 offset:18944
    v_mfma_f32_16x16x32_bf16 v[36:39], v[48:51], a[4:7], v[88:91]
    ds_read_b64_tr_b16 v[68:69], v108 offset:22528
    s_add_u32 m0, s29, 18176
    v_mfma_f32_16x16x32_bf16 v[36:39], v[52:55], a[12:15], v[36:39]
    ds_read_b64_tr_b16 v[70:71], v108 offset:23040
    buffer_load_dwordx4 v2, s[12:15], s60 offen offset:256 lds
    s_waitcnt lgkmcnt(4)
    v_mfma_f32_16x16x32_bf16 v[40:43], v[56:59], a[0:3], v[92:95]
    ds_read_b64_tr_b16 v[48:49], v109 offset:18432
    v_add_f32 v16, v16, v96
    v_fma_f32 v72, v16, s80, -0.5
    v_mfma_f32_16x16x32_bf16 v[40:43], v[60:63], a[8:11], v[40:43]
    ds_read_b64_tr_b16 v[50:51], v109 offset:18944
    v_add_f32 v17, v17, v97
    v_exp_f32 v72, v72
    v_mfma_f32_16x16x32_bf16 v[44:47], v[56:59], a[4:7], v[92:95]
    ds_read_b64_tr_b16 v[52:53], v109 offset:22528
    v_fma_f32 v73, v17, s80, -0.5
    v_add_f32 v72, s81, v72
    v_mfma_f32_16x16x32_bf16 v[44:47], v[60:63], a[12:15], v[44:47]
    ds_read_b64_tr_b16 v[54:55], v109 offset:23040
    v_add_f32 v18, v18, v98
    s_waitcnt lgkmcnt(4)
    v_mfma_f32_16x16x32_bf16 v[32:35], v[64:67], a[16:19], v[32:35]
    ds_read_b64_tr_b16 v[56:57], v106 offset:2048
    v_exp_f32 v73, v73
    v_fma_f32 v72, v72, v72, 0.5
    v_mfma_f32_16x16x32_bf16 v[32:35], v[68:71], a[24:27], v[32:35]
    ds_read_b64_tr_b16 v[58:59], v106 offset:2560
    v_fma_f32 v74, v18, s80, -0.5
    v_rcp_f32 v72, v72
    v_mfma_f32_16x16x32_bf16 v[36:39], v[64:67], a[20:23], v[36:39]
    ds_read_b64_tr_b16 v[60:61], v106 offset:6144
    v_add_f32 v73, s81, v73
    v_add_f32 v19, v19, v99
    v_mfma_f32_16x16x32_bf16 v[36:39], v[68:71], a[28:31], v[36:39]
    ds_read_b64_tr_b16 v[62:63], v106 offset:6656
    v_fma_f32 v72, -v16, v72, v16
    v_exp_f32 v74, v74
    s_waitcnt lgkmcnt(4)
    v_mfma_f32_16x16x32_bf16 v[40:43], v[48:51], a[16:19], v[40:43]
    ds_read_b64_tr_b16 v[64:65], v107 offset:2048
    v_fma_f32 v73, v73, v73, 0.5
    v_fma_f32 v75, v19, s80, -0.5
    v_mfma_f32_16x16x32_bf16 v[40:43], v[52:55], a[24:27], v[40:43]
    ds_read_b64_tr_b16 v[66:67], v107 offset:2560
    v_rcp_f32 v73, v73
    v_mfma_f32_16x16x32_bf16 v[44:47], v[48:51], a[20:23], v[44:47]
    ds_read_b64_tr_b16 v[68:69], v107 offset:6144
    v_add_f32 v74, s81, v74
    v_add_f32 v24, v24, v100
    v_mfma_f32_16x16x32_bf16 v[44:47], v[52:55], a[28:31], v[44:47]
    ds_read_b64_tr_b16 v[70:71], v107 offset:6656
    v_fma_f32 v73, -v17, v73, v17
    v_exp_f32 v75, v75
    s_waitcnt lgkmcnt(4)
    v_mfma_f32_16x16x32_bf16 v[32:35], v[56:59], a[32:35], v[32:35]
    ds_read_b64_tr_b16 v[48:49], v106 offset:10240
    v_fma_f32 v74, v74, v74, 0.5
    v_cvt_pk_bf16_f32 v80, v72, v73
    v_mfma_f32_16x16x32_bf16 v[32:35], v[60:63], a[40:43], v[32:35]
    ds_read_b64_tr_b16 v[50:51], v106 offset:10752
    v_fma_f32 v72, v24, s80, -0.5
    v_mfma_f32_16x16x32_bf16 v[36:39], v[56:59], a[36:39], v[36:39]
    ds_read_b64_tr_b16 v[52:53], v106 offset:14336
    v_rcp_f32 v74, v74
    v_add_f32 v75, s81, v75
    v_mfma_f32_16x16x32_bf16 v[36:39], v[60:63], a[44:47], v[36:39]
    ds_read_b64_tr_b16 v[54:55], v106 offset:14848
    v_add_f32 v25, v25, v101
    v_fma_f32 v74, -v18, v74, v18
    s_waitcnt lgkmcnt(4)
    v_mfma_f32_16x16x32_bf16 v[40:43], v[64:67], a[32:35], v[40:43]
    ds_read_b64_tr_b16 v[56:57], v107 offset:10240
    v_exp_f32 v72, v72
    v_fma_f32 v75, v75, v75, 0.5
    v_mfma_f32_16x16x32_bf16 v[40:43], v[68:71], a[40:43], v[40:43]
    ds_read_b64_tr_b16 v[58:59], v107 offset:10752
    v_fma_f32 v73, v25, s80, -0.5
    v_mfma_f32_16x16x32_bf16 v[44:47], v[64:67], a[36:39], v[44:47]
    ds_read_b64_tr_b16 v[60:61], v107 offset:14336
    v_rcp_f32 v75, v75
    v_add_f32 v72, s81, v72
    v_mfma_f32_16x16x32_bf16 v[44:47], v[68:71], a[44:47], v[44:47]
    ds_read_b64_tr_b16 v[62:63], v107 offset:14848
    v_add_f32 v26, v26, v102
    v_fma_f32 v75, -v19, v75, v19
    s_waitcnt lgkmcnt(4)
    v_mfma_f32_16x16x32_bf16 v[32:35], v[48:51], a[48:51], v[32:35]
    v_exp_f32 v73, v73
    v_fma_f32 v72, v72, v72, 0.5
    v_mfma_f32_16x16x32_bf16 v[32:35], v[52:55], a[56:59], v[32:35]
    v_cvt_pk_bf16_f32 v81, v74, v75
    v_fma_f32 v74, v26, s80, -0.5
    s_waitcnt vmcnt(6) lgkmcnt(0)
    s_barrier
    s_cmp_eq_u32 s28, 0
    s_cbranch_scc1 L_arr_o
L_arr:
    v_mfma_f32_16x16x32_bf16 v[36:39], v[48:51], a[52:55], v[36:39]
    ds_read_b64_tr_b16 v[64:65], v106 offset:26624
    ds_read_b64_tr_b16 v[66:67], v106 offset:27136
    v_rcp_f32 v72, v72
    v_add_f32 v73, s81, v73
    s_add_u32 m0, s29, 26368
    v_mfma_f32_16x16x32_bf16 v[36:39], v[52:55], a[60:63], v[36:39]
    ds_read_b64_tr_b16 v[68:69], v106 offset:30720
    buffer_load_dwordx4 v2, s[12:15], s61 offen offset:256 lds
    v_add_f32 v27, v27, v103
    v_mfma_f32_16x16x32_bf16 v[40:43], v[56:59], a[48:51], v[40:43]
    ds_read_b64_tr_b16 v[70:71], v106 offset:31232
    ds_read_b64_tr_b16 v[48:49], v107 offset:26624
    v_fma_f32 v72, -v24, v72, v24
    v_exp_f32 v74, v74
    v_mfma_f32_16x16x32_bf16 v[40:43], v[60:63], a[56:59], v[40:43]
    ds_read_b64_tr_b16 v[50:51], v107 offset:27136
    v_fma_f32 v73, v73, v73, 0.5
    v_fma_f32 v75, v27, s80, -0.5
    v_mfma_f32_16x16x32_bf16 v[44:47], v[56:59], a[52:55], v[44:47]
    ds_read_b64_tr_b16 v[52:53], v107 offset:30720
    v_rcp_f32 v73, v73
    v_add_f32 v74, s81, v74
    s_add_u32 m0, s29, 83712
    v_mfma_f32_16x16x32_bf16 v[44:47], v[60:63], a[60:63], v[44:47]
    ds_read_b64_tr_b16 v[54:55], v107 offset:31232
    buffer_load_dwordx4 v2, s[12:15], s62 offen offset:256 lds
    v_add_f32 v20, v20, v96
    s_waitcnt lgkmcnt(4)
    v_mfma_f32_16x16x32_bf16 v[32:35], v[64:67], a[64:67], v[32:35]
    ds_read_b64_tr_b16 v[56:57], v108 offset:2048
    v_fma_f32 v73, -v25, v73, v25
    v_exp_f32 v75, v75
    v_mfma_f32_16x16x32_bf16 v[32:35], v[68:71], a[72:75], v[32:35]
    ds_read_b64_tr_b16 v[58:59], v108 offset:2560
    v_fma_f32 v74, v74, v74, 0.5
    v_cvt_pk_bf16_f32 v82, v72, v73
    v_mfma_f32_16x16x32_bf16 v[36:39], v[64:67], a[68:71], v[36:39]
    ds_read_b64_tr_b16 v[60:61], v108 offset:6144
    v_fma_f32 v72, v20, s80, -0.5
    v_rcp_f32 v74, v74
    s_add_u32 m0, s29, 149248
    v_mfma_f32_16x16x32_bf16 v[36:39], v[68:71], a[76:79], v[36:39]
    ds_read_b64_tr_b16 v[62:63], v108 offset:6656
    buffer_load_dwordx4 v2, s[12:15], s63 offen offset:256 lds
    v_add_f32 v75, s81, v75
    s_waitcnt lgkmcnt(4)
    v_mfma_f32_16x16x32_bf16 v[40:43], v[48:51], a[64:67], v[40:43]
    ds_read_b64_tr_b16 v[64:65], v109 offset:2048
    v_add_f32 v21, v21, v97
    v_fma_f32 v74, -v26, v74, v26
    v_mfma_f32_16x16x32_bf16 v[40:43], v[52:55], a[72:75], v[40:43]
    ds_read_b64_tr_b16 v[66:67], v109 offset:2560
    v_exp_f32 v72, v72
    v_fma_f32 v75, v75, v75, 0.5
    v_mfma_f32_16x16x32_bf16 v[44:47], v[48:51], a[68:71], v[44:47]
    ds_read_b64_tr_b16 v[68:69], v109 offset:6144
    v_fma_f32 v73, v21, s80, -0.5
    v_rcp_f32 v75, v75
    s_add_u32 m0, s29, 34560
    v_mfma_f32_16x16x32_bf16 v[44:47], v[52:55], a[76:79], v[44:47]
    ds_read_b64_tr_b16 v[70:71], v109 offset:6656
    buffer_load_dwordx4 v2, s[12:15], s64 offen offset:256 lds
    v_add_f32 v72, s81, v72
    s_waitcnt lgkmcnt(4)
    v_mfma_f32_16x16x32_bf16 v[32:35], v[56:59], a[80:83], v[32:35]
    ds_read_b64_tr_b16 v[48:49], v106 offset:34816
    v_add_f32 v22, v22, v98
    v_fma_f32 v75, -v27, v75, v27
    v_mfma_f32_16x16x32_bf16 v[32:35], v[60:63], a[88:91], v[32:35]
    ds_read_b64_tr_b16 v[50:51], v106 offset:35328
    v_exp_f32 v73, v73
    v_fma_f32 v72, v72, v72, 0.5
    v_mfma_f32_16x16x32_bf16 v[36:39], v[56:59], a[84:87], v[36:39]
    ds_read_b64_tr_b16 v[52:53], v106 offset:38912
    v_cvt_pk_bf16_f32 v83, v74, v75
    v_fma_f32 v74, v22, s80, -0.5
    v_rcp_f32 v72, v72
    v_mfma_f32_16x16x32_bf16 v[36:39], v[60:63], a[92:95], v[36:39]
    ds_read_b64_tr_b16 v[54:55], v106 offset:39424
    s_mov_b32 s33, 0
    buffer_store_dwordx4 v[80:83], v5, s[20:23], s33 offen offset:0 sc1
    s_waitcnt lgkmcnt(4)
    v_mfma_f32_16x16x32_bf16 v[40:43], v[64:67], a[80:83], v[40:43]
    ds_read_b64_tr_b16 v[56:57], v107 offset:34816
    v_add_f32 v73, s81, v73
    v_add_f32 v23, v23, v99
    v_mfma_f32_16x16x32_bf16 v[40:43], v[68:71], a[88:91], v[40:43]
    ds_read_b64_tr_b16 v[58:59], v107 offset:35328
    v_fma_f32 v72, -v20, v72, v20
    v_exp_f32 v74, v74
    v_mfma_f32_16x16x32_bf16 v[44:47], v[64:67], a[84:87], v[44:47]
    ds_read_b64_tr_b16 v[60:61], v107 offset:38912
    v_fma_f32 v73, v73, v73, 0.5
    v_fma_f32 v75, v23, s80, -0.5
    v_mfma_f32_16x16x32_bf16 v[44:47], v[68:71], a[92:95], v[44:47]
    ds_read_b64_tr_b16 v[62:63], v107 offset:39424
    v_rcp_f32 v73, v73
    s_waitcnt lgkmcnt(4)
    v_mfma_f32_16x16x32_bf16 v[32:35], v[48:51], a[96:99], v[32:35]
    ds_read_b64_tr_b16 v[64:65], v106 offset:43008
    v_add_f32 v74, s81, v74
    v_add_f32 v28, v28, v100
    v_mfma_f32_16x16x32_bf16 v[32:35], v[52:55], a[104:107], v[32:35]
    ds_read_b64_tr_b16 v[66:67], v106 offset:43520
    v_fma_f32 v73, -v21, v73, v21
    v_exp_f32 v75, v75
    v_mfma_f32_16x16x32_bf16 v[36:39], v[48:51], a[100:103], v[36:39]
    ds_read_b64_tr_b16 v[68:69], v106 offset:47104
    v_fma_f32 v74, v74, v74, 0.5
    v_cvt_pk_bf16_f32 v84, v72, v73
    v_mfma_f32_16x16x32_bf16 v[36:39], v[52:55], a[108:111], v[36:39]
    ds_read_b64_tr_b16 v[70:71], v106 offset:47616
    v_fma_f32 v72, v28, s80, -0.5
    s_waitcnt lgkmcnt(4)
    v_mfma_f32_16x16x32_bf16 v[40:43], v[56:59], a[96:99], v[40:43]
    ds_read_b64_tr_b16 v[48:49], v107 offset:43008
    v_rcp_f32 v74, v74
    v_add_f32 v75, s81, v75
    v_mfma_f32_16x16x32_bf16 v[40:43], v[60:63], a[104:107], v[40:43]
    ds_read_b64_tr_b16 v[50:51], v107 offset:43520
    v_add_f32 v29, v29, v101
    v_fma_f32 v74, -v22, v74, v22
    v_mfma_f32_16x16x32_bf16 v[44:47], v[56:59], a[100:103], v[44:47]
    ds_read_b64_tr_b16 v[52:53], v107 offset:47104
    v_exp_f32 v72, v72
    v_fma_f32 v75, v75, v75, 0.5
    v_mfma_f32_16x16x32_bf16 v[44:47], v[60:63], a[108:111], v[44:47]
    ds_read_b64_tr_b16 v[54:55], v107 offset:47616
    v_fma_f32 v73, v29, s80, -0.5
    s_waitcnt lgkmcnt(4)
    v_mfma_f32_16x16x32_bf16 v[32:35], v[64:67], a[112:115], v[32:35]
    v_rcp_f32 v75, v75
    v_add_f32 v72, s81, v72
    v_mfma_f32_16x16x32_bf16 v[32:35], v[68:71], a[120:123], v[32:35]
    v_add_f32 v30, v30, v102
    v_fma_f32 v75, -v23, v75, v23
    s_waitcnt vmcnt(7) lgkmcnt(0)
    s_barrier
    v_mfma_f32_16x16x32_bf16 v[36:39], v[64:67], a[116:119], v[36:39]
    ds_read_b64_tr_b16 v[56:57], v106 offset:51200
    ds_read_b64_tr_b16 v[58:59], v106 offset:51712
    v_exp_f32 v73, v73
    v_fma_f32 v72, v72, v72, 0.5
    s_add_u32 m0, s29, 42624
    v_mfma_f32_16x16x32_bf16 v[36:39], v[68:71], a[124:127], v[36:39]
    ds_read_b64_tr_b16 v[60:61], v106 offset:55296
    buffer_load_dwordx4 v2, s[12:15], 0 offen offset:384 lds
    v_cvt_pk_bf16_f32 v85, v74, v75
    v_fma_f32 v74, v30, s80, -0.5
    v_mfma_f32_16x16x32_bf16 v[40:43], v[48:51], a[112:115], v[40:43]
    ds_read_b64_tr_b16 v[62:63], v106 offset:55808
    ds_read_b64_tr_b16 v[64:65], v107 offset:51200
    v_rcp_f32 v72, v72
    v_add_f32 v73, s81, v73
    v_add_f32 v31, v31, v103
    v_mfma_f32_16x16x32_bf16 v[40:43], v[52:55], a[120:123], v[40:43]
    ds_read_b64_tr_b16 v[66:67], v107 offset:51712
    ds_read_b128 v[88:91], v10 offset:512
    ds_read_b128 v[92:95], v10 offset:576
    s_mov_b32 m0, 157184
    s_mov_b64 exec, 0x1ff
    buffer_load_dword v15, s[12:15], 0 offen offset:512  lds
    s_mov_b64 exec, -1
    v_mfma_f32_16x16x32_bf16 v[44:47], v[48:51], a[116:119], v[44:47]
    ds_read_b64_tr_b16 v[68:69], v107 offset:55296
    v_fma_f32 v72, -v28, v72, v28
    v_exp_f32 v74, v74
    v_mfma_f32_16x16x32_bf16 v[44:47], v[52:55], a[124:127], v[44:47]
    ds_read_b64_tr_b16 v[70:71], v107 offset:55808
    v_fma_f32 v73, v73, v73, 0.5
    v_fma_f32 v75, v31, s80, -0.5
    s_waitcnt lgkmcnt(6)
    v_mfma_f32_16x16x32_bf16 v[32:35], v[56:59], a[128:131], v[32:35]
    ds_read_b64_tr_b16 v[48:49], v106 offset:59392
    v_rcp_f32 v73, v73
    v_add_f32 v74, s81, v74
    v_mfma_f32_16x16x32_bf16 v[32:35], v[60:63], a[136:139], v[32:35]
    ds_read_b64_tr_b16 v[50:51], v106 offset:59904
    v_fma_f32 v73, -v29, v73, v29
    v_mfma_f32_16x16x32_bf16 v[36:39], v[56:59], a[132:135], v[36:39]
    ds_read_b64_tr_b16 v[52:53], v106 offset:63488
    v_exp_f32 v75, v75
    v_fma_f32 v74, v74, v74, 0.5
    v_mfma_f32_16x16x32_bf16 v[36:39], v[60:63], a[140:143], v[36:39]
    ds_read_b64_tr_b16 v[54:55], v106 offset:64000
    v_cvt_pk_bf16_f32 v86, v72, v73
    s_waitcnt lgkmcnt(4)
    v_mfma_f32_16x16x32_bf16 v[40:43], v[64:67], a[128:131], v[40:43]
    ds_read_b64_tr_b16 v[56:57], v107 offset:59392
    v_rcp_f32 v74, v74
    v_add_f32 v75, s81, v75
    v_mfma_f32_16x16x32_bf16 v[40:43], v[68:71], a[136:139], v[40:43]
    ds_read_b64_tr_b16 v[58:59], v107 offset:59904
    v_fma_f32 v74, -v30, v74, v30
    v_fma_f32 v75, v75, v75, 0.5
    v_mfma_f32_16x16x32_bf16 v[44:47], v[64:67], a[132:135], v[44:47]
    ds_read_b64_tr_b16 v[60:61], v107 offset:63488
    v_rcp_f32 v75, v75
    s_nop 0
    v_fma_f32 v75, -v31, v75, v31
    v_mfma_f32_16x16x32_bf16 v[44:47], v[68:71], a[140:143], v[44:47]
    ds_read_b64_tr_b16 v[62:63], v107 offset:64000
    v_cvt_pk_bf16_f32 v87, v74, v75
    buffer_store_dwordx4 v[84:87], v5, s[20:23], s33 offen offset:1024 sc1
    s_waitcnt lgkmcnt(4)
    v_mfma_f32_16x16x32_bf16 v[16:19], v[48:51], a[0:3], v[88:91]
    ds_read_b64_tr_b16 v[64:65], v108 offset:10240
    v_mfma_f32_16x16x32_bf16 v[16:19], v[52:55], a[8:11], v[16:19]
    ds_read_b64_tr_b16 v[66:67], v108 offset:10752
    v_mfma_f32_16x16x32_bf16 v[20:23], v[48:51], a[4:7], v[88:91]
    ds_read_b64_tr_b16 v[68:69], v108 offset:14336
    v_mfma_f32_16x16x32_bf16 v[20:23], v[52:55], a[12:15], v[20:23]
    ds_read_b64_tr_b16 v[70:71], v108 offset:14848
    s_waitcnt lgkmcnt(4)
    v_mfma_f32_16x16x32_bf16 v[24:27], v[56:59], a[0:3], v[92:95]
    ds_read_b64_tr_b16 v[48:49], v109 offset:10240
    v_fma_f32 v72, v32, s80, -0.5
    v_exp_f32 v72, v72
    v_mfma_f32_16x16x32_bf16 v[24:27], v[60:63], a[8:11], v[24:27]
    ds_read_b64_tr_b16 v[50:51], v109 offset:10752
    v_fma_f32 v73, v33, s80, -0.5
    v_mfma_f32_16x16x32_bf16 v[28:31], v[56:59], a[4:7], v[92:95]
    ds_read_b64_tr_b16 v[52:53], v109 offset:14336
    v_add_f32 v72, s81, v72
    v_exp_f32 v73, v73
    v_mfma_f32_16x16x32_bf16 v[28:31], v[60:63], a[12:15], v[28:31]
    ds_read_b64_tr_b16 v[54:55], v109 offset:14848
    v_fma_f32 v72, v72, v72, 0.5
    s_waitcnt lgkmcnt(4)
    v_mfma_f32_16x16x32_bf16 v[16:19], v[64:67], a[16:19], v[16:19]
    ds_read_b64_tr_b16 v[56:57], v104 offset:2048
    v_fma_f32 v74, v34, s80, -0.5
    v_rcp_f32 v72, v72
    v_mfma_f32_16x16x32_bf16 v[16:19], v[68:71], a[24:27], v[16:19]
    ds_read_b64_tr_b16 v[58:59], v104 offset:2560
    v_add_f32 v73, s81, v73
    v_mfma_f32_16x16x32_bf16 v[20:23], v[64:67], a[20:23], v[20:23]
    ds_read_b64_tr_b16 v[60:61], v104 offset:6144
    v_fma_f32 v72, -v32, v72, v32
    v_exp_f32 v74, v74
    v_mfma_f32_16x16x32_bf16 v[20:23], v[68:71], a[28:31], v[20:23]
    ds_read_b64_tr_b16 v[62:63], v104 offset:6656
    v_fma_f32 v73, v73, v73, 0.5
    s_waitcnt lgkmcnt(4)
    v_mfma_f32_16x16x32_bf16 v[24:27], v[48:51], a[16:19], v[24:27]
    ds_read_b64_tr_b16 v[64:65], v105 offset:2048
    v_fma_f32 v75, v35, s80, -0.5
    v_rcp_f32 v73, v73
    v_mfma_f32_16x16x32_bf16 v[24:27], v[52:55], a[24:27], v[24:27]
    ds_read_b64_tr_b16 v[66:67], v105 offset:2560
    v_add_f32 v74, s81, v74
    v_mfma_f32_16x16x32_bf16 v[28:31], v[48:51], a[20:23], v[28:31]
    ds_read_b64_tr_b16 v[68:69], v105 offset:6144
    v_fma_f32 v73, -v33, v73, v33
    v_exp_f32 v75, v75
    v_mfma_f32_16x16x32_bf16 v[28:31], v[52:55], a[28:31], v[28:31]
    ds_read_b64_tr_b16 v[70:71], v105 offset:6656
    v_fma_f32 v74, v74, v74, 0.5
    s_waitcnt lgkmcnt(4)
    v_mfma_f32_16x16x32_bf16 v[16:19], v[56:59], a[32:35], v[16:19]
    v_cvt_pk_bf16_f32 v80, v72, v73
    v_fma_f32 v72, v40, s80, -0.5
    s_add_u32 m0, s29, 91776
    v_mfma_f32_16x16x32_bf16 v[16:19], v[60:63], a[40:43], v[16:19]
    buffer_load_dwordx4 v2, s[12:15], s57 offen offset:384 lds
    v_rcp_f32 v74, v74
    s_waitcnt vmcnt(7) lgkmcnt(0)
    s_barrier
    v_mfma_f32_16x16x32_bf16 v[20:23], v[56:59], a[36:39], v[20:23]
    ds_read_b64_tr_b16 v[48:49], v104 offset:10240
    ds_read_b64_tr_b16 v[50:51], v104 offset:10752
    v_add_f32 v75, s81, v75
    v_fma_f32 v74, -v34, v74, v34
    v_mfma_f32_16x16x32_bf16 v[20:23], v[60:63], a[44:47], v[20:23]
    ds_read_b64_tr_b16 v[52:53], v104 offset:14336
    v_exp_f32 v72, v72
    v_mfma_f32_16x16x32_bf16 v[24:27], v[64:67], a[32:35], v[24:27]
    ds_read_b64_tr_b16 v[54:55], v104 offset:14848
    ds_read_b64_tr_b16 v[56:57], v105 offset:10240
    v_fma_f32 v75, v75, v75, 0.5
    v_fma_f32 v73, v41, s80, -0.5
    s_add_u32 m0, s29, 132736
    v_mfma_f32_16x16x32_bf16 v[24:27], v[68:71], a[40:43], v[24:27]
    ds_read_b64_tr_b16 v[58:59], v105 offset:10752
    buffer_load_dwordx4 v2, s[12:15], s58 offen offset:384 lds
    v_rcp_f32 v75, v75
    v_add_f32 v72, s81, v72
    v_mfma_f32_16x16x32_bf16 v[28:31], v[64:67], a[36:39], v[28:31]
    ds_read_b64_tr_b16 v[60:61], v105 offset:14336
    v_fma_f32 v75, -v35, v75, v35
    v_exp_f32 v73, v73
    v_mfma_f32_16x16x32_bf16 v[28:31], v[68:71], a[44:47], v[28:31]
    ds_read_b64_tr_b16 v[62:63], v105 offset:14848
    v_fma_f32 v72, v72, v72, 0.5
    s_waitcnt lgkmcnt(4)
    v_mfma_f32_16x16x32_bf16 v[16:19], v[48:51], a[48:51], v[16:19]
    ds_read_b64_tr_b16 v[64:65], v104 offset:18432
    v_cvt_pk_bf16_f32 v81, v74, v75
    v_fma_f32 v74, v42, s80, -0.5
    s_add_u32 m0, s29, 50816
    v_mfma_f32_16x16x32_bf16 v[16:19], v[52:55], a[56:59], v[16:19]
    ds_read_b64_tr_b16 v[66:67], v104 offset:18944
    buffer_load_dwordx4 v2, s[12:15], s59 offen offset:384 lds
    v_rcp_f32 v72, v72
    v_mfma_f32_16x16x32_bf16 v[20:23], v[48:51], a[52:55], v[20:23]
    ds_read_b64_tr_b16 v[68:69], v104 offset:22528
    v_add_f32 v73, s81, v73
    v_fma_f32 v72, -v40, v72, v40
    v_mfma_f32_16x16x32_bf16 v[20:23], v[52:55], a[60:63], v[20:23]
    ds_read_b64_tr_b16 v[70:71], v104 offset:23040
    v_exp_f32 v74, v74
    s_waitcnt lgkmcnt(4)
    v_mfma_f32_16x16x32_bf16 v[24:27], v[56:59], a[48:51], v[24:27]
    ds_read_b64_tr_b16 v[48:49], v105 offset:18432
    v_fma_f32 v73, v73, v73, 0.5
    v_fma_f32 v75, v43, s80, -0.5
    s_add_u32 m0, s29, 1664
    v_mfma_f32_16x16x32_bf16 v[24:27], v[60:63], a[56:59], v[24:27]
    ds_read_b64_tr_b16 v[50:51], v105 offset:18944
    buffer_load_dwordx4 v2, s[12:15], s60 offen offset:384 lds
    v_rcp_f32 v73, v73
    v_mfma_f32_16x16x32_bf16 v[28:31], v[56:59], a[52:55], v[28:31]
    ds_read_b64_tr_b16 v[52:53], v105 offset:22528
    v_add_f32 v74, s81, v74
    v_fma_f32 v73, -v41, v73, v41
    v_mfma_f32_16x16x32_bf16 v[28:31], v[60:63], a[60:63], v[28:31]
    ds_read_b64_tr_b16 v[54:55], v105 offset:23040
    v_exp_f32 v75, v75
    s_waitcnt lgkmcnt(4)
    v_mfma_f32_16x16x32_bf16 v[16:19], v[64:67], a[64:67], v[16:19]
    ds_read_b64_tr_b16 v[56:57], v104 offset:26624
    v_fma_f32 v74, v74, v74, 0.5
    v_cvt_pk_bf16_f32 v82, v72, v73
    s_add_u32 m0, s29, 59008
    v_mfma_f32_16x16x32_bf16 v[16:19], v[68:71], a[72:75], v[16:19]
    ds_read_b64_tr_b16 v[58:59], v104 offset:27136
    buffer_load_dwordx4 v2, s[12:15], s61 offen offset:384 lds
    v_fma_f32 v72, v36, s80, -0.5
    v_mfma_f32_16x16x32_bf16 v[20:23], v[64:67], a[68:71], v[20:23]
    ds_read_b64_tr_b16 v[60:61], v104 offset:30720
    v_rcp_f32 v74, v74
    v_add_f32 v75, s81, v75
    v_mfma_f32_16x16x32_bf16 v[20:23], v[68:71], a[76:79], v[20:23]
    ds_read_b64_tr_b16 v[62:63], v104 offset:31232
    v_fma_f32 v74, -v42, v74, v42
    s_waitcnt lgkmcnt(4)
    v_mfma_f32_16x16x32_bf16 v[24:27], v[48:51], a[64:67], v[24:27]
    ds_read_b64_tr_b16 v[64:65], v105 offset:26624
    v_exp_f32 v72, v72
    v_fma_f32 v75, v75, v75, 0.5
    s_add_u32 m0, s29, 140928
    v_mfma_f32_16x16x32_bf16 v[24:27], v[52:55], a[72:75], v[24:27]
    ds_read_b64_tr_b16 v[66:67], v105 offset:27136
    buffer_load_dwordx4 v2, s[12:15], s62 offen offset:384 lds
    v_fma_f32 v73, v37, s80, -0.5
    v_mfma_f32_16x16x32_bf16 v[28:31], v[48:51], a[68:71], v[28:31]
    ds_read_b64_tr_b16 v[68:69], v105 offset:30720
    v_rcp_f32 v75, v75
    v_add_f32 v72, s81, v72
    v_mfma_f32_16x16x32_bf16 v[28:31], v[52:55], a[76:79], v[28:31]
    ds_read_b64_tr_b16 v[70:71], v105 offset:31232
    v_fma_f32 v75, -v43, v75, v43
    v_exp_f32 v73, v73
    s_waitcnt lgkmcnt(4)
    v_mfma_f32_16x16x32_bf16 v[16:19], v[56:59], a[80:83], v[16:19]
    ds_read_b64_tr_b16 v[48:49], v106 offset:18432
    v_fma_f32 v72, v72, v72, 0.5
    v_cvt_pk_bf16_f32 v83, v74, v75
    s_add_u32 m0, s29, 67200
    v_mfma_f32_16x16x32_bf16 v[16:19], v[60:63], a[88:91], v[16:19]
    ds_read_b64_tr_b16 v[50:51], v106 offset:18944
    buffer_load_dwordx4 v2, s[12:15], s63 offen offset:384 lds
    v_fma_f32 v74, v38, s80, -0.5
    v_mfma_f32_16x16x32_bf16 v[20:23], v[56:59], a[84:87], v[20:23]
    ds_read_b64_tr_b16 v[52:53], v106 offset:22528
    v_rcp_f32 v72, v72
    s_mov_b32 s33, 16384
    v_mfma_f32_16x16x32_bf16 v[20:23], v[60:63], a[92:95], v[20:23]
    ds_read_b64_tr_b16 v[54:55], v106 offset:23040
    buffer_store_dwordx4 v[80:83], v5, s[20:23], s33 offen offset:0 sc1
    v_add_f32 v73, s81, v73
    s_waitcnt lgkmcnt(4)
    v_mfma_f32_16x16x32_bf16 v[24:27], v[64:67], a[80:83], v[24:27]
    ds_read_b64_tr_b16 v[56:57], v107 offset:18432
    v_fma_f32 v72, -v36, v72, v36
    v_exp_f32 v74, v74
    v_mfma_f32_16x16x32_bf16 v[24:27], v[68:71], a[88:91], v[24:27]
    ds_read_b64_tr_b16 v[58:59], v107 offset:18944
    v_fma_f32 v73, v73, v73, 0.5
    v_mfma_f32_16x16x32_bf16 v[28:31], v[64:67], a[84:87], v[28:31]
    ds_read_b64_tr_b16 v[60:61], v107 offset:22528
    v_fma_f32 v75, v39, s80, -0.5
    v_rcp_f32 v73, v73
    v_mfma_f32_16x16x32_bf16 v[28:31], v[68:71], a[92:95], v[28:31]
    ds_read_b64_tr_b16 v[62:63], v107 offset:23040
    v_add_f32 v74, s81, v74
    s_waitcnt lgkmcnt(4)
    v_mfma_f32_16x16x32_bf16 v[16:19], v[48:51], a[96:99], v[16:19]
    v_fma_f32 v73, -v37, v73, v37
    v_exp_f32 v75, v75
    v_mfma_f32_16x16x32_bf16 v[16:19], v[52:55], a[104:107], v[16:19]
    v_fma_f32 v74, v74, v74, 0.5
    s_waitcnt vmcnt(7) lgkmcnt(0)
    s_barrier
    v_mfma_f32_16x16x32_bf16 v[20:23], v[48:51], a[100:103], v[20:23]
    ds_read_b64_tr_b16 v[64:65], v108 offset:18432
    ds_read_b64_tr_b16 v[66:67], v108 offset:18944
    v_cvt_pk_bf16_f32 v84, v72, v73
    v_fma_f32 v72, v44, s80, -0.5
    s_add_u32 m0, s29, 9856
    v_mfma_f32_16x16x32_bf16 v[20:23], v[52:55], a[108:111], v[20:23]
    ds_read_b64_tr_b16 v[68:69], v108 offset:22528
    buffer_load_dwordx4 v2, s[12:15], s64 offen offset:384 lds
    v_rcp_f32 v74, v74
    v_mfma_f32_16x16x32_bf16 v[24:27], v[56:59], a[96:99], v[24:27]
    ds_read_b64_tr_b16 v[70:71], v108 offset:23040
    ds_read_b64_tr_b16 v[48:49], v109 offset:18432
    v_add_f32 v75, s81, v75
    v_fma_f32 v74, -v38, v74, v38
    v_mfma_f32_16x16x32_bf16 v[24:27], v[60:63], a[104:107], v[24:27]
    ds_read_b64_tr_b16 v[50:51], v109 offset:18944
    v_exp_f32 v72, v72
    s_mov_b32 s84, 0
    s_mov_b32 m0, 157696
    s_mov_b64 exec, 0x1ff
    buffer_load_dword v14, s[16:19], s84 offen offset:0  lds
    s_mov_b64 exec, -1
    s_mov_b64 s[8:9], s[40:41]
    s_mov_b32 s10, 663552
    s_mov_b32 m0, 157696
    s_mov_b64 exec, 0xf
    buffer_load_dword v13, s[8:11], 0 offen offset:0  lds
    s_mov_b64 exec, -1
    v_mfma_f32_16x16x32_bf16 v[28:31], v[56:59], a[100:103], v[28:31]
    ds_read_b64_tr_b16 v[52:53], v109 offset:22528
    v_fma_f32 v75, v75, v75, 0.5
    v_fma_f32 v73, v45, s80, -0.5
    v_mfma_f32_16x16x32_bf16 v[28:31], v[60:63], a[108:111], v[28:31]
    ds_read_b64_tr_b16 v[54:55], v109 offset:23040
    v_rcp_f32 v75, v75
    v_add_f32 v72, s81, v72
    s_waitcnt lgkmcnt(4)
    v_mfma_f32_16x16x32_bf16 v[16:19], v[64:67], a[112:115], v[16:19]
    ds_read_b64_tr_b16 v[56:57], v104 offset:34816
    v_fma_f32 v75, -v39, v75, v39
    v_exp_f32 v73, v73
    v_mfma_f32_16x16x32_bf16 v[16:19], v[68:71], a[120:123], v[16:19]
    ds_read_b64_tr_b16 v[58:59], v104 offset:35328
    v_fma_f32 v72, v72, v72, 0.5
    v_mfma_f32_16x16x32_bf16 v[20:23], v[64:67], a[116:119], v[20:23]
    ds_read_b64_tr_b16 v[60:61], v104 offset:38912
    v_cvt_pk_bf16_f32 v85, v74, v75
    v_fma_f32 v74, v46, s80, -0.5
    v_mfma_f32_16x16x32_bf16 v[20:23], v[68:71], a[124:127], v[20:23]
    ds_read_b64_tr_b16 v[62:63], v104 offset:39424
    v_rcp_f32 v72, v72
    s_waitcnt lgkmcnt(4)
    v_mfma_f32_16x16x32_bf16 v[24:27], v[48:51], a[112:115], v[24:27]
    ds_read_b64_tr_b16 v[64:65], v105 offset:34816
    v_add_f32 v73, s81, v73
    v_fma_f32 v72, -v44, v72, v44
    v_exp_f32 v74, v74
    v_mfma_f32_16x16x32_bf16 v[24:27], v[52:55], a[120:123], v[24:27]
    ds_read_b64_tr_b16 v[66:67], v105 offset:35328
    ds_read_b128 v[88:91], v10 offset:768
    ds_read_b128 v[92:95], v10 offset:832
    v_mfma_f32_16x16x32_bf16 v[28:31], v[48:51], a[116:119], v[28:31]
    ds_read_b64_tr_b16 v[68:69], v105 offset:38912
    v_fma_f32 v73, v73, v73, 0.5
    v_fma_f32 v75, v47, s80, -0.5
    v_mfma_f32_16x16x32_bf16 v[28:31], v[52:55], a[124:127], v[28:31]
    ds_read_b64_tr_b16 v[70:71], v105 offset:39424
    v_rcp_f32 v73, v73
    s_waitcnt lgkmcnt(6)
    v_mfma_f32_16x16x32_bf16 v[16:19], v[56:59], a[128:131], v[16:19]
    ds_read_b64_tr_b16 v[48:49], v104 offset:43008
    v_add_f32 v74, s81, v74
    v_fma_f32 v73, -v45, v73, v45
    v_mfma_f32_16x16x32_bf16 v[16:19], v[60:63], a[136:139], v[16:19]
    ds_read_b64_tr_b16 v[50:51], v104 offset:43520
    v_exp_f32 v75, v75
    v_mfma_f32_16x16x32_bf16 v[20:23], v[56:59], a[132:135], v[20:23]
    ds_read_b64_tr_b16 v[52:53], v104 offset:47104
    v_fma_f32 v74, v74, v74, 0.5
    v_cvt_pk_bf16_f32 v86, v72, v73
    v_mfma_f32_16x16x32_bf16 v[20:23], v[60:63], a[140:143], v[20:23]
    ds_read_b64_tr_b16 v[54:55], v104 offset:47616
    v_rcp_f32 v74, v74
    s_waitcnt lgkmcnt(4)
    v_mfma_f32_16x16x32_bf16 v[24:27], v[64:67], a[128:131], v[24:27]
    ds_read_b64_tr_b16 v[56:57], v105 offset:43008
    v_add_f32 v75, s81, v75
    v_fma_f32 v74, -v46, v74, v46
    v_mfma_f32_16x16x32_bf16 v[24:27], v[68:71], a[136:139], v[24:27]
    ds_read_b64_tr_b16 v[58:59], v105 offset:43520
    v_fma_f32 v75, v75, v75, 0.5
    v_mfma_f32_16x16x32_bf16 v[28:31], v[64:67], a[132:135], v[28:31]
    ds_read_b64_tr_b16 v[60:61], v105 offset:47104
    v_rcp_f32 v75, v75
    s_nop 0
    v_fma_f32 v75, -v47, v75, v47
    v_mfma_f32_16x16x32_bf16 v[28:31], v[68:71], a[140:143], v[28:31]
    ds_read_b64_tr_b16 v[62:63], v105 offset:47616
    v_cvt_pk_bf16_f32 v87, v74, v75
    buffer_store_dwordx4 v[84:87], v5, s[20:23], s33 offen offset:1024 sc1
    s_waitcnt lgkmcnt(4)
    v_mfma_f32_16x16x32_bf16 v[32:35], v[48:51], a[0:3], v[88:91]
    ds_read_b64_tr_b16 v[64:65], v106 offset:26624
    v_mfma_f32_16x16x32_bf16 v[32:35], v[52:55], a[8:11], v[32:35]
    ds_read_b64_tr_b16 v[66:67], v106 offset:27136
    v_mfma_f32_16x16x32_bf16 v[36:39], v[48:51], a[4:7], v[88:91]
    ds_read_b64_tr_b16 v[68:69], v106 offset:30720
    v_mfma_f32_16x16x32_bf16 v[36:39], v[52:55], a[12:15], v[36:39]
    ds_read_b64_tr_b16 v[70:71], v106 offset:31232
    s_waitcnt lgkmcnt(4)
    v_mfma_f32_16x16x32_bf16 v[40:43], v[56:59], a[0:3], v[92:95]
    ds_read_b64_tr_b16 v[48:49], v107 offset:26624
    v_fma_f32 v72, v16, s80, -0.5
    v_exp_f32 v72, v72
    v_mfma_f32_16x16x32_bf16 v[40:43], v[60:63], a[8:11], v[40:43]
    ds_read_b64_tr_b16 v[50:51], v107 offset:27136
    v_fma_f32 v73, v17, s80, -0.5
    v_mfma_f32_16x16x32_bf16 v[44:47], v[56:59], a[4:7], v[92:95]
    ds_read_b64_tr_b16 v[52:53], v107 offset:30720
    v_add_f32 v72, s81, v72
    v_exp_f32 v73, v73
    v_mfma_f32_16x16x32_bf16 v[44:47], v[60:63], a[12:15], v[44:47]
    ds_read_b64_tr_b16 v[54:55], v107 offset:31232
    v_fma_f32 v72, v72, v72, 0.5
    s_waitcnt lgkmcnt(4)
    v_mfma_f32_16x16x32_bf16 v[32:35], v[64:67], a[16:19], v[32:35]
    v_fma_f32 v74, v18, s80, -0.5
    v_rcp_f32 v72, v72
    s_add_u32 m0, s29, 75264
    v_mfma_f32_16x16x32_bf16 v[32:35], v[68:71], a[24:27], v[32:35]
    buffer_load_dwordx4 v2, s[12:15], 0 offen offset:512 lds
    v_add_f32 v73, s81, v73
    s_waitcnt vmcnt(8) lgkmcnt(0)
    s_barrier
    v_mfma_f32_16x16x32_bf16 v[36:39], v[64:67], a[20:23], v[36:39]
    ds_read_b64_tr_b16 v[56:57], v108 offset:2048
    ds_read_b64_tr_b16 v[58:59], v108 offset:2560
    v_fma_f32 v72, -v16, v72, v16
    v_exp_f32 v74, v74
    v_mfma_f32_16x16x32_bf16 v[36:39], v[68:71], a[28:31], v[36:39]
    ds_read_b64_tr_b16 v[60:61], v108 offset:6144
    v_fma_f32 v73, v73, v73, 0.5
    v_mfma_f32_16x16x32_bf16 v[40:43], v[48:51], a[16:19], v[40:43]
    ds_read_b64_tr_b16 v[62:63], v108 offset:6656
    ds_read_b64_tr_b16 v[64:65], v109 offset:2048
    v_fma_f32 v75, v19, s80, -0.5
    v_rcp_f32 v73, v73
    s_add_u32 m0, s29, 83456
    v_mfma_f32_16x16x32_bf16 v[40:43], v[52:55], a[24:27], v[40:43]
    ds_read_b64_tr_b16 v[66:67], v109 offset:2560
    buffer_load_dwordx4 v2, s[12:15], s57 offen offset:512 lds
    v_add_f32 v74, s81, v74
    v_mfma_f32_16x16x32_bf16 v[44:47], v[48:51], a[20:23], v[44:47]
    ds_read_b64_tr_b16 v[68:69], v109 offset:6144
    v_fma_f32 v73, -v17, v73, v17
    v_exp_f32 v75, v75
    v_mfma_f32_16x16x32_bf16 v[44:47], v[52:55], a[28:31], v[44:47]
    ds_read_b64_tr_b16 v[70:71], v109 offset:6656
    v_fma_f32 v74, v74, v74, 0.5
    s_waitcnt lgkmcnt(4)
    v_mfma_f32_16x16x32_bf16 v[32:35], v[56:59], a[32:35], v[32:35]
    ds_read_b64_tr_b16 v[48:49], v104 offset:51200
    v_cvt_pk_bf16_f32 v80, v72, v73
    v_fma_f32 v72, v24, s80, -0.5
    s_add_u32 m0, s29, 17920
    v_mfma_f32_16x16x32_bf16 v[32:35], v[60:63], a[40:43], v[32:35]
    ds_read_b64_tr_b16 v[50:51], v104 offset:51712
    buffer_load_dwordx4 v2, s[12:15], s58 offen offset:512 lds
    v_rcp_f32 v74, v74
    v_mfma_f32_16x16x32_bf16 v[36:39], v[56:59], a[36:39], v[36:39]
    ds_read_b64_tr_b16 v[52:53], v104 offset:55296
    v_add_f32 v75, s81, v75
    v_fma_f32 v74, -v18, v74, v18
    v_mfma_f32_16x16x32_bf16 v[36:39], v[60:63], a[44:47], v[36:39]
    ds_read_b64_tr_b16 v[54:55], v104 offset:55808
    v_exp_f32 v72, v72
    s_waitcnt lgkmcnt(4)
    v_mfma_f32_16x16x32_bf16 v[40:43], v[64:67], a[32:35], v[40:43]
    ds_read_b64_tr_b16 v[56:57], v105 offset:51200
    v_fma_f32 v75, v75, v75, 0.5
    v_fma_f32 v73, v25, s80, -0.5
    s_add_u32 m0, s29, 26112
    v_mfma_f32_16x16x32_bf16 v[40:43], v[68:71], a[40:43], v[40:43]
    ds_read_b64_tr_b16 v[58:59], v105 offset:51712
    buffer_load_dwordx4 v2, s[12:15], s59 offen offset:512 lds
    v_rcp_f32 v75, v75
    v_add_f32 v72, s81, v72
    v_mfma_f32_16x16x32_bf16 v[44:47], v[64:67], a[36:39], v[44:47]
    ds_read_b64_tr_b16 v[60:61], v105 offset:55296
    v_fma_f32 v75, -v19, v75, v19
    v_exp_f32 v73, v73
    v_mfma_f32_16x16x32_bf16 v[44:47], v[68:71], a[44:47], v[44:47]
    ds_read_b64_tr_b16 v[62:63], v105 offset:55808
    v_fma_f32 v72, v72, v72, 0.5
    s_waitcnt lgkmcnt(4)
    v_mfma_f32_16x16x32_bf16 v[32:35], v[48:51], a[48:51], v[32:35]
    ds_read_b64_tr_b16 v[64:65], v104 offset:2048
    v_cvt_pk_bf16_f32 v81, v74, v75
    v_fma_f32 v74, v26, s80, -0.5
    s_add_u32 m0, s29, 91648
    v_mfma_f32_16x16x32_bf16 v[32:35], v[52:55], a[56:59], v[32:35]
    ds_read_b64_tr_b16 v[66:67], v104 offset:2560
    buffer_load_dwordx4 v2, s[12:15], s60 offen offset:512 lds
    v_rcp_f32 v72, v72
    v_mfma_f32_16x16x32_bf16 v[36:39], v[48:51], a[52:55], v[36:39]
    ds_read_b64_tr_b16 v[68:69], v104 offset:6144
    v_add_f32 v73, s81, v73
    v_fma_f32 v72, -v24, v72, v24
    v_mfma_f32_16x16x32_bf16 v[36:39], v[52:55], a[60:63], v[36:39]
    ds_read_b64_tr_b16 v[70:71], v104 offset:6656
    v_exp_f32 v74, v74
    s_waitcnt lgkmcnt(4)
    v_mfma_f32_16x16x32_bf16 v[40:43], v[56:59], a[48:51], v[40:43]
    ds_read_b64_tr_b16 v[48:49], v105 offset:2048
    v_fma_f32 v73, v73, v73, 0.5
    v_fma_f32 v75, v27, s80, -0.5
    s_add_u32 m0, s29, 148992
    v_mfma_f32_16x16x32_bf16 v[40:43], v[60:63], a[56:59], v[40:43]
    ds_read_b64_tr_b16 v[50:51], v105 offset:2560
    buffer_load_dwordx4 v2, s[12:15], s61 offen offset:512 lds
    v_rcp_f32 v73, v73
    v_mfma_f32_16x16x32_bf16 v[44:47], v[56:59], a[52:55], v[44:47]
    ds_read_b64_tr_b16 v[52:53], v105 offset:6144
    v_add_f32 v74, s81, v74
    v_fma_f32 v73, -v25, v73, v25
    v_mfma_f32_16x16x32_bf16 v[44:47], v[60:63], a[60:63], v[44:47]
    ds_read_b64_tr_b16 v[54:55], v105 offset:6656
    v_exp_f32 v75, v75
    s_waitcnt lgkmcnt(4)
    v_mfma_f32_16x16x32_bf16 v[32:35], v[64:67], a[64:67], v[32:35]
    ds_read_b64_tr_b16 v[56:57], v104 offset:59392
    v_fma_f32 v74, v74, v74, 0.5
    v_cvt_pk_bf16_f32 v82, v72, v73
    s_add_u32 m0, s29, 34304
    v_mfma_f32_16x16x32_bf16 v[32:35], v[68:71], a[72:75], v[32:35]
    ds_read_b64_tr_b16 v[58:59], v104 offset:59904
    buffer_load_dwordx4 v2, s[12:15], s62 offen offset:512 lds
    v_fma_f32 v72, v20, s80, -0.5
    v_mfma_f32_16x16x32_bf16 v[36:39], v[64:67], a[68:71], v[36:39]
    ds_read_b64_tr_b16 v[60:61], v104 offset:63488
    v_rcp_f32 v74, v74
    v_add_f32 v75, s81, v75
    v_mfma_f32_16x16x32_bf16 v[36:39], v[68:71], a[76:79], v[36:39]
    ds_read_b64_tr_b16 v[62:63], v104 offset:64000
    v_fma_f32 v74, -v26, v74, v26
    s_waitcnt lgkmcnt(4)
    v_mfma_f32_16x16x32_bf16 v[40:43], v[48:51], a[64:67], v[40:43]
    ds_read_b64_tr_b16 v[64:65], v105 offset:59392
    v_exp_f32 v72, v72
    v_fma_f32 v75, v75, v75, 0.5
    v_mfma_f32_16x16x32_bf16 v[40:43], v[52:55], a[72:75], v[40:43]
    ds_read_b64_tr_b16 v[66:67], v105 offset:59904
    v_fma_f32 v73, v21, s80, -0.5
    v_mfma_f32_16x16x32_bf16 v[44:47], v[48:51], a[68:71], v[44:47]
    ds_read_b64_tr_b16 v[68:69], v105 offset:63488
    v_rcp_f32 v75, v75
    v_add_f32 v72, s81, v72
    v_mfma_f32_16x16x32_bf16 v[44:47], v[52:55], a[76:79], v[44:47]
    ds_read_b64_tr_b16 v[70:71], v105 offset:64000
    v_fma_f32 v75, -v27, v75, v27
    v_exp_f32 v73, v73
    s_waitcnt lgkmcnt(4)
    v_mfma_f32_16x16x32_bf16 v[32:35], v[56:59], a[80:83], v[32:35]
    v_fma_f32 v72, v72, v72, 0.5
    v_cvt_pk_bf16_f32 v83, v74, v75
    v_mfma_f32_16x16x32_bf16 v[32:35], v[60:63], a[88:91], v[32:35]
    v_fma_f32 v74, v22, s80, -0.5
    s_waitcnt vmcnt(6) lgkmcnt(0)
    s_barrier
    s_cmp_eq_u32 s28, 0
    s_cbranch_scc1 L_hp1_o
L_hp1:
    v_mfma_f32_16x16x32_bf16 v[36:39], v[56:59], a[84:87], v[36:39]
    ds_read_b64_tr_b16 v[48:49], v108 offset:10240
    ds_read_b64_tr_b16 v[50:51], v108 offset:10752
    v_rcp_f32 v72, v72
    s_mov_b32 s33, 32768
    s_add_u32 m0, s29, 1536
    v_mfma_f32_16x16x32_bf16 v[36:39], v[60:63], a[92:95], v[36:39]
    ds_read_b64_tr_b16 v[52:53], v108 offset:14336
    buffer_load_dwordx4 v2, s[12:15], s63 offen offset:512 lds
    buffer_store_dwordx4 v[80:83], v5, s[20:23], s33 offen offset:0 sc1
    v_add_f32 v73, s81, v73
    v_mfma_f32_16x16x32_bf16 v[40:43], v[64:67], a[80:83], v[40:43]
    ds_read_b64_tr_b16 v[54:55], v108 offset:14848
    ds_read_b64_tr_b16 v[56:57], v109 offset:10240
    v_fma_f32 v72, -v20, v72, v20
    v_exp_f32 v74, v74
    v_mfma_f32_16x16x32_bf16 v[40:43], v[68:71], a[88:91], v[40:43]
    ds_read_b64_tr_b16 v[58:59], v109 offset:10752
    v_fma_f32 v73, v73, v73, 0.5
    s_mov_b32 s84, 147456
    s_mov_b32 m0, 157696
    s_mov_b64 exec, 0x1ff
    buffer_load_dword v14, s[16:19], s84 offen offset:0  lds
    s_mov_b64 exec, -1
    s_mov_b32 s84, 294912
    s_mov_b32 m0, 157696
    s_mov_b64 exec, 0x1ff
    buffer_load_dword v14, s[16:19], s84 offen offset:0  lds
    s_mov_b64 exec, -1
    v_mfma_f32_16x16x32_bf16 v[44:47], v[64:67], a[84:87], v[44:47]
    ds_read_b64_tr_b16 v[60:61], v109 offset:14336
    v_fma_f32 v75, v23, s80, -0.5
    v_rcp_f32 v73, v73
    v_mfma_f32_16x16x32_bf16 v[44:47], v[68:71], a[92:95], v[44:47]
    ds_read_b64_tr_b16 v[62:63], v109 offset:14848
    v_add_f32 v74, s81, v74
    s_waitcnt lgkmcnt(4)
    v_mfma_f32_16x16x32_bf16 v[32:35], v[48:51], a[96:99], v[32:35]
    ds_read_b64_tr_b16 v[64:65], v106 offset:2048
    v_fma_f32 v73, -v21, v73, v21
    v_exp_f32 v75, v75
    v_mfma_f32_16x16x32_bf16 v[32:35], v[52:55], a[104:107], v[32:35]
    ds_read_b64_tr_b16 v[66:67], v106 offset:2560
    v_fma_f32 v74, v74, v74, 0.5
    v_mfma_f32_16x16x32_bf16 v[36:39], v[48:51], a[100:103], v[36:39]
    ds_read_b64_tr_b16 v[68:69], v106 offset:6144
    v_cvt_pk_bf16_f32 v84, v72, v73
    v_fma_f32 v72, v28, s80, -0.5
    v_mfma_f32_16x16x32_bf16 v[36:39], v[52:55], a[108:111], v[36:39]
    ds_read_b64_tr_b16 v[70:71], v106 offset:6656
    v_rcp_f32 v74, v74
    s_waitcnt lgkmcnt(4)
    v_mfma_f32_16x16x32_bf16 v[40:43], v[56:59], a[96:99], v[40:43]
    ds_read_b64_tr_b16 v[48:49], v107 offset:2048
    v_add_f32 v75, s81, v75
    v_fma_f32 v74, -v22, v74, v22
    v_mfma_f32_16x16x32_bf16 v[40:43], v[60:63], a[104:107], v[40:43]
    ds_read_b64_tr_b16 v[50:51], v107 offset:2560
    v_exp_f32 v72, v72
    v_mfma_f32_16x16x32_bf16 v[44:47], v[56:59], a[100:103], v[44:47]
    ds_read_b64_tr_b16 v[52:53], v107 offset:6144
    v_fma_f32 v75, v75, v75, 0.5
    v_fma_f32 v73, v29, s80, -0.5
    v_mfma_f32_16x16x32_bf16 v[44:47], v[60:63], a[108:111], v[44:47]
    ds_read_b64_tr_b16 v[54:55], v107 offset:6656
    v_rcp_f32 v75, v75
    v_add_f32 v72, s81, v72
    s_waitcnt lgkmcnt(4)
    v_mfma_f32_16x16x32_bf16 v[32:35], v[64:67], a[112:115], v[32:35]
    ds_read_b64_tr_b16 v[56:57], v104 offset:10240
    v_fma_f32 v75, -v23, v75, v23
    v_exp_f32 v73, v73
    v_mfma_f32_16x16x32_bf16 v[32:35], v[68:71], a[120:123], v[32:35]
    ds_read_b64_tr_b16 v[58:59], v104 offset:10752
    v_fma_f32 v72, v72, v72, 0.5
    v_mfma_f32_16x16x32_bf16 v[36:39], v[64:67], a[116:119], v[36:39]
    ds_read_b64_tr_b16 v[60:61], v104 offset:14336
    v_cvt_pk_bf16_f32 v85, v74, v75
    v_fma_f32 v74, v30, s80, -0.5
    v_mfma_f32_16x16x32_bf16 v[36:39], v[68:71], a[124:127], v[36:39]
    ds_read_b64_tr_b16 v[62:63], v104 offset:14848
    v_rcp_f32 v72, v72
    s_waitcnt lgkmcnt(4)
    v_mfma_f32_16x16x32_bf16 v[40:43], v[48:51], a[112:115], v[40:43]
    ds_read_b64_tr_b16 v[64:65], v105 offset:10240
    v_add_f32 v73, s81, v73
    v_fma_f32 v72, -v28, v72, v28
    v_exp_f32 v74, v74
    v_mfma_f32_16x16x32_bf16 v[40:43], v[52:55], a[120:123], v[40:43]
    ds_read_b64_tr_b16 v[66:67], v105 offset:10752
    ds_read_b128 v[88:91], v10 offset:1024
    ds_read_b128 v[92:95], v10 offset:1088
    v_mfma_f32_16x16x32_bf16 v[44:47], v[48:51], a[116:119], v[44:47]
    ds_read_b64_tr_b16 v[68:69], v105 offset:14336
    v_fma_f32 v73, v73, v73, 0.5
    v_fma_f32 v75, v31, s80, -0.5
    v_mfma_f32_16x16x32_bf16 v[44:47], v[52:55], a[124:127], v[44:47]
    ds_read_b64_tr_b16 v[70:71], v105 offset:14848
    v_rcp_f32 v73, v73
    s_waitcnt lgkmcnt(6)
    v_mfma_f32_16x16x32_bf16 v[32:35], v[56:59], a[128:131], v[32:35]
    ds_read_b64_tr_b16 v[48:49], v106 offset:10240
    v_add_f32 v74, s81, v74
    v_fma_f32 v73, -v29, v73, v29
    v_mfma_f32_16x16x32_bf16 v[32:35], v[60:63], a[136:139], v[32:35]
    ds_read_b64_tr_b16 v[50:51], v106 offset:10752
    v_exp_f32 v75, v75
    v_mfma_f32_16x16x32_bf16 v[36:39], v[56:59], a[132:135], v[36:39]
    ds_read_b64_tr_b16 v[52:53], v106 offset:14336
    v_fma_f32 v74, v74, v74, 0.5
    v_cvt_pk_bf16_f32 v86, v72, v73
    v_mfma_f32_16x16x32_bf16 v[36:39], v[60:63], a[140:143], v[36:39]
    ds_read_b64_tr_b16 v[54:55], v106 offset:14848
    v_rcp_f32 v74, v74
    s_waitcnt lgkmcnt(4)
    v_mfma_f32_16x16x32_bf16 v[40:43], v[64:67], a[128:131], v[40:43]
    ds_read_b64_tr_b16 v[56:57], v107 offset:10240
    v_add_f32 v75, s81, v75
    v_fma_f32 v74, -v30, v74, v30
    v_mfma_f32_16x16x32_bf16 v[40:43], v[68:71], a[136:139], v[40:43]
    ds_read_b64_tr_b16 v[58:59], v107 offset:10752
    v_fma_f32 v75, v75, v75, 0.5
    v_mfma_f32_16x16x32_bf16 v[44:47], v[64:67], a[132:135], v[44:47]
    ds_read_b64_tr_b16 v[60:61], v107 offset:14336
    v_rcp_f32 v75, v75
    s_nop 0
    v_fma_f32 v75, -v31, v75, v31
    v_mfma_f32_16x16x32_bf16 v[44:47], v[68:71], a[140:143], v[44:47]
    ds_read_b64_tr_b16 v[62:63], v107 offset:14848
    v_cvt_pk_bf16_f32 v87, v74, v75
    buffer_store_dwordx4 v[84:87], v5, s[20:23], s33 offen offset:1024 sc1
    s_cmp_eq_u32 s28, 7
    s_cbranch_scc1 L_inii_o
L_inii:
    s_waitcnt lgkmcnt(4)
    v_mfma_f32_16x16x32_bf16 v[16:19], v[48:51], a[0:3], v[88:91]
    s_add_u32 m0, s29, 42496
    v_mfma_f32_16x16x32_bf16 v[16:19], v[52:55], a[8:11], v[16:19]
    buffer_load_dwordx4 v2, s[12:15], s64 offen offset:512 lds
    s_waitcnt vmcnt(8) lgkmcnt(0)
    s_barrier
    v_mfma_f32_16x16x32_bf16 v[20:23], v[48:51], a[4:7], v[88:91]
    ds_read_b64_tr_b16 v[64:65], v106 offset:18432
    ds_read_b64_tr_b16 v[66:67], v106 offset:18944
    v_mfma_f32_16x16x32_bf16 v[20:23], v[52:55], a[12:15], v[20:23]
    ds_read_b64_tr_b16 v[68:69], v106 offset:22528
    v_mfma_f32_16x16x32_bf16 v[24:27], v[56:59], a[0:3], v[92:95]
    ds_read_b64_tr_b16 v[70:71], v106 offset:23040
    ds_read_b64_tr_b16 v[48:49], v107 offset:18432
    v_fma_f32 v72, v32, s80, -0.5
    v_exp_f32 v72, v72
    s_add_u32 m0, s29, 132480
    v_mfma_f32_16x16x32_bf16 v[24:27], v[60:63], a[8:11], v[24:27]
    ds_read_b64_tr_b16 v[50:51], v107 offset:18944
    buffer_load_dwordx4 v2, s[12:15], 0 offen offset:640 lds
    v_fma_f32 v73, v33, s80, -0.5
    v_mfma_f32_16x16x32_bf16 v[28:31], v[56:59], a[4:7], v[92:95]
    ds_read_b64_tr_b16 v[52:53], v107 offset:22528
    v_add_f32 v72, s81, v72
    v_exp_f32 v73, v73
    v_mfma_f32_16x16x32_bf16 v[28:31], v[60:63], a[12:15], v[28:31]
    ds_read_b64_tr_b16 v[54:55], v107 offset:23040
    v_fma_f32 v72, v72, v72, 0.5
    s_waitcnt lgkmcnt(4)
    v_mfma_f32_16x16x32_bf16 v[16:19], v[64:67], a[16:19], v[16:19]
    ds_read_b64_tr_b16 v[56:57], v104 offset:18432
    v_fma_f32 v74, v34, s80, -0.5
    v_rcp_f32 v72, v72
    s_add_u32 m0, s29, 50560
    v_mfma_f32_16x16x32_bf16 v[16:19], v[68:71], a[24:27], v[16:19]
    ds_read_b64_tr_b16 v[58:59], v104 offset:18944
    buffer_load_dwordx4 v2, s[12:15], s57 offen offset:640 lds
    v_add_f32 v73, s81, v73
    v_mfma_f32_16x16x32_bf16 v[20:23], v[64:67], a[20:23], v[20:23]
    ds_read_b64_tr_b16 v[60:61], v104 offset:22528
    v_fma_f32 v72, -v32, v72, v32
    v_exp_f32 v74, v74
    v_mfma_f32_16x16x32_bf16 v[20:23], v[68:71], a[28:31], v[20:23]
    ds_read_b64_tr_b16 v[62:63], v104 offset:23040
    v_fma_f32 v73, v73, v73, 0.5
    s_waitcnt lgkmcnt(4)
    v_mfma_f32_16x16x32_bf16 v[24:27], v[48:51], a[16:19], v[24:27]
    ds_read_b64_tr_b16 v[64:65], v105 offset:18432
    v_fma_f32 v75, v35, s80, -0.5
    v_rcp_f32 v73, v73
    s_add_u32 m0, s29, 9600
    v_mfma_f32_16x16x32_bf16 v[24:27], v[52:55], a[24:27], v[24:27]
    ds_read_b64_tr_b16 v[66:67], v105 offset:18944
    buffer_load_dwordx4 v2, s[12:15], s58 offen offset:640 lds
    v_add_f32 v74, s81, v74
    v_mfma_f32_16x16x32_bf16 v[28:31], v[48:51], a[20:23], v[28:31]
    ds_read_b64_tr_b16 v[68:69], v105 offset:22528
    v_fma_f32 v73, -v33, v73, v33
    v_exp_f32 v75, v75
    v_mfma_f32_16x16x32_bf16 v[28:31], v[52:55], a[28:31], v[28:31]
    ds_read_b64_tr_b16 v[70:71], v105 offset:23040
    v_fma_f32 v74, v74, v74, 0.5
    s_waitcnt lgkmcnt(4)
    v_mfma_f32_16x16x32_bf16 v[16:19], v[56:59], a[32:35], v[16:19]
    ds_read_b64_tr_b16 v[48:49], v104 offset:26624
    v_cvt_pk_bf16_f32 v80, v72, v73
    v_fma_f32 v72, v40, s80, -0.5
    s_add_u32 m0, s29, 58752
    v_mfma_f32_16x16x32_bf16 v[16:19], v[60:63], a[40:43], v[16:19]
    ds_read_b64_tr_b16 v[50:51], v104 offset:27136
    buffer_load_dwordx4 v2, s[12:15], s59 offen offset:640 lds
    v_rcp_f32 v74, v74
    v_mfma_f32_16x16x32_bf16 v[20:23], v[56:59], a[36:39], v[20:23]
    ds_read_b64_tr_b16 v[52:53], v104 offset:30720
    v_add_f32 v75, s81, v75
    v_fma_f32 v74, -v34, v74, v34
    v_mfma_f32_16x16x32_bf16 v[20:23], v[60:63], a[44:47], v[20:23]
    ds_read_b64_tr_b16 v[54:55], v104 offset:31232
    v_exp_f32 v72, v72
    s_waitcnt lgkmcnt(4)
    v_mfma_f32_16x16x32_bf16 v[24:27], v[64:67], a[32:35], v[24:27]
    ds_read_b64_tr_b16 v[56:57], v105 offset:26624
    v_fma_f32 v75, v75, v75, 0.5
    v_fma_f32 v73, v41, s80, -0.5
    s_add_u32 m0, s29, 140672
    v_mfma_f32_16x16x32_bf16 v[24:27], v[68:71], a[40:43], v[24:27]
    ds_read_b64_tr_b16 v[58:59], v105 offset:27136
    buffer_load_dwordx4 v2, s[12:15], s60 offen offset:640 lds
    v_rcp_f32 v75, v75
    v_add_f32 v72, s81, v72
    v_mfma_f32_16x16x32_bf16 v[28:31], v[64:67], a[36:39], v[28:31]
    ds_read_b64_tr_b16 v[60:61], v105 offset:30720
    v_fma_f32 v75, -v35, v75, v35
    v_exp_f32 v73, v73
    v_mfma_f32_16x16x32_bf16 v[28:31], v[68:71], a[44:47], v[28:31]
    ds_read_b64_tr_b16 v[62:63], v105 offset:31232
    v_fma_f32 v72, v72, v72, 0.5
    s_waitcnt lgkmcnt(4)
    v_mfma_f32_16x16x32_bf16 v[16:19], v[48:51], a[48:51], v[16:19]
    ds_read_b64_tr_b16 v[64:65], v106 offset:26624
    v_cvt_pk_bf16_f32 v81, v74, v75
    v_fma_f32 v74, v42, s80, -0.5
    v_mfma_f32_16x16x32_bf16 v[16:19], v[52:55], a[56:59], v[16:19]
    ds_read_b64_tr_b16 v[66:67], v106 offset:27136
    v_rcp_f32 v72, v72
    v_mfma_f32_16x16x32_bf16 v[20:23], v[48:51], a[52:55], v[20:23]
    ds_read_b64_tr_b16 v[68:69], v106 offset:30720
    v_add_f32 v73, s81, v73
    v_fma_f32 v72, -v40, v72, v40
    v_mfma_f32_16x16x32_bf16 v[20:23], v[52:55], a[60:63], v[20:23]
    ds_read_b64_tr_b16 v[70:71], v106 offset:31232
    v_exp_f32 v74, v74
    s_waitcnt lgkmcnt(4)
    v_mfma_f32_16x16x32_bf16 v[24:27], v[56:59], a[48:51], v[24:27]
    ds_read_b64_tr_b16 v[48:49], v107 offset:26624
    v_fma_f32 v73, v73, v73, 0.5
    v_fma_f32 v75, v43, s80, -0.5
    v_mfma_f32_16x16x32_bf16 v[24:27], v[60:63], a[56:59], v[24:27]
    ds_read_b64_tr_b16 v[50:51], v107 offset:27136
    v_rcp_f32 v73, v73
    v_mfma_f32_16x16x32_bf16 v[28:31], v[56:59], a[52:55], v[28:31]
    ds_read_b64_tr_b16 v[52:53], v107 offset:30720
    v_add_f32 v74, s81, v74
    v_fma_f32 v73, -v41, v73, v41
    v_mfma_f32_16x16x32_bf16 v[28:31], v[60:63], a[60:63], v[28:31]
    ds_read_b64_tr_b16 v[54:55], v107 offset:31232
    v_exp_f32 v75, v75
    s_waitcnt lgkmcnt(4)
    v_mfma_f32_16x16x32_bf16 v[16:19], v[64:67], a[64:67], v[16:19]
    v_fma_f32 v74, v74, v74, 0.5
    v_cvt_pk_bf16_f32 v82, v72, v73
    v_mfma_f32_16x16x32_bf16 v[16:19], v[68:71], a[72:75], v[16:19]
    v_fma_f32 v72, v36, s80, -0.5
    s_cmp_eq_u32 s28, 7
    s_cbranch_scc1 L_inic_o
L_inic:
    s_waitcnt vmcnt(5) lgkmcnt(0)
    s_barrier
    v_mfma_f32_16x16x32_bf16 v[20:23], v[64:67], a[68:71], v[20:23]
    ds_read_b64_tr_b16 v[56:57], v108 offset:18432
    ds_read_b64_tr_b16 v[58:59], v108 offset:18944
    v_rcp_f32 v74, v74
    v_add_f32 v75, s81, v75
    s_add_u32 m0, s29, 17792
    v_mfma_f32_16x16x32_bf16 v[20:23], v[68:71], a[76:79], v[20:23]
    ds_read_b64_tr_b16 v[60:61], v108 offset:22528
    buffer_load_dwordx4 v2, s[12:15], s61 offen offset:640 lds
    v_fma_f32 v74, -v42, v74, v42
    s_cmp_eq_u32 s28, 7
    s_cbranch_scc1 L_hc1i_o
L_hc1i:
    v_mfma_f32_16x16x32_bf16 v[24:27], v[48:51], a[64:67], v[24:27]
    ds_read_b64_tr_b16 v[62:63], v108 offset:23040
    ds_read_b64_tr_b16 v[64:65], v109 offset:18432
    v_exp_f32 v72, v72
    v_fma_f32 v75, v75, v75, 0.5
    v_mfma_f32_16x16x32_bf16 v[24:27], v[52:55], a[72:75], v[24:27]
    ds_read_b64_tr_b16 v[66:67], v109 offset:18944
    v_fma_f32 v73, v37, s80, -0.5
    v_mfma_f32_16x16x32_bf16 v[28:31], v[48:51], a[68:71], v[28:31]
    ds_read_b64_tr_b16 v[68:69], v109 offset:22528
    v_rcp_f32 v75, v75
    v_add_f32 v72, s81, v72
    s_add_u32 m0, s29, 25984
    v_mfma_f32_16x16x32_bf16 v[28:31], v[52:55], a[76:79], v[28:31]
    ds_read_b64_tr_b16 v[70:71], v109 offset:23040
    buffer_load_dwordx4 v2, s[12:15], s62 offen offset:640 lds
    v_fma_f32 v75, -v43, v75, v43
    v_exp_f32 v73, v73
    s_waitcnt lgkmcnt(4)
    v_mfma_f32_16x16x32_bf16 v[16:19], v[56:59], a[80:83], v[16:19]
    ds_read_b64_tr_b16 v[48:49], v104 offset:34816
    v_fma_f32 v72, v72, v72, 0.5
    v_cvt_pk_bf16_f32 v83, v74, v75
    v_mfma_f32_16x16x32_bf16 v[16:19], v[60:63], a[88:91], v[16:19]
    ds_read_b64_tr_b16 v[50:51], v104 offset:35328
    v_fma_f32 v74, v38, s80, -0.5
    v_mfma_f32_16x16x32_bf16 v[20:23], v[56:59], a[84:87], v[20:23]
    ds_read_b64_tr_b16 v[52:53], v104 offset:38912
    v_rcp_f32 v72, v72
    s_mov_b32 s33, 49152
    s_add_u32 m0, s29, 66944
    v_mfma_f32_16x16x32_bf16 v[20:23], v[60:63], a[92:95], v[20:23]
    ds_read_b64_tr_b16 v[54:55], v104 offset:39424
    buffer_load_dwordx4 v2, s[12:15], s63 offen offset:640 lds
    buffer_store_dwordx4 v[80:83], v5, s[20:23], s33 offen offset:0 sc1
    v_add_f32 v73, s81, v73
    s_waitcnt lgkmcnt(4)
    v_mfma_f32_16x16x32_bf16 v[24:27], v[64:67], a[80:83], v[24:27]
    ds_read_b64_tr_b16 v[56:57], v105 offset:34816
    v_fma_f32 v72, -v36, v72, v36
    v_exp_f32 v74, v74
    v_mfma_f32_16x16x32_bf16 v[24:27], v[68:71], a[88:91], v[24:27]
    ds_read_b64_tr_b16 v[58:59], v105 offset:35328
    v_fma_f32 v73, v73, v73, 0.5
    v_mfma_f32_16x16x32_bf16 v[28:31], v[64:67], a[84:87], v[28:31]
    ds_read_b64_tr_b16 v[60:61], v105 offset:38912
    v_fma_f32 v75, v39, s80, -0.5
    v_rcp_f32 v73, v73
    s_add_u32 m0, s29, 75136
    v_mfma_f32_16x16x32_bf16 v[28:31], v[68:71], a[92:95], v[28:31]
    ds_read_b64_tr_b16 v[62:63], v105 offset:39424
    buffer_load_dwordx4 v2, s[12:15], s64 offen offset:640 lds
    v_add_f32 v74, s81, v74
    s_waitcnt lgkmcnt(4)
    v_mfma_f32_16x16x32_bf16 v[16:19], v[48:51], a[96:99], v[16:19]
    ds_read_b64_tr_b16 v[64:65], v104 offset:2048
    v_fma_f32 v73, -v37, v73, v37
    v_exp_f32 v75, v75
    v_mfma_f32_16x16x32_bf16 v[16:19], v[52:55], a[104:107], v[16:19]
    ds_read_b64_tr_b16 v[66:67], v104 offset:2560
    v_fma_f32 v74, v74, v74, 0.5
    v_mfma_f32_16x16x32_bf16 v[20:23], v[48:51], a[100:103], v[20:23]
    ds_read_b64_tr_b16 v[68:69], v104 offset:6144
    v_cvt_pk_bf16_f32 v84, v72, v73
    v_fma_f32 v72, v44, s80, -0.5
    v_mfma_f32_16x16x32_bf16 v[20:23], v[52:55], a[108:111], v[20:23]
    ds_read_b64_tr_b16 v[70:71], v104 offset:6656
    v_rcp_f32 v74, v74
    s_waitcnt lgkmcnt(4)
    v_mfma_f32_16x16x32_bf16 v[24:27], v[56:59], a[96:99], v[24:27]
    ds_read_b64_tr_b16 v[48:49], v105 offset:2048
    v_add_f32 v75, s81, v75
    v_fma_f32 v74, -v38, v74, v38
    v_mfma_f32_16x16x32_bf16 v[24:27], v[60:63], a[104:107], v[24:27]
    ds_read_b64_tr_b16 v[50:51], v105 offset:2560
    v_exp_f32 v72, v72
    v_mfma_f32_16x16x32_bf16 v[28:31], v[56:59], a[100:103], v[28:31]
    ds_read_b64_tr_b16 v[52:53], v105 offset:6144
    v_fma_f32 v75, v75, v75, 0.5
    v_fma_f32 v73, v45, s80, -0.5
    v_mfma_f32_16x16x32_bf16 v[28:31], v[60:63], a[108:111], v[28:31]
    ds_read_b64_tr_b16 v[54:55], v105 offset:6656
    v_rcp_f32 v75, v75
    v_add_f32 v72, s81, v72
    s_waitcnt lgkmcnt(4)
    v_mfma_f32_16x16x32_bf16 v[16:19], v[64:67], a[112:115], v[16:19]
    ds_read_b64_tr_b16 v[56:57], v104 offset:43008
    v_fma_f32 v75, -v39, v75, v39
    v_exp_f32 v73, v73
    v_mfma_f32_16x16x32_bf16 v[16:19], v[68:71], a[120:123], v[16:19]
    ds_read_b64_tr_b16 v[58:59], v104 offset:43520
    v_fma_f32 v72, v72, v72, 0.5
    v_mfma_f32_16x16x32_bf16 v[20:23], v[64:67], a[116:119], v[20:23]
    ds_read_b64_tr_b16 v[60:61], v104 offset:47104
    v_cvt_pk_bf16_f32 v85, v74, v75
    v_fma_f32 v74, v46, s80, -0.5
    v_mfma_f32_16x16x32_bf16 v[20:23], v[68:71], a[124:127], v[20:23]
    ds_read_b64_tr_b16 v[62:63], v104 offset:47616
    v_rcp_f32 v72, v72
    s_waitcnt lgkmcnt(4)
    v_mfma_f32_16x16x32_bf16 v[24:27], v[48:51], a[112:115], v[24:27]
    ds_read_b64_tr_b16 v[64:65], v105 offset:43008
    v_add_f32 v73, s81, v73
    v_fma_f32 v72, -v44, v72, v44
    v_exp_f32 v74, v74
    v_mfma_f32_16x16x32_bf16 v[24:27], v[52:55], a[120:123], v[24:27]
    ds_read_b64_tr_b16 v[66:67], v105 offset:43520
    ds_read_b128 v[88:91], v10 offset:1280
    ds_read_b128 v[92:95], v10 offset:1344
    v_mfma_f32_16x16x32_bf16 v[28:31], v[48:51], a[116:119], v[28:31]
    ds_read_b64_tr_b16 v[68:69], v105 offset:47104
    v_fma_f32 v73, v73, v73, 0.5
    v_fma_f32 v75, v47, s80, -0.5
    v_mfma_f32_16x16x32_bf16 v[28:31], v[52:55], a[124:127], v[28:31]
    ds_read_b64_tr_b16 v[70:71], v105 offset:47616
    v_rcp_f32 v73, v73
    s_waitcnt lgkmcnt(6)
    v_mfma_f32_16x16x32_bf16 v[16:19], v[56:59], a[128:131], v[16:19]
    v_add_f32 v74, s81, v74
    v_fma_f32 v73, -v45, v73, v45
    v_mfma_f32_16x16x32_bf16 v[16:19], v[60:63], a[136:139], v[16:19]
    v_exp_f32 v75, v75
    s_cmp_eq_u32 s28, 7
    s_cbranch_scc1 L_hc1c_o
L_hc1c:
    s_waitcnt vmcnt(5) lgkmcnt(0)
    s_barrier
    v_mfma_f32_16x16x32_bf16 v[20:23], v[56:59], a[132:135], v[20:23]
    ds_read_b64_tr_b16 v[48:49], v108 offset:2048
    ds_read_b64_tr_b16 v[50:51], v108 offset:2560
    v_fma_f32 v74, v74, v74, 0.5
    v_cvt_pk_bf16_f32 v86, v72, v73
    s_mov_b32 s75, 0
    s_add_u32 m0, s35, 34816
    v_mfma_f32_16x16x32_bf16 v[20:23], v[60:63], a[140:143], v[20:23]
    ds_read_b64_tr_b16 v[52:53], v108 offset:6144
    buffer_load_dwordx4 v4, s[20:23], s75 offen offset:0 sc1 lds
    v_rcp_f32 v74, v74
    v_mfma_f32_16x16x32_bf16 v[24:27], v[64:67], a[128:131], v[24:27]
    ds_read_b64_tr_b16 v[54:55], v108 offset:6656
    ds_read_b64_tr_b16 v[56:57], v109 offset:2048
    v_add_f32 v75, s81, v75
    v_fma_f32 v74, -v46, v74, v46
    v_mfma_f32_16x16x32_bf16 v[24:27], v[68:71], a[136:139], v[24:27]
    ds_read_b64_tr_b16 v[58:59], v109 offset:2560
    v_fma_f32 v75, v75, v75, 0.5
    v_mfma_f32_16x16x32_bf16 v[28:31], v[64:67], a[132:135], v[28:31]
    ds_read_b64_tr_b16 v[60:61], v109 offset:6144
    v_rcp_f32 v75, v75
    s_nop 0
    v_fma_f32 v75, -v47, v75, v47
    v_mfma_f32_16x16x32_bf16 v[28:31], v[68:71], a[140:143], v[28:31]
    ds_read_b64_tr_b16 v[62:63], v109 offset:6656
    buffer_load_dwordx4 v4, s[20:23], s75 offen offset:1024 sc1 lds
    v_cvt_pk_bf16_f32 v87, v74, v75
    buffer_store_dwordx4 v[84:87], v5, s[20:23], s33 offen offset:1024 sc1
    s_waitcnt lgkmcnt(4)
    v_mfma_f32_16x16x32_bf16 v[32:35], v[48:51], a[0:3], v[88:91]
    ds_read_b64_tr_b16 v[64:65], v104 offset:51200
    v_mfma_f32_16x16x32_bf16 v[32:35], v[52:55], a[8:11], v[32:35]
    ds_read_b64_tr_b16 v[66:67], v104 offset:51712
    v_mfma_f32_16x16x32_bf16 v[36:39], v[48:51], a[4:7], v[88:91]
    ds_read_b64_tr_b16 v[68:69], v104 offset:55296
    s_add_u32 s74, s68, 0
    s_add_u32 m0, s29, 2048
    v_mfma_f32_16x16x32_bf16 v[36:39], v[52:55], a[12:15], v[36:39]
    ds_read_b64_tr_b16 v[70:71], v104 offset:55808
    buffer_load_dwordx4 v3, s[16:19], s74 offen offset:0 lds
    s_waitcnt lgkmcnt(4)
    v_mfma_f32_16x16x32_bf16 v[40:43], v[56:59], a[0:3], v[92:95]
    ds_read_b64_tr_b16 v[48:49], v105 offset:51200
    v_fma_f32 v72, v16, s80, -0.5
    v_exp_f32 v72, v72
    v_mfma_f32_16x16x32_bf16 v[40:43], v[60:63], a[8:11], v[40:43]
    ds_read_b64_tr_b16 v[50:51], v105 offset:51712
    v_fma_f32 v73, v17, s80, -0.5
    v_mfma_f32_16x16x32_bf16 v[44:47], v[56:59], a[4:7], v[92:95]
    ds_read_b64_tr_b16 v[52:53], v105 offset:55296
    v_add_f32 v72, s81, v72
    v_exp_f32 v73, v73
    s_add_u32 m0, s29, 149376
    v_mfma_f32_16x16x32_bf16 v[44:47], v[60:63], a[12:15], v[44:47]
    ds_read_b64_tr_b16 v[54:55], v105 offset:55808
    buffer_load_dwordx4 v3, s[16:19], s74 offen offset:128 lds
    v_fma_f32 v72, v72, v72, 0.5
    s_waitcnt lgkmcnt(4)
    v_mfma_f32_16x16x32_bf16 v[32:35], v[64:67], a[16:19], v[32:35]
    ds_read_b64_tr_b16 v[56:57], v104 offset:10240
    v_fma_f32 v74, v18, s80, -0.5
    v_rcp_f32 v72, v72
    v_mfma_f32_16x16x32_bf16 v[32:35], v[68:71], a[24:27], v[32:35]
    ds_read_b64_tr_b16 v[58:59], v104 offset:10752
    v_add_f32 v73, s81, v73
    v_mfma_f32_16x16x32_bf16 v[36:39], v[64:67], a[20:23], v[36:39]
    ds_read_b64_tr_b16 v[60:61], v104 offset:14336
    v_fma_f32 v72, -v16, v72, v16
    v_exp_f32 v74, v74
    s_add_u32 m0, s29, 83712
    v_mfma_f32_16x16x32_bf16 v[36:39], v[68:71], a[28:31], v[36:39]
    ds_read_b64_tr_b16 v[62:63], v104 offset:14848
    buffer_load_dwordx4 v3, s[16:19], s74 offen offset:256 lds
    v_fma_f32 v73, v73, v73, 0.5
    s_waitcnt lgkmcnt(4)
    v_mfma_f32_16x16x32_bf16 v[40:43], v[48:51], a[16:19], v[40:43]
    ds_read_b64_tr_b16 v[64:65], v105 offset:10240
    v_fma_f32 v75, v19, s80, -0.5
    v_rcp_f32 v73, v73
    v_mfma_f32_16x16x32_bf16 v[40:43], v[52:55], a[24:27], v[40:43]
    ds_read_b64_tr_b16 v[66:67], v105 offset:10752
    v_add_f32 v74, s81, v74
    v_mfma_f32_16x16x32_bf16 v[44:47], v[48:51], a[20:23], v[44:47]
    ds_read_b64_tr_b16 v[68:69], v105 offset:14336
    v_fma_f32 v73, -v17, v73, v17
    v_exp_f32 v75, v75
    s_mov_b32 s75, 98304
    s_add_u32 m0, s35, 100352
    v_mfma_f32_16x16x32_bf16 v[44:47], v[52:55], a[28:31], v[44:47]
    ds_read_b64_tr_b16 v[70:71], v105 offset:14848
    buffer_load_dwordx4 v4, s[20:23], s75 offen offset:0 sc1 lds
    v_fma_f32 v74, v74, v74, 0.5
    s_waitcnt lgkmcnt(4)
    v_mfma_f32_16x16x32_bf16 v[32:35], v[56:59], a[32:35], v[32:35]
    ds_read_b64_tr_b16 v[48:49], v104 offset:59392
    v_cvt_pk_bf16_f32 v80, v72, v73
    v_fma_f32 v72, v24, s80, -0.5
    v_mfma_f32_16x16x32_bf16 v[32:35], v[60:63], a[40:43], v[32:35]
    ds_read_b64_tr_b16 v[50:51], v104 offset:59904
    v_rcp_f32 v74, v74
    v_mfma_f32_16x16x32_bf16 v[36:39], v[56:59], a[36:39], v[36:39]
    ds_read_b64_tr_b16 v[52:53], v104 offset:63488
    v_add_f32 v75, s81, v75
    v_fma_f32 v74, -v18, v74, v18
    v_mfma_f32_16x16x32_bf16 v[36:39], v[60:63], a[44:47], v[36:39]
    ds_read_b64_tr_b16 v[54:55], v104 offset:64000
    buffer_load_dwordx4 v4, s[20:23], s75 offen offset:1024 sc1 lds
    v_exp_f32 v72, v72
    s_waitcnt lgkmcnt(4)
    v_mfma_f32_16x16x32_bf16 v[40:43], v[64:67], a[32:35], v[40:43]
    ds_read_b64_tr_b16 v[56:57], v105 offset:59392
    v_fma_f32 v75, v75, v75, 0.5
    v_fma_f32 v73, v25, s80, -0.5
    v_mfma_f32_16x16x32_bf16 v[40:43], v[68:71], a[40:43], v[40:43]
    ds_read_b64_tr_b16 v[58:59], v105 offset:59904
    v_rcp_f32 v75, v75
    v_add_f32 v72, s81, v72
    v_mfma_f32_16x16x32_bf16 v[44:47], v[64:67], a[36:39], v[44:47]
    ds_read_b64_tr_b16 v[60:61], v105 offset:63488
    v_fma_f32 v75, -v19, v75, v19
    v_exp_f32 v73, v73
    s_add_u32 s74, s68, 442368
    s_add_u32 m0, s29, 92160
    v_mfma_f32_16x16x32_bf16 v[44:47], v[68:71], a[44:47], v[44:47]
    ds_read_b64_tr_b16 v[62:63], v105 offset:64000
    buffer_load_dwordx4 v3, s[16:19], s74 offen offset:0 lds
    v_fma_f32 v72, v72, v72, 0.5
    s_waitcnt lgkmcnt(4)
    v_mfma_f32_16x16x32_bf16 v[32:35], v[48:51], a[48:51], v[32:35]
    ds_read_b64_tr_b16 v[64:65], v108 offset:10240
    v_cvt_pk_bf16_f32 v81, v74, v75
    v_fma_f32 v74, v26, s80, -0.5
    v_mfma_f32_16x16x32_bf16 v[32:35], v[52:55], a[56:59], v[32:35]
    ds_read_b64_tr_b16 v[66:67], v108 offset:10752
    v_rcp_f32 v72, v72
    v_mfma_f32_16x16x32_bf16 v[36:39], v[48:51], a[52:55], v[36:39]
    ds_read_b64_tr_b16 v[68:69], v108 offset:14336
    v_add_f32 v73, s81, v73
    v_fma_f32 v72, -v24, v72, v24
    s_add_u32 m0, s29, 116608
    v_mfma_f32_16x16x32_bf16 v[36:39], v[52:55], a[60:63], v[36:39]
    ds_read_b64_tr_b16 v[70:71], v108 offset:14848
    buffer_load_dwordx4 v3, s[16:19], s74 offen offset:128 lds
    v_exp_f32 v74, v74
    s_waitcnt lgkmcnt(4)
    v_mfma_f32_16x16x32_bf16 v[40:43], v[56:59], a[48:51], v[40:43]
    ds_read_b64_tr_b16 v[48:49], v109 offset:10240
    v_fma_f32 v73, v73, v73, 0.5
    v_fma_f32 v75, v27, s80, -0.5
    v_mfma_f32_16x16x32_bf16 v[40:43], v[60:63], a[56:59], v[40:43]
    ds_read_b64_tr_b16 v[50:51], v109 offset:10752
    v_rcp_f32 v73, v73
    v_mfma_f32_16x16x32_bf16 v[44:47], v[56:59], a[52:55], v[44:47]
    ds_read_b64_tr_b16 v[52:53], v109 offset:14336
    v_add_f32 v74, s81, v74
    v_fma_f32 v73, -v25, v73, v25
    s_add_u32 m0, s29, 124672
    v_mfma_f32_16x16x32_bf16 v[44:47], v[60:63], a[60:63], v[44:47]
    ds_read_b64_tr_b16 v[54:55], v109 offset:14848
    buffer_load_dwordx4 v3, s[16:19], s74 offen offset:256 lds
    v_exp_f32 v75, v75
    s_waitcnt lgkmcnt(4)
    v_mfma_f32_16x16x32_bf16 v[32:35], v[64:67], a[64:67], v[32:35]
    v_fma_f32 v74, v74, v74, 0.5
    v_cvt_pk_bf16_f32 v82, v72, v73
    v_mfma_f32_16x16x32_bf16 v[32:35], v[68:71], a[72:75], v[32:35]
    v_fma_f32 v72, v20, s80, -0.5
    s_waitcnt vmcnt(8) lgkmcnt(0)
    s_barrier
    s_cmp_eq_u32 s28, 0
    s_cbranch_scc1 L_hp3_o
L_hp3:
    v_mfma_f32_16x16x32_bf16 v[36:39], v[64:67], a[68:71], v[36:39]
    ds_read_b64_tr_b16 v[56:57], v104 offset:18432
    ds_read_b64_tr_b16 v[58:59], v104 offset:18944
    v_rcp_f32 v74, v74
    v_add_f32 v75, s81, v75
    s_mov_b32 s75, 196608
    s_add_u32 m0, s35, 51200
    v_mfma_f32_16x16x32_bf16 v[36:39], v[68:71], a[76:79], v[36:39]
    ds_read_b64_tr_b16 v[60:61], v104 offset:22528
    buffer_load_dwordx4 v4, s[20:23], s75 offen offset:0 sc1 lds
    v_fma_f32 v74, -v26, v74, v26
    v_mfma_f32_16x16x32_bf16 v[40:43], v[48:51], a[64:67], v[40:43]
    ds_read_b64_tr_b16 v[62:63], v104 offset:23040
    ds_read_b64_tr_b16 v[64:65], v105 offset:18432
    v_exp_f32 v72, v72
    v_fma_f32 v75, v75, v75, 0.5
    v_mfma_f32_16x16x32_bf16 v[40:43], v[52:55], a[72:75], v[40:43]
    ds_read_b64_tr_b16 v[66:67], v105 offset:18944
    v_fma_f32 v73, v21, s80, -0.5
    v_mfma_f32_16x16x32_bf16 v[44:47], v[48:51], a[68:71], v[44:47]
    ds_read_b64_tr_b16 v[68:69], v105 offset:22528
    v_rcp_f32 v75, v75
    v_add_f32 v72, s81, v72
    v_mfma_f32_16x16x32_bf16 v[44:47], v[52:55], a[76:79], v[44:47]
    ds_read_b64_tr_b16 v[70:71], v105 offset:23040
    buffer_load_dwordx4 v4, s[20:23], s75 offen offset:1024 sc1 lds
    v_fma_f32 v75, -v27, v75, v27
    v_exp_f32 v73, v73
    s_waitcnt lgkmcnt(4)
    v_mfma_f32_16x16x32_bf16 v[32:35], v[56:59], a[80:83], v[32:35]
    ds_read_b64_tr_b16 v[48:49], v104 offset:26624
    v_fma_f32 v72, v72, v72, 0.5
    v_cvt_pk_bf16_f32 v83, v74, v75
    v_mfma_f32_16x16x32_bf16 v[32:35], v[60:63], a[88:91], v[32:35]
    ds_read_b64_tr_b16 v[50:51], v104 offset:27136
    v_fma_f32 v74, v22, s80, -0.5
    v_mfma_f32_16x16x32_bf16 v[36:39], v[56:59], a[84:87], v[36:39]
    ds_read_b64_tr_b16 v[52:53], v104 offset:30720
    v_rcp_f32 v72, v72
    s_mov_b32 s33, 65536
    s_add_u32 s74, s68, 884736
    s_add_u32 m0, s29, 10240
    v_mfma_f32_16x16x32_bf16 v[36:39], v[60:63], a[92:95], v[36:39]
    ds_read_b64_tr_b16 v[54:55], v104 offset:31232
    buffer_load_dwordx4 v3, s[16:19], s74 offen offset:0 lds
    buffer_store_dwordx4 v[80:83], v5, s[20:23], s33 offen offset:0 sc1
    v_add_f32 v73, s81, v73
    s_waitcnt lgkmcnt(4)
    v_mfma_f32_16x16x32_bf16 v[40:43], v[64:67], a[80:83], v[40:43]
    ds_read_b64_tr_b16 v[56:57], v105 offset:26624
    v_fma_f32 v72, -v20, v72, v20
    v_exp_f32 v74, v74
    v_mfma_f32_16x16x32_bf16 v[40:43], v[68:71], a[88:91], v[40:43]
    ds_read_b64_tr_b16 v[58:59], v105 offset:27136
    v_fma_f32 v73, v73, v73, 0.5
    v_mfma_f32_16x16x32_bf16 v[44:47], v[64:67], a[84:87], v[44:47]
    ds_read_b64_tr_b16 v[60:61], v105 offset:30720
    v_fma_f32 v75, v23, s80, -0.5
    v_rcp_f32 v73, v73
    s_add_u32 m0, s29, 132992
    v_mfma_f32_16x16x32_bf16 v[44:47], v[68:71], a[92:95], v[44:47]
    ds_read_b64_tr_b16 v[62:63], v105 offset:31232
    buffer_load_dwordx4 v3, s[16:19], s74 offen offset:128 lds
    v_add_f32 v74, s81, v74
    s_waitcnt lgkmcnt(4)
    v_mfma_f32_16x16x32_bf16 v[32:35], v[48:51], a[96:99], v[32:35]
    ds_read_b64_tr_b16 v[64:65], v106 offset:2048
    v_fma_f32 v73, -v21, v73, v21
    v_exp_f32 v75, v75
    v_mfma_f32_16x16x32_bf16 v[32:35], v[52:55], a[104:107], v[32:35]
    ds_read_b64_tr_b16 v[66:67], v106 offset:2560
    v_fma_f32 v74, v74, v74, 0.5
    v_mfma_f32_16x16x32_bf16 v[36:39], v[48:51], a[100:103], v[36:39]
    ds_read_b64_tr_b16 v[68:69], v106 offset:6144
    v_cvt_pk_bf16_f32 v84, v72, v73
    v_fma_f32 v72, v28, s80, -0.5
    s_add_u32 m0, s29, 141056
    v_mfma_f32_16x16x32_bf16 v[36:39], v[52:55], a[108:111], v[36:39]
    ds_read_b64_tr_b16 v[70:71], v106 offset:6656
    buffer_load_dwordx4 v3, s[16:19], s74 offen offset:256 lds
    v_rcp_f32 v74, v74
    s_waitcnt lgkmcnt(4)
    v_mfma_f32_16x16x32_bf16 v[40:43], v[56:59], a[96:99], v[40:43]
    ds_read_b64_tr_b16 v[48:49], v107 offset:2048
    v_add_f32 v75, s81, v75
    v_fma_f32 v74, -v22, v74, v22
    v_mfma_f32_16x16x32_bf16 v[40:43], v[60:63], a[104:107], v[40:43]
    ds_read_b64_tr_b16 v[50:51], v107 offset:2560
    v_exp_f32 v72, v72
    v_mfma_f32_16x16x32_bf16 v[44:47], v[56:59], a[100:103], v[44:47]
    ds_read_b64_tr_b16 v[52:53], v107 offset:6144
    v_fma_f32 v75, v75, v75, 0.5
    v_fma_f32 v73, v29, s80, -0.5
    v_mfma_f32_16x16x32_bf16 v[44:47], v[60:63], a[108:111], v[44:47]
    ds_read_b64_tr_b16 v[54:55], v107 offset:6656
    v_rcp_f32 v75, v75
    v_add_f32 v72, s81, v72
    s_waitcnt lgkmcnt(4)
    v_mfma_f32_16x16x32_bf16 v[32:35], v[64:67], a[112:115], v[32:35]
    ds_read_b64_tr_b16 v[56:57], v106 offset:10240
    v_fma_f32 v75, -v23, v75, v23
    v_exp_f32 v73, v73
    v_mfma_f32_16x16x32_bf16 v[32:35], v[68:71], a[120:123], v[32:35]
    ds_read_b64_tr_b16 v[58:59], v106 offset:10752
    v_fma_f32 v72, v72, v72, 0.5
    v_mfma_f32_16x16x32_bf16 v[36:39], v[64:67], a[116:119], v[36:39]
    ds_read_b64_tr_b16 v[60:61], v106 offset:14336
    v_cvt_pk_bf16_f32 v85, v74, v75
    v_fma_f32 v74, v30, s80, -0.5
    v_mfma_f32_16x16x32_bf16 v[36:39], v[68:71], a[124:127], v[36:39]
    ds_read_b64_tr_b16 v[62:63], v106 offset:14848
    v_rcp_f32 v72, v72
    s_waitcnt lgkmcnt(4)
    v_mfma_f32_16x16x32_bf16 v[40:43], v[48:51], a[112:115], v[40:43]
    ds_read_b64_tr_b16 v[64:65], v107 offset:10240
    v_add_f32 v73, s81, v73
    v_fma_f32 v72, -v28, v72, v28
    v_mfma_f32_16x16x32_bf16 v[40:43], v[52:55], a[120:123], v[40:43]
    ds_read_b64_tr_b16 v[66:67], v107 offset:10752
    v_exp_f32 v74, v74
    v_mfma_f32_16x16x32_bf16 v[44:47], v[48:51], a[116:119], v[44:47]
    ds_read_b64_tr_b16 v[68:69], v107 offset:14336
    v_fma_f32 v73, v73, v73, 0.5
    v_fma_f32 v75, v31, s80, -0.5
    v_mfma_f32_16x16x32_bf16 v[44:47], v[52:55], a[124:127], v[44:47]
    ds_read_b64_tr_b16 v[70:71], v107 offset:14848
    v_rcp_f32 v73, v73
    s_waitcnt lgkmcnt(4)
    v_mfma_f32_16x16x32_bf16 v[32:35], v[56:59], a[128:131], v[32:35]
    v_add_f32 v74, s81, v74
    v_fma_f32 v73, -v29, v73, v29
    v_mfma_f32_16x16x32_bf16 v[32:35], v[60:63], a[136:139], v[32:35]
    v_exp_f32 v75, v75
    s_waitcnt vmcnt(11) lgkmcnt(0)
    s_barrier
    v_mov_b32 v104, v12
    v_add_u32 v105, 65536, v12
    v_add_u32 v106, 131072, v12
    v_mfma_f32_16x16x32_bf16 v[36:39], v[56:59], a[132:135], v[36:39]
    ds_read_b128 a[0:3], v6 offset:34816
    ds_read_b128 a[16:19], v6 offset:36864
    v_fma_f32 v74, v74, v74, 0.5
    v_cvt_pk_bf16_f32 v86, v72, v73
    s_mov_b32 s75, 16384
    s_add_u32 m0, s35, 18432
    v_mfma_f32_16x16x32_bf16 v[36:39], v[60:63], a[140:143], v[36:39]
    ds_read_b64_tr_b16 v[48:49], v104 offset:2048
    ds_read_b64_tr_b16 v[50:51], v104 offset:4096
    buffer_load_dwordx4 v4, s[20:23], s75 offen offset:0 sc1 lds
    v_rcp_f32 v74, v74
    v_mfma_f32_16x16x32_bf16 v[40:43], v[64:67], a[128:131], v[40:43]
    ds_read_b128 a[4:7], v6 offset:35840
    ds_read_b128 a[20:23], v6 offset:37888
    v_add_f32 v75, s81, v75
    v_fma_f32 v74, -v30, v74, v30
    v_mfma_f32_16x16x32_bf16 v[40:43], v[68:71], a[136:139], v[40:43]
    ds_read_b64_tr_b16 v[52:53], v104 offset:6144
    ds_read_b64_tr_b16 v[54:55], v104 offset:8192
    v_fma_f32 v75, v75, v75, 0.5
    v_mfma_f32_16x16x32_bf16 v[44:47], v[64:67], a[132:135], v[44:47]
    ds_read_b128 a[8:11], v6 offset:38912
    ds_read_b128 a[24:27], v6 offset:40960
    v_rcp_f32 v75, v75
    s_nop 0
    v_fma_f32 v75, -v31, v75, v31
    v_mfma_f32_16x16x32_bf16 v[44:47], v[68:71], a[140:143], v[44:47]
    ds_read_b128 a[12:15], v6 offset:39936
    ds_read_b128 a[28:31], v6 offset:41984
    buffer_load_dwordx4 v4, s[20:23], s75 offen offset:1024 sc1 lds
    v_cvt_pk_bf16_f32 v87, v74, v75
    buffer_store_dwordx4 v[84:87], v5, s[20:23], s33 offen offset:1024 sc1
    s_waitcnt lgkmcnt(4)
    v_mfma_f32_16x16x32_bf16 a[128:131], v[48:51], a[0:3], 0
    ds_read_b64_tr_b16 v[56:57], v106 offset:18432
    v_mfma_f32_16x16x32_bf16 a[128:131], v[52:55], a[16:19], a[128:131]
    ds_read_b64_tr_b16 v[58:59], v106 offset:20480
    v_mfma_f32_16x16x32_bf16 a[132:135], v[48:51], a[4:7], 0
    ds_read_b64_tr_b16 v[60:61], v106 offset:22528
    s_add_u32 s74, s68, 73728
    s_add_u32 m0, s29, 67584
    v_mfma_f32_16x16x32_bf16 a[132:135], v[52:55], a[20:23], a[132:135]
    ds_read_b64_tr_b16 v[62:63], v106 offset:24576
    buffer_load_dwordx4 v3, s[16:19], s74 offen offset:0 lds
    s_waitcnt lgkmcnt(6)
    v_mfma_f32_16x16x32_bf16 a[136:139], v[48:51], a[8:11], 0
    ds_read_b64_tr_b16 v[64:65], v105 offset:18432
    v_fma_f32 v72, v32, s80, -0.5
    v_exp_f32 v72, v72
    v_mfma_f32_16x16x32_bf16 a[136:139], v[52:55], a[24:27], a[136:139]
    ds_read_b64_tr_b16 v[66:67], v105 offset:20480
    v_fma_f32 v73, v33, s80, -0.5
    s_waitcnt lgkmcnt(6)
    v_mfma_f32_16x16x32_bf16 a[140:143], v[48:51], a[12:15], 0
    ds_read_b64_tr_b16 v[68:69], v105 offset:22528
    v_add_f32 v72, s81, v72
    s_add_u32 m0, s29, 75648
    v_mfma_f32_16x16x32_bf16 a[140:143], v[52:55], a[28:31], a[140:143]
    ds_read_b64_tr_b16 v[70:71], v105 offset:24576
    buffer_load_dwordx4 v3, s[16:19], s74 offen offset:128 lds
    v_exp_f32 v73, v73
    s_waitcnt lgkmcnt(4)
    v_mfma_f32_16x16x32_bf16 v[88:91], v[56:59], a[0:3], 0
    v_fma_f32 v72, v72, v72, 0.5
    v_fma_f32 v74, v34, s80, -0.5
    v_mfma_f32_16x16x32_bf16 v[88:91], v[60:63], a[16:19], v[88:91]
    v_rcp_f32 v72, v72
    v_mfma_f32_16x16x32_bf16 v[92:95], v[56:59], a[4:7], 0
    v_add_f32 v73, s81, v73
    v_fma_f32 v72, -v32, v72, v32
    v_mfma_f32_16x16x32_bf16 v[92:95], v[60:63], a[20:23], v[92:95]
    v_exp_f32 v74, v74
    v_mfma_f32_16x16x32_bf16 v[96:99], v[56:59], a[8:11], 0
    v_fma_f32 v73, v73, v73, 0.5
    v_fma_f32 v75, v35, s80, -0.5
    v_mfma_f32_16x16x32_bf16 v[96:99], v[60:63], a[24:27], v[96:99]
    v_rcp_f32 v73, v73
    s_waitcnt vmcnt(11) lgkmcnt(0)
    s_barrier
    v_mfma_f32_16x16x32_bf16 v[100:103], v[56:59], a[12:15], 0
    ds_read_b128 a[32:35], v7 offset:34816
    v_add_f32 v74, s81, v74
    s_add_u32 m0, s29, 1792
    v_mfma_f32_16x16x32_bf16 v[100:103], v[60:63], a[28:31], v[100:103]
    ds_read_b128 a[48:51], v7 offset:36864
    buffer_load_dwordx4 v3, s[16:19], s74 offen offset:256 lds
    v_fma_f32 v73, -v33, v73, v33
    v_mfma_f32_16x16x32_bf16 v[16:19], v[64:67], a[0:3], 0
    ds_read_b64_tr_b16 v[48:49], v105 offset:26624
    v_exp_f32 v75, v75
    v_fma_f32 v74, v74, v74, 0.5
    v_mfma_f32_16x16x32_bf16 v[16:19], v[68:71], a[16:19], v[16:19]
    ds_read_b64_tr_b16 v[50:51], v105 offset:28672
    v_cvt_pk_bf16_f32 v80, v72, v73
    v_mfma_f32_16x16x32_bf16 v[20:23], v[64:67], a[4:7], 0
    ds_read_b128 a[36:39], v7 offset:35840
    v_fma_f32 v72, v40, s80, -0.5
    v_rcp_f32 v74, v74
    s_mov_b32 s75, 114688
    s_add_u32 m0, s35, 34816
    v_mfma_f32_16x16x32_bf16 v[20:23], v[68:71], a[20:23], v[20:23]
    ds_read_b128 a[52:55], v7 offset:37888
    buffer_load_dwordx4 v4, s[20:23], s75 offen offset:0 sc1 lds
    v_add_f32 v75, s81, v75
    v_mfma_f32_16x16x32_bf16 v[24:27], v[64:67], a[8:11], 0
    ds_read_b64_tr_b16 v[52:53], v105 offset:30720
    v_fma_f32 v74, -v34, v74, v34
    v_exp_f32 v72, v72
    v_mfma_f32_16x16x32_bf16 v[24:27], v[68:71], a[24:27], v[24:27]
    ds_read_b64_tr_b16 v[54:55], v105 offset:32768
    v_fma_f32 v75, v75, v75, 0.5
    v_mfma_f32_16x16x32_bf16 v[28:31], v[64:67], a[12:15], 0
    ds_read_b128 a[40:43], v7 offset:38912
    v_fma_f32 v73, v41, s80, -0.5
    v_mfma_f32_16x16x32_bf16 v[28:31], v[68:71], a[28:31], v[28:31]
    ds_read_b128 a[56:59], v7 offset:40960
    buffer_load_dwordx4 v4, s[20:23], s75 offen offset:1024 sc1 lds
    v_rcp_f32 v75, v75
    s_waitcnt lgkmcnt(2)
    v_mfma_f32_16x16x32_bf16 a[128:131], v[48:51], a[32:35], a[128:131]
    ds_read_b128 a[44:47], v7 offset:39936
    v_add_f32 v72, s81, v72
    v_fma_f32 v75, -v35, v75, v35
    v_mfma_f32_16x16x32_bf16 a[128:131], v[52:55], a[48:51], a[128:131]
    ds_read_b128 a[60:63], v7 offset:41984
    v_exp_f32 v73, v73
    v_mfma_f32_16x16x32_bf16 a[132:135], v[48:51], a[36:39], a[132:135]
    ds_read_b64_tr_b16 v[56:57], v105 offset:51200
    v_fma_f32 v72, v72, v72, 0.5
    v_cvt_pk_bf16_f32 v81, v74, v75
    s_add_u32 s74, s68, 516096
    s_add_u32 m0, s29, 83968
    v_mfma_f32_16x16x32_bf16 a[132:135], v[52:55], a[52:55], a[132:135]
    ds_read_b64_tr_b16 v[58:59], v105 offset:53248
    buffer_load_dwordx4 v3, s[16:19], s74 offen offset:0 lds
    v_fma_f32 v74, v42, s80, -0.5
    s_waitcnt lgkmcnt(4)
    v_mfma_f32_16x16x32_bf16 a[136:139], v[48:51], a[40:43], a[136:139]
    ds_read_b64_tr_b16 v[60:61], v105 offset:55296
    v_rcp_f32 v72, v72
    v_add_f32 v73, s81, v73
    v_mfma_f32_16x16x32_bf16 a[136:139], v[52:55], a[56:59], a[136:139]
    ds_read_b64_tr_b16 v[62:63], v105 offset:57344
    v_fma_f32 v72, -v40, v72, v40
    s_waitcnt lgkmcnt(4)
    v_mfma_f32_16x16x32_bf16 a[140:143], v[48:51], a[44:47], a[140:143]
    ds_read_b64_tr_b16 v[64:65], v105 offset:59392
    v_exp_f32 v74, v74
    v_fma_f32 v73, v73, v73, 0.5
    s_add_u32 m0, s29, 149376
    v_mfma_f32_16x16x32_bf16 a[140:143], v[52:55], a[60:63], a[140:143]
    ds_read_b64_tr_b16 v[66:67], v105 offset:61440
    buffer_load_dwordx4 v3, s[16:19], s74 offen offset:128 lds
    v_fma_f32 v75, v43, s80, -0.5
    s_cmp_eq_u32 s28, 7
    s_cbranch_scc1 L_hc3i_o
L_hc3i:
    s_waitcnt lgkmcnt(2)
    v_mfma_f32_16x16x32_bf16 v[88:91], v[56:59], a[32:35], v[88:91]
    ds_read_b64_tr_b16 v[68:69], v105 offset:63488
    v_rcp_f32 v73, v73
    v_mfma_f32_16x16x32_bf16 v[88:91], v[60:63], a[48:51], v[88:91]
    ds_read_b64_tr_b16 v[70:71], v106 offset:0
    v_add_f32 v74, s81, v74
    v_mfma_f32_16x16x32_bf16 v[92:95], v[56:59], a[36:39], v[92:95]
    v_fma_f32 v73, -v41, v73, v41
    v_exp_f32 v75, v75
    v_mfma_f32_16x16x32_bf16 v[92:95], v[60:63], a[52:55], v[92:95]
    v_fma_f32 v74, v74, v74, 0.5
    v_mfma_f32_16x16x32_bf16 v[96:99], v[56:59], a[40:43], v[96:99]
    v_cvt_pk_bf16_f32 v82, v72, v73
    v_fma_f32 v72, v36, s80, -0.5
    v_mfma_f32_16x16x32_bf16 v[96:99], v[60:63], a[56:59], v[96:99]
    v_rcp_f32 v74, v74
    s_waitcnt vmcnt(10) lgkmcnt(0)
    s_barrier
    v_mfma_f32_16x16x32_bf16 v[100:103], v[56:59], a[44:47], v[100:103]
    ds_read_b128 a[0:3], v6 offset:51200
    v_add_f32 v75, s81, v75
    v_fma_f32 v74, -v42, v74, v42
    s_add_u32 m0, s29, 91904
    v_mfma_f32_16x16x32_bf16 v[100:103], v[60:63], a[60:63], v[100:103]
    ds_read_b128 a[16:19], v6 offset:53248
    buffer_load_dwordx4 v3, s[16:19], s74 offen offset:256 lds
    v_exp_f32 v72, v72
    v_mfma_f32_16x16x32_bf16 v[16:19], v[64:67], a[32:35], v[16:19]
    ds_read_b64_tr_b16 v[48:49], v104 offset:10240
    v_fma_f32 v75, v75, v75, 0.5
    v_mfma_f32_16x16x32_bf16 v[16:19], v[68:71], a[48:51], v[16:19]
    ds_read_b64_tr_b16 v[50:51], v104 offset:12288
    v_fma_f32 v73, v37, s80, -0.5
    v_mfma_f32_16x16x32_bf16 v[20:23], v[64:67], a[36:39], v[20:23]
    ds_read_b128 a[4:7], v6 offset:52224
    v_rcp_f32 v75, v75
    v_add_f32 v72, s81, v72
    s_mov_b32 s75, 212992
    s_add_u32 m0, s35, 100352
    v_mfma_f32_16x16x32_bf16 v[20:23], v[68:71], a[52:55], v[20:23]
    ds_read_b128 a[20:23], v6 offset:54272
    buffer_load_dwordx4 v4, s[20:23], s75 offen offset:0 sc1 lds
    v_fma_f32 v75, -v43, v75, v43
    v_mfma_f32_16x16x32_bf16 v[24:27], v[64:67], a[40:43], v[24:27]
    ds_read_b64_tr_b16 v[52:53], v104 offset:14336
    v_exp_f32 v73, v73
    v_fma_f32 v72, v72, v72, 0.5
    v_mfma_f32_16x16x32_bf16 v[24:27], v[68:71], a[56:59], v[24:27]
    ds_read_b64_tr_b16 v[54:55], v104 offset:16384
    v_cvt_pk_bf16_f32 v83, v74, v75
    v_mfma_f32_16x16x32_bf16 v[28:31], v[64:67], a[44:47], v[28:31]
    ds_read_b128 a[8:11], v6 offset:55296
    v_fma_f32 v74, v38, s80, -0.5
    v_rcp_f32 v72, v72
    v_mfma_f32_16x16x32_bf16 v[28:31], v[68:71], a[60:63], v[28:31]
    ds_read_b128 a[24:27], v6 offset:57344
    buffer_load_dwordx4 v4, s[20:23], s75 offen offset:1024 sc1 lds
    s_mov_b32 s33, 81920
    buffer_store_dwordx4 v[80:83], v5, s[20:23], s33 offen offset:0 sc1
    s_waitcnt lgkmcnt(2)
    v_mfma_f32_16x16x32_bf16 a[128:131], v[48:51], a[0:3], a[128:131]
    ds_read_b128 a[12:15], v6 offset:56320
    v_add_f32 v73, s81, v73
    v_fma_f32 v72, -v36, v72, v36
    v_mfma_f32_16x16x32_bf16 a[128:131], v[52:55], a[16:19], a[128:131]
    ds_read_b128 a[28:31], v6 offset:58368
    v_exp_f32 v74, v74
    v_mfma_f32_16x16x32_bf16 a[132:135], v[48:51], a[4:7], a[132:135]
    ds_read_b64_tr_b16 v[56:57], v106 offset:2048
    v_fma_f32 v73, v73, v73, 0.5
    v_fma_f32 v75, v39, s80, -0.5
    s_add_u32 s74, s68, 958464
    s_add_u32 m0, s29, 116736
    v_mfma_f32_16x16x32_bf16 a[132:135], v[52:55], a[20:23], a[132:135]
    ds_read_b64_tr_b16 v[58:59], v106 offset:4096
    buffer_load_dwordx4 v3, s[16:19], s74 offen offset:0 lds
    v_rcp_f32 v73, v73
    s_waitcnt lgkmcnt(4)
    v_mfma_f32_16x16x32_bf16 a[136:139], v[48:51], a[8:11], a[136:139]
    ds_read_b64_tr_b16 v[60:61], v106 offset:6144
    v_add_f32 v74, s81, v74
    v_mfma_f32_16x16x32_bf16 a[136:139], v[52:55], a[24:27], a[136:139]
    ds_read_b64_tr_b16 v[62:63], v106 offset:8192
    v_fma_f32 v73, -v37, v73, v37
    s_waitcnt lgkmcnt(4)
    v_mfma_f32_16x16x32_bf16 a[140:143], v[48:51], a[12:15], a[140:143]
    ds_read_b64_tr_b16 v[64:65], v106 offset:10240
    v_exp_f32 v75, v75
    v_fma_f32 v74, v74, v74, 0.5
    s_add_u32 m0, s29, 124800
    v_mfma_f32_16x16x32_bf16 a[140:143], v[52:55], a[28:31], a[140:143]
    ds_read_b64_tr_b16 v[66:67], v106 offset:12288
    buffer_load_dwordx4 v3, s[16:19], s74 offen offset:128 lds
    v_cvt_pk_bf16_f32 v84, v72, v73
    s_waitcnt lgkmcnt(2)
    v_mfma_f32_16x16x32_bf16 v[88:91], v[56:59], a[0:3], v[88:91]
    ds_read_b64_tr_b16 v[68:69], v106 offset:14336
    v_fma_f32 v72, v44, s80, -0.5
    v_rcp_f32 v74, v74
    v_mfma_f32_16x16x32_bf16 v[88:91], v[60:63], a[16:19], v[88:91]
    ds_read_b64_tr_b16 v[70:71], v106 offset:16384
    v_add_f32 v75, s81, v75
    v_mfma_f32_16x16x32_bf16 v[92:95], v[56:59], a[4:7], v[92:95]
    v_fma_f32 v74, -v38, v74, v38
    v_exp_f32 v72, v72
    v_mfma_f32_16x16x32_bf16 v[92:95], v[60:63], a[20:23], v[92:95]
    v_fma_f32 v75, v75, v75, 0.5
    v_mfma_f32_16x16x32_bf16 v[96:99], v[56:59], a[8:11], v[96:99]
    v_fma_f32 v73, v45, s80, -0.5
    v_mfma_f32_16x16x32_bf16 v[96:99], v[60:63], a[24:27], v[96:99]
    v_rcp_f32 v75, v75
    s_cmp_eq_u32 s28, 7
    s_cbranch_scc1 L_hc3c_o
L_hc3c:
    s_waitcnt vmcnt(10) lgkmcnt(0)
    s_barrier
    v_mfma_f32_16x16x32_bf16 v[100:103], v[56:59], a[12:15], v[100:103]
    ds_read_b128 a[32:35], v6 offset:18432
    v_add_f32 v72, s81, v72
    v_fma_f32 v75, -v39, v75, v39
    s_add_u32 m0, s29, 9984
    v_mfma_f32_16x16x32_bf16 v[100:103], v[60:63], a[28:31], v[100:103]
    ds_read_b128 a[48:51], v6 offset:20480
    buffer_load_dwordx4 v3, s[16:19], s74 offen offset:256 lds
    v_exp_f32 v73, v73
    v_mfma_f32_16x16x32_bf16 v[16:19], v[64:67], a[0:3], v[16:19]
    ds_read_b64_tr_b16 v[48:49], v105 offset:2048
    v_fma_f32 v72, v72, v72, 0.5
    v_cvt_pk_bf16_f32 v85, v74, v75
    v_mfma_f32_16x16x32_bf16 v[16:19], v[68:71], a[16:19], v[16:19]
    ds_read_b64_tr_b16 v[50:51], v105 offset:4096
    v_fma_f32 v74, v46, s80, -0.5
    v_mfma_f32_16x16x32_bf16 v[20:23], v[64:67], a[4:7], v[20:23]
    ds_read_b128 a[36:39], v6 offset:19456
    v_rcp_f32 v72, v72
    v_add_f32 v73, s81, v73
    s_mov_b32 s75, 32768
    s_add_u32 m0, s35, 51200
    v_mfma_f32_16x16x32_bf16 v[20:23], v[68:71], a[20:23], v[20:23]
    ds_read_b128 a[52:55], v6 offset:21504
    buffer_load_dwordx4 v4, s[20:23], s75 offen offset:0 sc1 lds
    v_fma_f32 v72, -v44, v72, v44
    v_mfma_f32_16x16x32_bf16 v[24:27], v[64:67], a[8:11], v[24:27]
    ds_read_b64_tr_b16 v[52:53], v105 offset:6144
    v_exp_f32 v74, v74
    v_fma_f32 v73, v73, v73, 0.5
    v_mfma_f32_16x16x32_bf16 v[24:27], v[68:71], a[24:27], v[24:27]
    ds_read_b64_tr_b16 v[54:55], v105 offset:8192
    v_fma_f32 v75, v47, s80, -0.5
    v_mfma_f32_16x16x32_bf16 v[28:31], v[64:67], a[12:15], v[28:31]
    ds_read_b128 a[40:43], v6 offset:22528
    v_rcp_f32 v73, v73
    v_mfma_f32_16x16x32_bf16 v[28:31], v[68:71], a[28:31], v[28:31]
    ds_read_b128 a[56:59], v6 offset:24576
    buffer_load_dwordx4 v4, s[20:23], s75 offen offset:1024 sc1 lds
    v_add_f32 v74, s81, v74
    s_waitcnt lgkmcnt(2)
    v_mfma_f32_16x16x32_bf16 a[128:131], v[48:51], a[32:35], a[128:131]
    ds_read_b128 a[44:47], v6 offset:23552
    v_fma_f32 v73, -v45, v73, v45
    v_exp_f32 v75, v75
    v_mfma_f32_16x16x32_bf16 a[128:131], v[52:55], a[48:51], a[128:131]
    ds_read_b128 a[60:63], v6 offset:25600
    v_fma_f32 v74, v74, v74, 0.5
    v_mfma_f32_16x16x32_bf16 a[132:135], v[48:51], a[36:39], a[132:135]
    ds_read_b64_tr_b16 v[56:57], v105 offset:10240
    v_cvt_pk_bf16_f32 v86, v72, v73
    v_rcp_f32 v74, v74
    s_add_u32 s74, s68, 147456
    s_add_u32 m0, s29, 133120
    v_mfma_f32_16x16x32_bf16 a[132:135], v[52:55], a[52:55], a[132:135]
    ds_read_b64_tr_b16 v[58:59], v105 offset:12288
    buffer_load_dwordx4 v3, s[16:19], s74 offen offset:0 lds
    v_add_f32 v75, s81, v75
    s_waitcnt lgkmcnt(4)
    v_mfma_f32_16x16x32_bf16 a[136:139], v[48:51], a[40:43], a[136:139]
    ds_read_b64_tr_b16 v[60:61], v105 offset:14336
    v_fma_f32 v74, -v46, v74, v46
    v_fma_f32 v75, v75, v75, 0.5
    v_mfma_f32_16x16x32_bf16 a[136:139], v[52:55], a[56:59], a[136:139]
    ds_read_b64_tr_b16 v[62:63], v105 offset:16384
    v_rcp_f32 v75, v75
    s_waitcnt lgkmcnt(4)
    v_mfma_f32_16x16x32_bf16 a[140:143], v[48:51], a[44:47], a[140:143]
    ds_read_b64_tr_b16 v[64:65], v104 offset:2048
    v_fma_f32 v75, -v47, v75, v47
    v_cvt_pk_bf16_f32 v87, v74, v75
    s_add_u32 m0, s29, 141184
    v_mfma_f32_16x16x32_bf16 a[140:143], v[52:55], a[60:63], a[140:143]
    ds_read_b64_tr_b16 v[66:67], v104 offset:4096
    buffer_load_dwordx4 v3, s[16:19], s74 offen offset:128 lds
    buffer_store_dwordx4 v[84:87], v5, s[20:23], s33 offen offset:1024 sc1
    s_waitcnt lgkmcnt(2)
    v_mfma_f32_16x16x32_bf16 v[88:91], v[56:59], a[32:35], v[88:91]
    ds_read_b64_tr_b16 v[68:69], v104 offset:6144
    v_mfma_f32_16x16x32_bf16 v[88:91], v[60:63], a[48:51], v[88:91]
    ds_read_b64_tr_b16 v[70:71], v104 offset:8192
    v_mfma_f32_16x16x32_bf16 v[92:95], v[56:59], a[36:39], v[92:95]
    v_mfma_f32_16x16x32_bf16 v[92:95], v[60:63], a[52:55], v[92:95]
    v_mfma_f32_16x16x32_bf16 v[96:99], v[56:59], a[40:43], v[96:99]
    v_mfma_f32_16x16x32_bf16 v[96:99], v[60:63], a[56:59], v[96:99]
    s_waitcnt vmcnt(11) lgkmcnt(0)
    s_barrier
    v_mfma_f32_16x16x32_bf16 v[100:103], v[56:59], a[44:47], v[100:103]
    ds_read_b128 a[0:3], v6 offset:34816
    s_add_u32 m0, s29, 1792
    v_mfma_f32_16x16x32_bf16 v[100:103], v[60:63], a[60:63], v[100:103]
    ds_read_b128 a[16:19], v6 offset:36864
    buffer_load_dwordx4 v3, s[16:19], s74 offen offset:256 lds
    v_mfma_f32_16x16x32_bf16 v[16:19], v[64:67], a[32:35], v[16:19]
    ds_read_b64_tr_b16 v[48:49], v105 offset:18432
    v_mfma_f32_16x16x32_bf16 v[16:19], v[68:71], a[48:51], v[16:19]
    ds_read_b64_tr_b16 v[50:51], v105 offset:20480
    v_mfma_f32_16x16x32_bf16 v[20:23], v[64:67], a[36:39], v[20:23]
    ds_read_b128 a[4:7], v6 offset:35840
    s_mov_b32 s75, 131072
    s_add_u32 m0, s35, 18432
    v_mfma_f32_16x16x32_bf16 v[20:23], v[68:71], a[52:55], v[20:23]
    ds_read_b128 a[20:23], v6 offset:37888
    buffer_load_dwordx4 v4, s[20:23], s75 offen offset:0 sc1 lds
    v_mfma_f32_16x16x32_bf16 v[24:27], v[64:67], a[40:43], v[24:27]
    ds_read_b64_tr_b16 v[52:53], v105 offset:22528
    v_mfma_f32_16x16x32_bf16 v[24:27], v[68:71], a[56:59], v[24:27]
    ds_read_b64_tr_b16 v[54:55], v105 offset:24576
    v_mfma_f32_16x16x32_bf16 v[28:31], v[64:67], a[44:47], v[28:31]
    ds_read_b128 a[8:11], v6 offset:38912
    v_mfma_f32_16x16x32_bf16 v[28:31], v[68:71], a[60:63], v[28:31]
    ds_read_b128 a[24:27], v6 offset:40960
    buffer_load_dwordx4 v4, s[20:23], s75 offen offset:1024 sc1 lds
    s_waitcnt lgkmcnt(2)
    v_mfma_f32_16x16x32_bf16 a[128:131], v[48:51], a[0:3], a[128:131]
    ds_read_b128 a[12:15], v6 offset:39936
    v_mfma_f32_16x16x32_bf16 a[128:131], v[52:55], a[16:19], a[128:131]
    ds_read_b128 a[28:31], v6 offset:41984
    v_mfma_f32_16x16x32_bf16 a[132:135], v[48:51], a[4:7], a[132:135]
    ds_read_b64_tr_b16 v[56:57], v106 offset:18432
    s_add_u32 s74, s68, 589824
    s_add_u32 m0, s29, 67584
    v_mfma_f32_16x16x32_bf16 a[132:135], v[52:55], a[20:23], a[132:135]
    ds_read_b64_tr_b16 v[58:59], v106 offset:20480
    buffer_load_dwordx4 v3, s[16:19], s74 offen offset:0 lds
    s_waitcnt lgkmcnt(4)
    v_mfma_f32_16x16x32_bf16 a[136:139], v[48:51], a[8:11], a[136:139]
    ds_read_b64_tr_b16 v[60:61], v106 offset:22528
    v_mfma_f32_16x16x32_bf16 a[136:139], v[52:55], a[24:27], a[136:139]
    ds_read_b64_tr_b16 v[62:63], v106 offset:24576
    s_waitcnt lgkmcnt(4)
    v_mfma_f32_16x16x32_bf16 a[140:143], v[48:51], a[12:15], a[140:143]
    ds_read_b64_tr_b16 v[64:65], v105 offset:26624
    s_add_u32 m0, s29, 75648
    v_mfma_f32_16x16x32_bf16 a[140:143], v[52:55], a[28:31], a[140:143]
    ds_read_b64_tr_b16 v[66:67], v105 offset:28672
    buffer_load_dwordx4 v3, s[16:19], s74 offen offset:128 lds
    s_waitcnt lgkmcnt(2)
    v_mfma_f32_16x16x32_bf16 v[88:91], v[56:59], a[0:3], v[88:91]
    ds_read_b64_tr_b16 v[68:69], v105 offset:30720
    v_mfma_f32_16x16x32_bf16 v[88:91], v[60:63], a[16:19], v[88:91]
    ds_read_b64_tr_b16 v[70:71], v105 offset:32768
    v_mfma_f32_16x16x32_bf16 v[92:95], v[56:59], a[4:7], v[92:95]
    v_mfma_f32_16x16x32_bf16 v[92:95], v[60:63], a[20:23], v[92:95]
    v_mfma_f32_16x16x32_bf16 v[96:99], v[56:59], a[8:11], v[96:99]
    v_mfma_f32_16x16x32_bf16 v[96:99], v[60:63], a[24:27], v[96:99]
    s_waitcnt vmcnt(5) lgkmcnt(0)
    s_barrier
    s_cmp_eq_u32 s28, 0
    s_cbranch_scc1 L_hp5_o
L_hp5:
    v_mfma_f32_16x16x32_bf16 v[100:103], v[56:59], a[12:15], v[100:103]
    ds_read_b128 a[32:35], v7 offset:34816
    s_add_u32 m0, s29, 149248
    v_mfma_f32_16x16x32_bf16 v[100:103], v[60:63], a[28:31], v[100:103]
    ds_read_b128 a[48:51], v7 offset:36864
    buffer_load_dwordx4 v3, s[16:19], s74 offen offset:256 lds
    v_mfma_f32_16x16x32_bf16 v[16:19], v[64:67], a[0:3], v[16:19]
    ds_read_b64_tr_b16 v[48:49], v105 offset:51200
    v_mfma_f32_16x16x32_bf16 v[16:19], v[68:71], a[16:19], v[16:19]
    ds_read_b64_tr_b16 v[50:51], v105 offset:53248
    v_mfma_f32_16x16x32_bf16 v[20:23], v[64:67], a[4:7], v[20:23]
    ds_read_b128 a[36:39], v7 offset:35840
    s_mov_b32 s75, 229376
    s_add_u32 m0, s35, 34816
    v_mfma_f32_16x16x32_bf16 v[20:23], v[68:71], a[20:23], v[20:23]
    ds_read_b128 a[52:55], v7 offset:37888
    buffer_load_dwordx4 v4, s[20:23], s75 offen offset:0 sc1 lds
    v_mfma_f32_16x16x32_bf16 v[24:27], v[64:67], a[8:11], v[24:27]
    ds_read_b64_tr_b16 v[52:53], v105 offset:55296
    v_mfma_f32_16x16x32_bf16 v[24:27], v[68:71], a[24:27], v[24:27]
    ds_read_b64_tr_b16 v[54:55], v105 offset:57344
    v_mfma_f32_16x16x32_bf16 v[28:31], v[64:67], a[12:15], v[28:31]
    ds_read_b128 a[40:43], v7 offset:38912
    v_mfma_f32_16x16x32_bf16 v[28:31], v[68:71], a[28:31], v[28:31]
    ds_read_b128 a[56:59], v7 offset:40960
    buffer_load_dwordx4 v4, s[20:23], s75 offen offset:1024 sc1 lds
    s_waitcnt lgkmcnt(2)
    v_mfma_f32_16x16x32_bf16 a[128:131], v[48:51], a[32:35], a[128:131]
    ds_read_b128 a[44:47], v7 offset:39936
    v_mfma_f32_16x16x32_bf16 a[128:131], v[52:55], a[48:51], a[128:131]
    ds_read_b128 a[60:63], v7 offset:41984
    v_mfma_f32_16x16x32_bf16 a[132:135], v[48:51], a[36:39], a[132:135]
    ds_read_b64_tr_b16 v[56:57], v105 offset:59392
    s_add_u32 s74, s68, 1032192
    s_add_u32 m0, s29, 83968
    v_mfma_f32_16x16x32_bf16 a[132:135], v[52:55], a[52:55], a[132:135]
    ds_read_b64_tr_b16 v[58:59], v105 offset:61440
    buffer_load_dwordx4 v3, s[16:19], s74 offen offset:0 lds
    s_waitcnt lgkmcnt(4)
    v_mfma_f32_16x16x32_bf16 a[136:139], v[48:51], a[40:43], a[136:139]
    ds_read_b64_tr_b16 v[60:61], v105 offset:63488
    v_mfma_f32_16x16x32_bf16 a[136:139], v[52:55], a[56:59], a[136:139]
    ds_read_b64_tr_b16 v[62:63], v106 offset:0
    s_waitcnt lgkmcnt(4)
    v_mfma_f32_16x16x32_bf16 a[140:143], v[48:51], a[44:47], a[140:143]
    ds_read_b64_tr_b16 v[64:65], v104 offset:10240
    s_add_u32 m0, s29, 92032
    v_mfma_f32_16x16x32_bf16 a[140:143], v[52:55], a[60:63], a[140:143]
    ds_read_b64_tr_b16 v[66:67], v104 offset:12288
    buffer_load_dwordx4 v3, s[16:19], s74 offen offset:128 lds
    s_waitcnt lgkmcnt(2)
    v_mfma_f32_16x16x32_bf16 v[88:91], v[56:59], a[32:35], v[88:91]
    ds_read_b64_tr_b16 v[68:69], v104 offset:14336
    v_mfma_f32_16x16x32_bf16 v[88:91], v[60:63], a[48:51], v[88:91]
    ds_read_b64_tr_b16 v[70:71], v104 offset:16384
    v_mfma_f32_16x16x32_bf16 v[92:95], v[56:59], a[36:39], v[92:95]
    v_mfma_f32_16x16x32_bf16 v[92:95], v[60:63], a[52:55], v[92:95]
    v_mfma_f32_16x16x32_bf16 v[96:99], v[56:59], a[40:43], v[96:99]
    v_mfma_f32_16x16x32_bf16 v[96:99], v[60:63], a[56:59], v[96:99]
    s_waitcnt vmcnt(9) lgkmcnt(0)
    s_barrier
    v_mfma_f32_16x16x32_bf16 v[100:103], v[56:59], a[44:47], v[100:103]
    ds_read_b128 a[0:3], v6 offset:51200
    s_add_u32 m0, s29, 9984
    v_mfma_f32_16x16x32_bf16 v[100:103], v[60:63], a[60:63], v[100:103]
    ds_read_b128 a[16:19], v6 offset:53248
    buffer_load_dwordx4 v3, s[16:19], s74 offen offset:256 lds
    v_mfma_f32_16x16x32_bf16 v[16:19], v[64:67], a[32:35], v[16:19]
    ds_read_b64_tr_b16 v[48:49], v106 offset:2048
    v_mfma_f32_16x16x32_bf16 v[16:19], v[68:71], a[48:51], v[16:19]
    ds_read_b64_tr_b16 v[50:51], v106 offset:4096
    v_mfma_f32_16x16x32_bf16 v[20:23], v[64:67], a[36:39], v[20:23]
    ds_read_b128 a[4:7], v6 offset:52224
    s_mov_b32 s75, 49152
    s_add_u32 m0, s35, 100352
    v_mfma_f32_16x16x32_bf16 v[20:23], v[68:71], a[52:55], v[20:23]
    ds_read_b128 a[20:23], v6 offset:54272
    buffer_load_dwordx4 v4, s[20:23], s75 offen offset:0 sc1 lds
    v_mfma_f32_16x16x32_bf16 v[24:27], v[64:67], a[40:43], v[24:27]
    ds_read_b64_tr_b16 v[52:53], v106 offset:6144
    v_mfma_f32_16x16x32_bf16 v[24:27], v[68:71], a[56:59], v[24:27]
    ds_read_b64_tr_b16 v[54:55], v106 offset:8192
    v_mfma_f32_16x16x32_bf16 v[28:31], v[64:67], a[44:47], v[28:31]
    ds_read_b128 a[8:11], v6 offset:55296
    v_mfma_f32_16x16x32_bf16 v[28:31], v[68:71], a[60:63], v[28:31]
    ds_read_b128 a[24:27], v6 offset:57344
    buffer_load_dwordx4 v4, s[20:23], s75 offen offset:1024 sc1 lds
    s_waitcnt lgkmcnt(2)
    v_mfma_f32_16x16x32_bf16 a[128:131], v[48:51], a[0:3], a[128:131]
    ds_read_b128 a[12:15], v6 offset:56320
    v_mfma_f32_16x16x32_bf16 a[128:131], v[52:55], a[16:19], a[128:131]
    ds_read_b128 a[28:31], v6 offset:58368
    v_mfma_f32_16x16x32_bf16 a[132:135], v[48:51], a[4:7], a[132:135]
    ds_read_b64_tr_b16 v[56:57], v106 offset:10240
    s_add_u32 s74, s68, 221184
    s_add_u32 m0, s29, 116736
    v_mfma_f32_16x16x32_bf16 a[132:135], v[52:55], a[20:23], a[132:135]
    ds_read_b64_tr_b16 v[58:59], v106 offset:12288
    buffer_load_dwordx4 v3, s[16:19], s74 offen offset:0 lds
    s_waitcnt lgkmcnt(4)
    v_mfma_f32_16x16x32_bf16 a[136:139], v[48:51], a[8:11], a[136:139]
    ds_read_b64_tr_b16 v[60:61], v106 offset:14336
    v_mfma_f32_16x16x32_bf16 a[136:139], v[52:55], a[24:27], a[136:139]
    ds_read_b64_tr_b16 v[62:63], v106 offset:16384
    s_waitcnt lgkmcnt(4)
    v_mfma_f32_16x16x32_bf16 a[140:143], v[48:51], a[12:15], a[140:143]
    ds_read_b64_tr_b16 v[64:65], v104 offset:2048
    s_add_u32 m0, s29, 124800
    v_mfma_f32_16x16x32_bf16 a[140:143], v[52:55], a[28:31], a[140:143]
    ds_read_b64_tr_b16 v[66:67], v104 offset:4096
    buffer_load_dwordx4 v3, s[16:19], s74 offen offset:128 lds
    s_waitcnt lgkmcnt(2)
    v_mfma_f32_16x16x32_bf16 v[88:91], v[56:59], a[0:3], v[88:91]
    ds_read_b64_tr_b16 v[68:69], v104 offset:6144
    v_mfma_f32_16x16x32_bf16 v[88:91], v[60:63], a[16:19], v[88:91]
    ds_read_b64_tr_b16 v[70:71], v104 offset:8192
    v_mfma_f32_16x16x32_bf16 v[92:95], v[56:59], a[4:7], v[92:95]
    v_mfma_f32_16x16x32_bf16 v[92:95], v[60:63], a[20:23], v[92:95]
    v_mfma_f32_16x16x32_bf16 v[96:99], v[56:59], a[8:11], v[96:99]
    v_mfma_f32_16x16x32_bf16 v[96:99], v[60:63], a[24:27], v[96:99]
    s_waitcnt vmcnt(9) lgkmcnt(0)
    s_barrier
    v_mfma_f32_16x16x32_bf16 v[100:103], v[56:59], a[12:15], v[100:103]
    ds_read_b128 a[32:35], v6 offset:18432
    s_add_u32 m0, s29, 1792
    v_mfma_f32_16x16x32_bf16 v[100:103], v[60:63], a[28:31], v[100:103]
    ds_read_b128 a[48:51], v6 offset:20480
    buffer_load_dwordx4 v3, s[16:19], s74 offen offset:256 lds
    v_mfma_f32_16x16x32_bf16 v[16:19], v[64:67], a[0:3], v[16:19]
    ds_read_b64_tr_b16 v[48:49], v105 offset:2048
    v_mfma_f32_16x16x32_bf16 v[16:19], v[68:71], a[16:19], v[16:19]
    ds_read_b64_tr_b16 v[50:51], v105 offset:4096
    v_mfma_f32_16x16x32_bf16 v[20:23], v[64:67], a[4:7], v[20:23]
    ds_read_b128 a[36:39], v6 offset:19456
    s_mov_b32 s75, 147456
    s_add_u32 m0, s35, 51200
    v_mfma_f32_16x16x32_bf16 v[20:23], v[68:71], a[20:23], v[20:23]
    ds_read_b128 a[52:55], v6 offset:21504
    buffer_load_dwordx4 v4, s[20:23], s75 offen offset:0 sc1 lds
    v_mfma_f32_16x16x32_bf16 v[24:27], v[64:67], a[8:11], v[24:27]
    ds_read_b64_tr_b16 v[52:53], v105 offset:6144
    v_mfma_f32_16x16x32_bf16 v[24:27], v[68:71], a[24:27], v[24:27]
    ds_read_b64_tr_b16 v[54:55], v105 offset:8192
    v_mfma_f32_16x16x32_bf16 v[28:31], v[64:67], a[12:15], v[28:31]
    ds_read_b128 a[40:43], v6 offset:22528
    v_mfma_f32_16x16x32_bf16 v[28:31], v[68:71], a[28:31], v[28:31]
    ds_read_b128 a[56:59], v6 offset:24576
    buffer_load_dwordx4 v4, s[20:23], s75 offen offset:1024 sc1 lds
    s_waitcnt lgkmcnt(2)
    v_mfma_f32_16x16x32_bf16 a[128:131], v[48:51], a[32:35], a[128:131]
    ds_read_b128 a[44:47], v6 offset:23552
    v_mfma_f32_16x16x32_bf16 a[128:131], v[52:55], a[48:51], a[128:131]
    ds_read_b128 a[60:63], v6 offset:25600
    v_mfma_f32_16x16x32_bf16 a[132:135], v[48:51], a[36:39], a[132:135]
    ds_read_b64_tr_b16 v[56:57], v105 offset:10240
    s_add_u32 s74, s68, 663552
    s_add_u32 m0, s29, 133120
    v_mfma_f32_16x16x32_bf16 a[132:135], v[52:55], a[52:55], a[132:135]
    ds_read_b64_tr_b16 v[58:59], v105 offset:12288
    buffer_load_dwordx4 v3, s[16:19], s74 offen offset:0 lds
    s_waitcnt lgkmcnt(4)
    v_mfma_f32_16x16x32_bf16 a[136:139], v[48:51], a[40:43], a[136:139]
    ds_read_b64_tr_b16 v[60:61], v105 offset:14336
    v_mfma_f32_16x16x32_bf16 a[136:139], v[52:55], a[56:59], a[136:139]
    ds_read_b64_tr_b16 v[62:63], v105 offset:16384
    s_waitcnt lgkmcnt(4)
    v_mfma_f32_16x16x32_bf16 a[140:143], v[48:51], a[44:47], a[140:143]
    ds_read_b64_tr_b16 v[64:65], v106 offset:18432
    s_add_u32 m0, s29, 141184
    v_mfma_f32_16x16x32_bf16 a[140:143], v[52:55], a[60:63], a[140:143]
    ds_read_b64_tr_b16 v[66:67], v106 offset:20480
    buffer_load_dwordx4 v3, s[16:19], s74 offen offset:128 lds
    s_cmp_eq_u32 s28, 7
    s_cbranch_scc1 L_hc5i_o
L_hc5i:
    s_waitcnt lgkmcnt(2)
    v_mfma_f32_16x16x32_bf16 v[88:91], v[56:59], a[32:35], v[88:91]
    ds_read_b64_tr_b16 v[68:69], v106 offset:22528
    v_mfma_f32_16x16x32_bf16 v[88:91], v[60:63], a[48:51], v[88:91]
    ds_read_b64_tr_b16 v[70:71], v106 offset:24576
    v_mfma_f32_16x16x32_bf16 v[92:95], v[56:59], a[36:39], v[92:95]
    v_mfma_f32_16x16x32_bf16 v[92:95], v[60:63], a[52:55], v[92:95]
    v_mfma_f32_16x16x32_bf16 v[96:99], v[56:59], a[40:43], v[96:99]
    v_mfma_f32_16x16x32_bf16 v[96:99], v[60:63], a[56:59], v[96:99]
    s_waitcnt vmcnt(9) lgkmcnt(0)
    s_barrier
    v_mfma_f32_16x16x32_bf16 v[100:103], v[56:59], a[44:47], v[100:103]
    ds_read_b128 a[0:3], v6 offset:34816
    s_add_u32 m0, s29, 149248
    v_mfma_f32_16x16x32_bf16 v[100:103], v[60:63], a[60:63], v[100:103]
    ds_read_b128 a[16:19], v6 offset:36864
    buffer_load_dwordx4 v3, s[16:19], s74 offen offset:256 lds
    v_mfma_f32_16x16x32_bf16 v[16:19], v[64:67], a[32:35], v[16:19]
    ds_read_b64_tr_b16 v[48:49], v105 offset:18432
    v_mfma_f32_16x16x32_bf16 v[16:19], v[68:71], a[48:51], v[16:19]
    ds_read_b64_tr_b16 v[50:51], v105 offset:20480
    v_mfma_f32_16x16x32_bf16 v[20:23], v[64:67], a[36:39], v[20:23]
    ds_read_b128 a[4:7], v6 offset:35840
    s_mov_b32 s75, 245760
    s_add_u32 m0, s35, 18432
    v_mfma_f32_16x16x32_bf16 v[20:23], v[68:71], a[52:55], v[20:23]
    ds_read_b128 a[20:23], v6 offset:37888
    buffer_load_dwordx4 v4, s[20:23], s75 offen offset:0 sc1 lds
    v_mfma_f32_16x16x32_bf16 v[24:27], v[64:67], a[40:43], v[24:27]
    ds_read_b64_tr_b16 v[52:53], v105 offset:22528
    v_mfma_f32_16x16x32_bf16 v[24:27], v[68:71], a[56:59], v[24:27]
    ds_read_b64_tr_b16 v[54:55], v105 offset:24576
    v_mfma_f32_16x16x32_bf16 v[28:31], v[64:67], a[44:47], v[28:31]
    ds_read_b128 a[8:11], v6 offset:38912
    v_mfma_f32_16x16x32_bf16 v[28:31], v[68:71], a[60:63], v[28:31]
    ds_read_b128 a[24:27], v6 offset:40960
    buffer_load_dwordx4 v4, s[20:23], s75 offen offset:1024 sc1 lds
    s_waitcnt lgkmcnt(2)
    v_mfma_f32_16x16x32_bf16 a[128:131], v[48:51], a[0:3], a[128:131]
    ds_read_b128 a[12:15], v6 offset:39936
    v_mfma_f32_16x16x32_bf16 a[128:131], v[52:55], a[16:19], a[128:131]
    ds_read_b128 a[28:31], v6 offset:41984
    v_mfma_f32_16x16x32_bf16 a[132:135], v[48:51], a[4:7], a[132:135]
    ds_read_b64_tr_b16 v[56:57], v105 offset:26624
    s_add_u32 s74, s68, 1105920
    s_add_u32 m0, s29, 67584
    v_mfma_f32_16x16x32_bf16 a[132:135], v[52:55], a[20:23], a[132:135]
    ds_read_b64_tr_b16 v[58:59], v105 offset:28672
    buffer_load_dwordx4 v3, s[16:19], s74 offen offset:0 lds
    s_waitcnt lgkmcnt(4)
    v_mfma_f32_16x16x32_bf16 a[136:139], v[48:51], a[8:11], a[136:139]
    ds_read_b64_tr_b16 v[60:61], v105 offset:30720
    v_mfma_f32_16x16x32_bf16 a[136:139], v[52:55], a[24:27], a[136:139]
    ds_read_b64_tr_b16 v[62:63], v105 offset:32768
    s_waitcnt lgkmcnt(4)
    v_mfma_f32_16x16x32_bf16 a[140:143], v[48:51], a[12:15], a[140:143]
    ds_read_b64_tr_b16 v[64:65], v104 offset:10240
    s_add_u32 m0, s29, 75648
    v_mfma_f32_16x16x32_bf16 a[140:143], v[52:55], a[28:31], a[140:143]
    ds_read_b64_tr_b16 v[66:67], v104 offset:12288
    buffer_load_dwordx4 v3, s[16:19], s74 offen offset:128 lds
    s_waitcnt lgkmcnt(2)
    v_mfma_f32_16x16x32_bf16 v[88:91], v[56:59], a[0:3], v[88:91]
    ds_read_b64_tr_b16 v[68:69], v104 offset:14336
    v_mfma_f32_16x16x32_bf16 v[88:91], v[60:63], a[16:19], v[88:91]
    ds_read_b64_tr_b16 v[70:71], v104 offset:16384
    v_mfma_f32_16x16x32_bf16 v[92:95], v[56:59], a[4:7], v[92:95]
    v_mfma_f32_16x16x32_bf16 v[92:95], v[60:63], a[20:23], v[92:95]
    v_mfma_f32_16x16x32_bf16 v[96:99], v[56:59], a[8:11], v[96:99]
    v_mfma_f32_16x16x32_bf16 v[96:99], v[60:63], a[24:27], v[96:99]
    s_cmp_eq_u32 s28, 7
    s_cbranch_scc1 L_hc5c_o
L_hc5c:
    s_waitcnt vmcnt(9) lgkmcnt(0)
    s_barrier
    v_mfma_f32_16x16x32_bf16 v[100:103], v[56:59], a[12:15], v[100:103]
    ds_read_b128 a[32:35], v7 offset:34816
    s_add_u32 m0, s29, 9984
    v_mfma_f32_16x16x32_bf16 v[100:103], v[60:63], a[28:31], v[100:103]
    ds_read_b128 a[48:51], v7 offset:36864
    buffer_load_dwordx4 v3, s[16:19], s74 offen offset:256 lds
    v_mfma_f32_16x16x32_bf16 v[16:19], v[64:67], a[0:3], v[16:19]
    ds_read_b64_tr_b16 v[48:49], v105 offset:51200
    v_mfma_f32_16x16x32_bf16 v[16:19], v[68:71], a[16:19], v[16:19]
    ds_read_b64_tr_b16 v[50:51], v105 offset:53248
    v_mfma_f32_16x16x32_bf16 v[20:23], v[64:67], a[4:7], v[20:23]
    ds_read_b128 a[36:39], v7 offset:35840
    s_mov_b32 s75, 65536
    s_add_u32 m0, s35, 34816
    v_mfma_f32_16x16x32_bf16 v[20:23], v[68:71], a[20:23], v[20:23]
    ds_read_b128 a[52:55], v7 offset:37888
    buffer_load_dwordx4 v4, s[20:23], s75 offen offset:0 sc1 lds
    v_mfma_f32_16x16x32_bf16 v[24:27], v[64:67], a[8:11], v[24:27]
    ds_read_b64_tr_b16 v[52:53], v105 offset:55296
    v_mfma_f32_16x16x32_bf16 v[24:27], v[68:71], a[24:27], v[24:27]
    ds_read_b64_tr_b16 v[54:55], v105 offset:57344
    v_mfma_f32_16x16x32_bf16 v[28:31], v[64:67], a[12:15], v[28:31]
    ds_read_b128 a[40:43], v7 offset:38912
    v_mfma_f32_16x16x32_bf16 v[28:31], v[68:71], a[28:31], v[28:31]
    ds_read_b128 a[56:59], v7 offset:40960
    buffer_load_dwordx4 v4, s[20:23], s75 offen offset:1024 sc1 lds
    s_waitcnt lgkmcnt(2)
    v_mfma_f32_16x16x32_bf16 a[128:131], v[48:51], a[32:35], a[128:131]
    ds_read_b128 a[44:47], v7 offset:39936
    v_mfma_f32_16x16x32_bf16 a[128:131], v[52:55], a[48:51], a[128:131]
    ds_read_b128 a[60:63], v7 offset:41984
    v_mfma_f32_16x16x32_bf16 a[132:135], v[48:51], a[36:39], a[132:135]
    ds_read_b64_tr_b16 v[56:57], v105 offset:59392
    s_add_u32 s74, s68, 294912
    s_add_u32 m0, s29, 83968
    v_mfma_f32_16x16x32_bf16 a[132:135], v[52:55], a[52:55], a[132:135]
    ds_read_b64_tr_b16 v[58:59], v105 offset:61440
    buffer_load_dwordx4 v3, s[16:19], s74 offen offset:0 lds
    s_waitcnt lgkmcnt(4)
    v_mfma_f32_16x16x32_bf16 a[136:139], v[48:51], a[40:43], a[136:139]
    ds_read_b64_tr_b16 v[60:61], v105 offset:63488
    v_mfma_f32_16x16x32_bf16 a[136:139], v[52:55], a[56:59], a[136:139]
    ds_read_b64_tr_b16 v[62:63], v106 offset:0
    s_waitcnt lgkmcnt(4)
    v_mfma_f32_16x16x32_bf16 a[140:143], v[48:51], a[44:47], a[140:143]
    ds_read_b64_tr_b16 v[64:65], v104 offset:2048
    s_add_u32 m0, s29, 92032
    v_mfma_f32_16x16x32_bf16 a[140:143], v[52:55], a[60:63], a[140:143]
    ds_read_b64_tr_b16 v[66:67], v104 offset:4096
    buffer_load_dwordx4 v3, s[16:19], s74 offen offset:128 lds
    s_waitcnt lgkmcnt(2)
    v_mfma_f32_16x16x32_bf16 v[88:91], v[56:59], a[32:35], v[88:91]
    ds_read_b64_tr_b16 v[68:69], v104 offset:6144
    v_mfma_f32_16x16x32_bf16 v[88:91], v[60:63], a[48:51], v[88:91]
    ds_read_b64_tr_b16 v[70:71], v104 offset:8192
    v_mfma_f32_16x16x32_bf16 v[92:95], v[56:59], a[36:39], v[92:95]
    v_mfma_f32_16x16x32_bf16 v[92:95], v[60:63], a[52:55], v[92:95]
    v_mfma_f32_16x16x32_bf16 v[96:99], v[56:59], a[40:43], v[96:99]
    v_mfma_f32_16x16x32_bf16 v[96:99], v[60:63], a[56:59], v[96:99]
    s_waitcnt vmcnt(9) lgkmcnt(0)
    s_barrier
    v_mfma_f32_16x16x32_bf16 v[100:103], v[56:59], a[44:47], v[100:103]
    ds_read_b128 a[0:3], v6 offset:51200
    s_add_u32 m0, s29, 1792
    v_mfma_f32_16x16x32_bf16 v[100:103], v[60:63], a[60:63], v[100:103]
    ds_read_b128 a[16:19], v6 offset:53248
    buffer_load_dwordx4 v3, s[16:19], s74 offen offset:256 lds
    v_mfma_f32_16x16x32_bf16 v[16:19], v[64:67], a[32:35], v[16:19]
    ds_read_b64_tr_b16 v[48:49], v106 offset:2048
    v_mfma_f32_16x16x32_bf16 v[16:19], v[68:71], a[48:51], v[16:19]
    ds_read_b64_tr_b16 v[50:51], v106 offset:4096
    v_mfma_f32_16x16x32_bf16 v[20:23], v[64:67], a[36:39], v[20:23]
    ds_read_b128 a[4:7], v6 offset:52224
    s_mov_b32 s75, 163840
    s_add_u32 m0, s35, 100352
    v_mfma_f32_16x16x32_bf16 v[20:23], v[68:71], a[52:55], v[20:23]
    ds_read_b128 a[20:23], v6 offset:54272
    buffer_load_dwordx4 v4, s[20:23], s75 offen offset:0 sc1 lds
    v_mfma_f32_16x16x32_bf16 v[24:27], v[64:67], a[40:43], v[24:27]
    ds_read_b64_tr_b16 v[52:53], v106 offset:6144
    v_mfma_f32_16x16x32_bf16 v[24:27], v[68:71], a[56:59], v[24:27]
    ds_read_b64_tr_b16 v[54:55], v106 offset:8192
    v_mfma_f32_16x16x32_bf16 v[28:31], v[64:67], a[44:47], v[28:31]
    ds_read_b128 a[8:11], v6 offset:55296
    v_mfma_f32_16x16x32_bf16 v[28:31], v[68:71], a[60:63], v[28:31]
    ds_read_b128 a[24:27], v6 offset:57344
    buffer_load_dwordx4 v4, s[20:23], s75 offen offset:1024 sc1 lds
    s_waitcnt lgkmcnt(2)
    v_mfma_f32_16x16x32_bf16 a[128:131], v[48:51], a[0:3], a[128:131]
    ds_read_b128 a[12:15], v6 offset:56320
    v_mfma_f32_16x16x32_bf16 a[128:131], v[52:55], a[16:19], a[128:131]
    ds_read_b128 a[28:31], v6 offset:58368
    v_mfma_f32_16x16x32_bf16 a[132:135], v[48:51], a[4:7], a[132:135]
    ds_read_b64_tr_b16 v[56:57], v106 offset:10240
    s_add_u32 s74, s68, 737280
    s_add_u32 m0, s29, 116736
    v_mfma_f32_16x16x32_bf16 a[132:135], v[52:55], a[20:23], a[132:135]
    ds_read_b64_tr_b16 v[58:59], v106 offset:12288
    buffer_load_dwordx4 v3, s[16:19], s74 offen offset:0 lds
    s_waitcnt lgkmcnt(4)
    v_mfma_f32_16x16x32_bf16 a[136:139], v[48:51], a[8:11], a[136:139]
    ds_read_b64_tr_b16 v[60:61], v106 offset:14336
    v_mfma_f32_16x16x32_bf16 a[136:139], v[52:55], a[24:27], a[136:139]
    ds_read_b64_tr_b16 v[62:63], v106 offset:16384
    s_waitcnt lgkmcnt(4)
    v_mfma_f32_16x16x32_bf16 a[140:143], v[48:51], a[12:15], a[140:143]
    ds_read_b64_tr_b16 v[64:65], v106 offset:18432
    s_add_u32 m0, s29, 124800
    v_mfma_f32_16x16x32_bf16 a[140:143], v[52:55], a[28:31], a[140:143]
    ds_read_b64_tr_b16 v[66:67], v106 offset:20480
    buffer_load_dwordx4 v3, s[16:19], s74 offen offset:128 lds
    s_waitcnt lgkmcnt(2)
    v_mfma_f32_16x16x32_bf16 v[88:91], v[56:59], a[0:3], v[88:91]
    ds_read_b64_tr_b16 v[68:69], v106 offset:22528
    v_mfma_f32_16x16x32_bf16 v[88:91], v[60:63], a[16:19], v[88:91]
    ds_read_b64_tr_b16 v[70:71], v106 offset:24576
    v_mfma_f32_16x16x32_bf16 v[92:95], v[56:59], a[4:7], v[92:95]
    v_mfma_f32_16x16x32_bf16 v[92:95], v[60:63], a[20:23], v[92:95]
    v_mfma_f32_16x16x32_bf16 v[96:99], v[56:59], a[8:11], v[96:99]
    v_mfma_f32_16x16x32_bf16 v[96:99], v[60:63], a[24:27], v[96:99]
    s_waitcnt vmcnt(9) lgkmcnt(0)
    s_barrier
    v_mfma_f32_16x16x32_bf16 v[100:103], v[56:59], a[12:15], v[100:103]
    ds_read_b128 a[32:35], v6 offset:18432
    s_add_u32 m0, s29, 149248
    v_mfma_f32_16x16x32_bf16 v[100:103], v[60:63], a[28:31], v[100:103]
    ds_read_b128 a[48:51], v6 offset:20480
    buffer_load_dwordx4 v3, s[16:19], s74 offen offset:256 lds
    v_mfma_f32_16x16x32_bf16 v[16:19], v[64:67], a[0:3], v[16:19]
    ds_read_b64_tr_b16 v[48:49], v105 offset:2048
    v_mfma_f32_16x16x32_bf16 v[16:19], v[68:71], a[16:19], v[16:19]
    ds_read_b64_tr_b16 v[50:51], v105 offset:4096
    v_mfma_f32_16x16x32_bf16 v[20:23], v[64:67], a[4:7], v[20:23]
    ds_read_b128 a[36:39], v6 offset:19456
    s_mov_b32 s75, 262144
    s_add_u32 m0, s35, 51200
    v_mfma_f32_16x16x32_bf16 v[20:23], v[68:71], a[20:23], v[20:23]
    ds_read_b128 a[52:55], v6 offset:21504
    buffer_load_dwordx4 v4, s[20:23], s75 offen offset:0 sc1 lds
    v_mfma_f32_16x16x32_bf16 v[24:27], v[64:67], a[8:11], v[24:27]
    ds_read_b64_tr_b16 v[52:53], v105 offset:6144
    v_mfma_f32_16x16x32_bf16 v[24:27], v[68:71], a[24:27], v[24:27]
    ds_read_b64_tr_b16 v[54:55], v105 offset:8192
    v_mfma_f32_16x16x32_bf16 v[28:31], v[64:67], a[12:15], v[28:31]
    ds_read_b128 a[40:43], v6 offset:22528
    v_mfma_f32_16x16x32_bf16 v[28:31], v[68:71], a[28:31], v[28:31]
    ds_read_b128 a[56:59], v6 offset:24576
    buffer_load_dwordx4 v4, s[20:23], s75 offen offset:1024 sc1 lds
    s_waitcnt lgkmcnt(2)
    v_mfma_f32_16x16x32_bf16 a[128:131], v[48:51], a[32:35], a[128:131]
    ds_read_b128 a[44:47], v6 offset:23552
    v_mfma_f32_16x16x32_bf16 a[128:131], v[52:55], a[48:51], a[128:131]
    ds_read_b128 a[60:63], v6 offset:25600
    v_mfma_f32_16x16x32_bf16 a[132:135], v[48:51], a[36:39], a[132:135]
    ds_read_b64_tr_b16 v[56:57], v105 offset:10240
    s_add_u32 s74, s68, 1179648
    s_add_u32 m0, s29, 133120
    v_mfma_f32_16x16x32_bf16 a[132:135], v[52:55], a[52:55], a[132:135]
    ds_read_b64_tr_b16 v[58:59], v105 offset:12288
    buffer_load_dwordx4 v3, s[16:19], s74 offen offset:0 lds
    s_waitcnt lgkmcnt(4)
    v_mfma_f32_16x16x32_bf16 a[136:139], v[48:51], a[40:43], a[136:139]
    ds_read_b64_tr_b16 v[60:61], v105 offset:14336
    v_mfma_f32_16x16x32_bf16 a[136:139], v[52:55], a[56:59], a[136:139]
    ds_read_b64_tr_b16 v[62:63], v105 offset:16384
    s_waitcnt lgkmcnt(4)
    v_mfma_f32_16x16x32_bf16 a[140:143], v[48:51], a[44:47], a[140:143]
    ds_read_b64_tr_b16 v[64:65], v104 offset:10240
    s_add_u32 m0, s29, 141184
    v_mfma_f32_16x16x32_bf16 a[140:143], v[52:55], a[60:63], a[140:143]
    ds_read_b64_tr_b16 v[66:67], v104 offset:12288
    buffer_load_dwordx4 v3, s[16:19], s74 offen offset:128 lds
    s_waitcnt lgkmcnt(2)
    v_mfma_f32_16x16x32_bf16 v[88:91], v[56:59], a[32:35], v[88:91]
    ds_read_b64_tr_b16 v[68:69], v104 offset:14336
    v_mfma_f32_16x16x32_bf16 v[88:91], v[60:63], a[48:51], v[88:91]
    ds_read_b64_tr_b16 v[70:71], v104 offset:16384
    v_mfma_f32_16x16x32_bf16 v[92:95], v[56:59], a[36:39], v[92:95]
    v_mfma_f32_16x16x32_bf16 v[92:95], v[60:63], a[52:55], v[92:95]
    v_mfma_f32_16x16x32_bf16 v[96:99], v[56:59], a[40:43], v[96:99]
    v_mfma_f32_16x16x32_bf16 v[96:99], v[60:63], a[56:59], v[96:99]
    s_waitcnt vmcnt(9) lgkmcnt(0)
    s_barrier
    v_mfma_f32_16x16x32_bf16 v[100:103], v[56:59], a[44:47], v[100:103]
    ds_read_b128 a[0:3], v6 offset:34816
    s_add_u32 m0, s29, 9984
    v_mfma_f32_16x16x32_bf16 v[100:103], v[60:63], a[60:63], v[100:103]
    ds_read_b128 a[16:19], v6 offset:36864
    buffer_load_dwordx4 v3, s[16:19], s74 offen offset:256 lds
    v_mfma_f32_16x16x32_bf16 v[16:19], v[64:67], a[32:35], v[16:19]
    ds_read_b64_tr_b16 v[48:49], v105 offset:18432
    v_mfma_f32_16x16x32_bf16 v[16:19], v[68:71], a[48:51], v[16:19]
    ds_read_b64_tr_b16 v[50:51], v105 offset:20480
    v_mfma_f32_16x16x32_bf16 v[20:23], v[64:67], a[36:39], v[20:23]
    ds_read_b128 a[4:7], v6 offset:35840
    s_mov_b32 s75, 81920
    s_add_u32 m0, s35, 18432
    v_mfma_f32_16x16x32_bf16 v[20:23], v[68:71], a[52:55], v[20:23]
    ds_read_b128 a[20:23], v6 offset:37888
    buffer_load_dwordx4 v4, s[20:23], s75 offen offset:0 sc1 lds
    v_mfma_f32_16x16x32_bf16 v[24:27], v[64:67], a[40:43], v[24:27]
    ds_read_b64_tr_b16 v[52:53], v105 offset:22528
    v_mfma_f32_16x16x32_bf16 v[24:27], v[68:71], a[56:59], v[24:27]
    ds_read_b64_tr_b16 v[54:55], v105 offset:24576
    v_mfma_f32_16x16x32_bf16 v[28:31], v[64:67], a[44:47], v[28:31]
    ds_read_b128 a[8:11], v6 offset:38912
    v_mfma_f32_16x16x32_bf16 v[28:31], v[68:71], a[60:63], v[28:31]
    ds_read_b128 a[24:27], v6 offset:40960
    buffer_load_dwordx4 v4, s[20:23], s75 offen offset:1024 sc1 lds
    s_waitcnt lgkmcnt(2)
    v_mfma_f32_16x16x32_bf16 a[128:131], v[48:51], a[0:3], a[128:131]
    ds_read_b128 a[12:15], v6 offset:39936
    v_mfma_f32_16x16x32_bf16 a[128:131], v[52:55], a[16:19], a[128:131]
    ds_read_b128 a[28:31], v6 offset:41984
    v_mfma_f32_16x16x32_bf16 a[132:135], v[48:51], a[4:7], a[132:135]
    ds_read_b64_tr_b16 v[56:57], v105 offset:26624
    s_add_u32 s74, s68, 368640
    s_add_u32 m0, s29, 67584
    v_mfma_f32_16x16x32_bf16 a[132:135], v[52:55], a[20:23], a[132:135]
    ds_read_b64_tr_b16 v[58:59], v105 offset:28672
    buffer_load_dwordx4 v3, s[16:19], s74 offen offset:0 lds
    s_waitcnt lgkmcnt(4)
    v_mfma_f32_16x16x32_bf16 a[136:139], v[48:51], a[8:11], a[136:139]
    ds_read_b64_tr_b16 v[60:61], v105 offset:30720
    v_mfma_f32_16x16x32_bf16 a[136:139], v[52:55], a[24:27], a[136:139]
    ds_read_b64_tr_b16 v[62:63], v105 offset:32768
    s_waitcnt lgkmcnt(4)
    v_mfma_f32_16x16x32_bf16 a[140:143], v[48:51], a[12:15], a[140:143]
    ds_read_b64_tr_b16 v[64:65], v104 offset:2048
    s_add_u32 m0, s29, 75648
    v_mfma_f32_16x16x32_bf16 a[140:143], v[52:55], a[28:31], a[140:143]
    ds_read_b64_tr_b16 v[66:67], v104 offset:4096
    buffer_load_dwordx4 v3, s[16:19], s74 offen offset:128 lds
    s_waitcnt lgkmcnt(2)
    v_mfma_f32_16x16x32_bf16 v[88:91], v[56:59], a[0:3], v[88:91]
    ds_read_b64_tr_b16 v[68:69], v104 offset:6144
    v_mfma_f32_16x16x32_bf16 v[88:91], v[60:63], a[16:19], v[88:91]
    ds_read_b64_tr_b16 v[70:71], v104 offset:8192
    v_mfma_f32_16x16x32_bf16 v[92:95], v[56:59], a[4:7], v[92:95]
    v_mfma_f32_16x16x32_bf16 v[92:95], v[60:63], a[20:23], v[92:95]
    v_mfma_f32_16x16x32_bf16 v[96:99], v[56:59], a[8:11], v[96:99]
    v_mfma_f32_16x16x32_bf16 v[96:99], v[60:63], a[24:27], v[96:99]
    s_waitcnt vmcnt(9) lgkmcnt(0)
    s_barrier
    v_mfma_f32_16x16x32_bf16 v[100:103], v[56:59], a[12:15], v[100:103]
    ds_read_b128 a[32:35], v7 offset:34816
    s_add_u32 m0, s29, 1792
    v_mfma_f32_16x16x32_bf16 v[100:103], v[60:63], a[28:31], v[100:103]
    ds_read_b128 a[48:51], v7 offset:36864
    buffer_load_dwordx4 v3, s[16:19], s74 offen offset:256 lds
    v_mfma_f32_16x16x32_bf16 v[16:19], v[64:67], a[0:3], v[16:19]
    ds_read_b64_tr_b16 v[48:49], v105 offset:51200
    v_mfma_f32_16x16x32_bf16 v[16:19], v[68:71], a[16:19], v[16:19]
    ds_read_b64_tr_b16 v[50:51], v105 offset:53248
    v_mfma_f32_16x16x32_bf16 v[20:23], v[64:67], a[4:7], v[20:23]
    ds_read_b128 a[36:39], v7 offset:35840
    s_mov_b32 s75, 180224
    s_add_u32 m0, s35, 34816
    v_mfma_f32_16x16x32_bf16 v[20:23], v[68:71], a[20:23], v[20:23]
    ds_read_b128 a[52:55], v7 offset:37888
    buffer_load_dwordx4 v4, s[20:23], s75 offen offset:0 sc1 lds
    v_mfma_f32_16x16x32_bf16 v[24:27], v[64:67], a[8:11], v[24:27]
    ds_read_b64_tr_b16 v[52:53], v105 offset:55296
    v_mfma_f32_16x16x32_bf16 v[24:27], v[68:71], a[24:27], v[24:27]
    ds_read_b64_tr_b16 v[54:55], v105 offset:57344
    v_mfma_f32_16x16x32_bf16 v[28:31], v[64:67], a[12:15], v[28:31]
    ds_read_b128 a[40:43], v7 offset:38912
    v_mfma_f32_16x16x32_bf16 v[28:31], v[68:71], a[28:31], v[28:31]
    ds_read_b128 a[56:59], v7 offset:40960
    buffer_load_dwordx4 v4, s[20:23], s75 offen offset:1024 sc1 lds
    s_waitcnt lgkmcnt(2)
    v_mfma_f32_16x16x32_bf16 a[128:131], v[48:51], a[32:35], a[128:131]
    ds_read_b128 a[44:47], v7 offset:39936
    v_mfma_f32_16x16x32_bf16 a[128:131], v[52:55], a[48:51], a[128:131]
    ds_read_b128 a[60:63], v7 offset:41984
    v_mfma_f32_16x16x32_bf16 a[132:135], v[48:51], a[36:39], a[132:135]
    ds_read_b64_tr_b16 v[56:57], v105 offset:59392
    s_add_u32 s74, s68, 811008
    s_add_u32 m0, s29, 83968
    v_mfma_f32_16x16x32_bf16 a[132:135], v[52:55], a[52:55], a[132:135]
    ds_read_b64_tr_b16 v[58:59], v105 offset:61440
    buffer_load_dwordx4 v3, s[16:19], s74 offen offset:0 lds
    s_waitcnt lgkmcnt(4)
    v_mfma_f32_16x16x32_bf16 a[136:139], v[48:51], a[40:43], a[136:139]
    ds_read_b64_tr_b16 v[60:61], v105 offset:63488
    v_mfma_f32_16x16x32_bf16 a[136:139], v[52:55], a[56:59], a[136:139]
    ds_read_b64_tr_b16 v[62:63], v106 offset:0
    s_waitcnt lgkmcnt(4)
    v_mfma_f32_16x16x32_bf16 a[140:143], v[48:51], a[44:47], a[140:143]
    ds_read_b64_tr_b16 v[64:65], v106 offset:18432
    s_add_u32 m0, s29, 92032
    v_mfma_f32_16x16x32_bf16 a[140:143], v[52:55], a[60:63], a[140:143]
    ds_read_b64_tr_b16 v[66:67], v106 offset:20480
    buffer_load_dwordx4 v3, s[16:19], s74 offen offset:128 lds
    s_cmp_eq_u32 s28, 7
    s_cbranch_scc1 L_oci_o
L_oci:
    s_waitcnt lgkmcnt(2)
    v_mfma_f32_16x16x32_bf16 v[88:91], v[56:59], a[32:35], v[88:91]
    ds_read_b64_tr_b16 v[68:69], v106 offset:22528
    v_mfma_f32_16x16x32_bf16 v[88:91], v[60:63], a[48:51], v[88:91]
    ds_read_b64_tr_b16 v[70:71], v106 offset:24576
    v_mfma_f32_16x16x32_bf16 v[92:95], v[56:59], a[36:39], v[92:95]
    v_mfma_f32_16x16x32_bf16 v[92:95], v[60:63], a[52:55], v[92:95]
    v_mfma_f32_16x16x32_bf16 v[96:99], v[56:59], a[40:43], v[96:99]
    v_mfma_f32_16x16x32_bf16 v[96:99], v[60:63], a[56:59], v[96:99]
    s_waitcnt vmcnt(9) lgkmcnt(0)
    s_barrier
    v_mfma_f32_16x16x32_bf16 v[100:103], v[56:59], a[44:47], v[100:103]
    ds_read_b128 a[0:3], v6 offset:51200
    s_add_u32 m0, s29, 149248
    v_mfma_f32_16x16x32_bf16 v[100:103], v[60:63], a[60:63], v[100:103]
    ds_read_b128 a[16:19], v6 offset:53248
    buffer_load_dwordx4 v3, s[16:19], s74 offen offset:256 lds
    v_mfma_f32_16x16x32_bf16 v[16:19], v[64:67], a[32:35], v[16:19]
    ds_read_b64_tr_b16 v[48:49], v106 offset:2048
    v_mfma_f32_16x16x32_bf16 v[16:19], v[68:71], a[48:51], v[16:19]
    ds_read_b64_tr_b16 v[50:51], v106 offset:4096
    v_mfma_f32_16x16x32_bf16 v[20:23], v[64:67], a[36:39], v[20:23]
    ds_read_b128 a[4:7], v6 offset:52224
    s_mov_b32 s75, 278528
    s_add_u32 m0, s35, 100352
    v_mfma_f32_16x16x32_bf16 v[20:23], v[68:71], a[52:55], v[20:23]
    ds_read_b128 a[20:23], v6 offset:54272
    buffer_load_dwordx4 v4, s[20:23], s75 offen offset:0 sc1 lds
    v_mfma_f32_16x16x32_bf16 v[24:27], v[64:67], a[40:43], v[24:27]
    ds_read_b64_tr_b16 v[52:53], v106 offset:6144
    v_mfma_f32_16x16x32_bf16 v[24:27], v[68:71], a[56:59], v[24:27]
    ds_read_b64_tr_b16 v[54:55], v106 offset:8192
    v_mfma_f32_16x16x32_bf16 v[28:31], v[64:67], a[44:47], v[28:31]
    ds_read_b128 a[8:11], v6 offset:55296
    v_mfma_f32_16x16x32_bf16 v[28:31], v[68:71], a[60:63], v[28:31]
    ds_read_b128 a[24:27], v6 offset:57344
    buffer_load_dwordx4 v4, s[20:23], s75 offen offset:1024 sc1 lds
    s_waitcnt lgkmcnt(2)
    v_mfma_f32_16x16x32_bf16 a[128:131], v[48:51], a[0:3], a[128:131]
    ds_read_b128 a[12:15], v6 offset:56320
    v_mfma_f32_16x16x32_bf16 a[128:131], v[52:55], a[16:19], a[128:131]
    ds_read_b128 a[28:31], v6 offset:58368
    v_mfma_f32_16x16x32_bf16 a[132:135], v[48:51], a[4:7], a[132:135]
    ds_read_b64_tr_b16 v[56:57], v106 offset:10240
    s_add_u32 s74, s68, 1253376
    s_add_u32 m0, s29, 116736
    v_mfma_f32_16x16x32_bf16 a[132:135], v[52:55], a[20:23], a[132:135]
    ds_read_b64_tr_b16 v[58:59], v106 offset:12288
    buffer_load_dwordx4 v3, s[16:19], s74 offen offset:0 lds
    s_waitcnt lgkmcnt(4)
    v_mfma_f32_16x16x32_bf16 a[136:139], v[48:51], a[8:11], a[136:139]
    ds_read_b64_tr_b16 v[60:61], v106 offset:14336
    v_mfma_f32_16x16x32_bf16 a[136:139], v[52:55], a[24:27], a[136:139]
    ds_read_b64_tr_b16 v[62:63], v106 offset:16384
    s_waitcnt lgkmcnt(4)
    v_mfma_f32_16x16x32_bf16 a[140:143], v[48:51], a[12:15], a[140:143]
    ds_read_b64_tr_b16 v[64:65], v104 offset:10240
    s_add_u32 m0, s29, 124928
    v_mfma_f32_16x16x32_bf16 a[140:143], v[52:55], a[28:31], a[140:143]
    ds_read_b64_tr_b16 v[66:67], v104 offset:12288
    buffer_load_dwordx4 v3, s[8:11], s69 offen offset:0 lds
    s_waitcnt lgkmcnt(2)
    v_mfma_f32_16x16x32_bf16 v[88:91], v[56:59], a[0:3], v[88:91]
    ds_read_b64_tr_b16 v[68:69], v104 offset:14336
    v_mfma_f32_16x16x32_bf16 v[88:91], v[60:63], a[16:19], v[88:91]
    ds_read_b64_tr_b16 v[70:71], v104 offset:16384
    v_mfma_f32_16x16x32_bf16 v[92:95], v[56:59], a[4:7], v[92:95]
    v_mfma_f32_16x16x32_bf16 v[92:95], v[60:63], a[20:23], v[92:95]
    v_mfma_f32_16x16x32_bf16 v[96:99], v[56:59], a[8:11], v[96:99]
    v_mfma_f32_16x16x32_bf16 v[96:99], v[60:63], a[24:27], v[96:99]
    s_cmp_eq_u32 s28, 7
    s_cbranch_scc1 L_occ_o
L_occ:
    s_waitcnt vmcnt(9) lgkmcnt(0)
    s_barrier
    v_mfma_f32_16x16x32_bf16 v[100:103], v[56:59], a[12:15], v[100:103]
    ds_read_b128 a[32:35], v6 offset:18432
    s_add_u32 m0, s29, 10240
    v_mfma_f32_16x16x32_bf16 v[100:103], v[60:63], a[28:31], v[100:103]
    ds_read_b128 a[48:51], v6 offset:20480
    buffer_load_dwordx4 v3, s[8:11], s70 offen offset:0 lds
    v_mfma_f32_16x16x32_bf16 v[16:19], v[64:67], a[0:3], v[16:19]
    ds_read_b64_tr_b16 v[48:49], v105 offset:2048
    v_mfma_f32_16x16x32_bf16 v[16:19], v[68:71], a[16:19], v[16:19]
    ds_read_b64_tr_b16 v[50:51], v105 offset:4096
    v_mfma_f32_16x16x32_bf16 v[20:23], v[64:67], a[4:7], v[20:23]
    ds_read_b128 a[36:39], v6 offset:19456
    s_add_u32 m0, s29, 51200
    v_mfma_f32_16x16x32_bf16 v[20:23], v[68:71], a[20:23], v[20:23]
    ds_read_b128 a[52:55], v6 offset:21504
    buffer_load_dwordx4 v3, s[8:11], s71 offen offset:0 lds
    v_mfma_f32_16x16x32_bf16 v[24:27], v[64:67], a[8:11], v[24:27]
    ds_read_b64_tr_b16 v[52:53], v105 offset:6144
    v_mfma_f32_16x16x32_bf16 v[24:27], v[68:71], a[24:27], v[24:27]
    ds_read_b64_tr_b16 v[54:55], v105 offset:8192
    v_mfma_f32_16x16x32_bf16 v[28:31], v[64:67], a[12:15], v[28:31]
    ds_read_b128 a[40:43], v6 offset:22528
    s_mov_b32 s75, 294912
    s_add_u32 m0, s35, 133120
    v_mfma_f32_16x16x32_bf16 v[28:31], v[68:71], a[28:31], v[28:31]
    ds_read_b128 a[56:59], v6 offset:24576
    buffer_load_dwordx4 v4, s[20:23], s75 offen offset:0 sc1 lds
    s_waitcnt lgkmcnt(2)
    v_mfma_f32_16x16x32_bf16 a[128:131], v[48:51], a[32:35], a[128:131]
    ds_read_b128 a[44:47], v6 offset:23552
    v_mfma_f32_16x16x32_bf16 a[128:131], v[52:55], a[48:51], a[128:131]
    ds_read_b128 a[60:63], v6 offset:25600
    v_mfma_f32_16x16x32_bf16 a[132:135], v[48:51], a[36:39], a[132:135]
    ds_read_b64_tr_b16 v[56:57], v105 offset:10240
    v_mfma_f32_16x16x32_bf16 a[132:135], v[52:55], a[52:55], a[132:135]
    ds_read_b64_tr_b16 v[58:59], v105 offset:12288
    buffer_load_dwordx4 v4, s[20:23], s75 offen offset:1024 sc1 lds
    s_waitcnt lgkmcnt(4)
    v_mfma_f32_16x16x32_bf16 a[136:139], v[48:51], a[40:43], a[136:139]
    ds_read_b64_tr_b16 v[60:61], v105 offset:14336
    v_mfma_f32_16x16x32_bf16 a[136:139], v[52:55], a[56:59], a[136:139]
    ds_read_b64_tr_b16 v[62:63], v105 offset:16384
    s_waitcnt lgkmcnt(4)
    v_mfma_f32_16x16x32_bf16 a[140:143], v[48:51], a[44:47], a[140:143]
    ds_read_b64_tr_b16 v[64:65], v104 offset:2048
    v_mfma_f32_16x16x32_bf16 a[140:143], v[52:55], a[60:63], a[140:143]
    ds_read_b64_tr_b16 v[66:67], v104 offset:4096
    s_waitcnt lgkmcnt(2)
    v_mfma_f32_16x16x32_bf16 v[88:91], v[56:59], a[32:35], v[88:91]
    ds_read_b64_tr_b16 v[68:69], v104 offset:6144
    v_mfma_f32_16x16x32_bf16 v[88:91], v[60:63], a[48:51], v[88:91]
    ds_read_b64_tr_b16 v[70:71], v104 offset:8192
    v_mfma_f32_16x16x32_bf16 v[92:95], v[56:59], a[36:39], v[92:95]
    v_mfma_f32_16x16x32_bf16 v[92:95], v[60:63], a[52:55], v[92:95]
    v_mfma_f32_16x16x32_bf16 v[96:99], v[56:59], a[40:43], v[96:99]
    v_mfma_f32_16x16x32_bf16 v[96:99], v[60:63], a[56:59], v[96:99]
    s_waitcnt vmcnt(8) lgkmcnt(0)
    s_barrier
    v_mfma_f32_16x16x32_bf16 v[100:103], v[56:59], a[44:47], v[100:103]
    ds_read_b128 a[0:3], v6 offset:34816
    s_mov_b32 s75, 311296
    s_add_u32 m0, s35, 18432
    v_mfma_f32_16x16x32_bf16 v[100:103], v[60:63], a[60:63], v[100:103]
    ds_read_b128 a[16:19], v6 offset:36864
    buffer_load_dwordx4 v4, s[20:23], s75 offen offset:0 sc1 lds
    v_mfma_f32_16x16x32_bf16 v[16:19], v[64:67], a[32:35], v[16:19]
    ds_read_b64_tr_b16 v[48:49], v105 offset:18432
    v_mfma_f32_16x16x32_bf16 v[16:19], v[68:71], a[48:51], v[16:19]
    ds_read_b64_tr_b16 v[50:51], v105 offset:20480
    v_mfma_f32_16x16x32_bf16 v[20:23], v[64:67], a[36:39], v[20:23]
    ds_read_b128 a[4:7], v6 offset:35840
    v_mfma_f32_16x16x32_bf16 v[20:23], v[68:71], a[52:55], v[20:23]
    ds_read_b128 a[20:23], v6 offset:37888
    buffer_load_dwordx4 v4, s[20:23], s75 offen offset:1024 sc1 lds
    v_mfma_f32_16x16x32_bf16 v[24:27], v[64:67], a[40:43], v[24:27]
    ds_read_b64_tr_b16 v[52:53], v105 offset:22528
    v_mfma_f32_16x16x32_bf16 v[24:27], v[68:71], a[56:59], v[24:27]
    ds_read_b64_tr_b16 v[54:55], v105 offset:24576
    v_mfma_f32_16x16x32_bf16 v[28:31], v[64:67], a[44:47], v[28:31]
    ds_read_b128 a[8:11], v6 offset:38912
    s_add_u32 m0, s35, 67584
    v_mfma_f32_16x16x32_bf16 v[28:31], v[68:71], a[60:63], v[28:31]
    ds_read_b128 a[24:27], v6 offset:40960
    buffer_load_dwordx4 v4, s[20:23], s73 offen offset:0 sc1 lds
    s_waitcnt lgkmcnt(2)
    v_mfma_f32_16x16x32_bf16 a[128:131], v[48:51], a[0:3], a[128:131]
    ds_read_b128 a[12:15], v6 offset:39936
    v_mfma_f32_16x16x32_bf16 a[128:131], v[52:55], a[16:19], a[128:131]
    ds_read_b128 a[28:31], v6 offset:41984
    v_mfma_f32_16x16x32_bf16 a[132:135], v[48:51], a[4:7], a[132:135]
    ds_read_b64_tr_b16 v[56:57], v105 offset:26624
    v_mfma_f32_16x16x32_bf16 a[132:135], v[52:55], a[20:23], a[132:135]
    ds_read_b64_tr_b16 v[58:59], v105 offset:28672
    buffer_load_dwordx4 v4, s[20:23], s73 offen offset:1024 sc1 lds
    s_waitcnt lgkmcnt(4)
    v_mfma_f32_16x16x32_bf16 a[136:139], v[48:51], a[8:11], a[136:139]
    ds_read_b64_tr_b16 v[60:61], v105 offset:30720
    v_mfma_f32_16x16x32_bf16 a[136:139], v[52:55], a[24:27], a[136:139]
    ds_read_b64_tr_b16 v[62:63], v105 offset:32768
    s_waitcnt lgkmcnt(4)
    v_mfma_f32_16x16x32_bf16 a[140:143], v[48:51], a[12:15], a[140:143]
    ds_read_b64_tr_b16 v[64:65], v106 offset:18432
    s_add_u32 m0, s29, 1920
    v_mfma_f32_16x16x32_bf16 a[140:143], v[52:55], a[28:31], a[140:143]
    ds_read_b64_tr_b16 v[66:67], v106 offset:20480
    buffer_load_dwordx4 v3, s[16:19], s74 offen offset:128 lds
    s_waitcnt lgkmcnt(2)
    v_mfma_f32_16x16x32_bf16 v[88:91], v[56:59], a[0:3], v[88:91]
    ds_read_b64_tr_b16 v[68:69], v106 offset:22528
    v_mfma_f32_16x16x32_bf16 v[88:91], v[60:63], a[16:19], v[88:91]
    ds_read_b64_tr_b16 v[70:71], v106 offset:24576
    v_mfma_f32_16x16x32_bf16 v[92:95], v[56:59], a[4:7], v[92:95]
    s_add_u32 m0, s29, 59264
    v_mfma_f32_16x16x32_bf16 v[92:95], v[60:63], a[20:23], v[92:95]
    buffer_load_dwordx4 v3, s[8:11], s69 offen offset:128 lds
    v_mfma_f32_16x16x32_bf16 v[96:99], v[56:59], a[8:11], v[96:99]
    v_mfma_f32_16x16x32_bf16 v[96:99], v[60:63], a[24:27], v[96:99]
    s_waitcnt vmcnt(11) lgkmcnt(0)
    s_barrier
    v_mfma_f32_16x16x32_bf16 v[100:103], v[56:59], a[12:15], v[100:103]
    ds_read_b128 a[32:35], v7 offset:34816
    s_add_u32 m0, s29, 149376
    v_mfma_f32_16x16x32_bf16 v[100:103], v[60:63], a[28:31], v[100:103]
    ds_read_b128 a[48:51], v7 offset:36864
    buffer_load_dwordx4 v3, s[8:11], s70 offen offset:128 lds
    v_mfma_f32_16x16x32_bf16 v[16:19], v[64:67], a[0:3], v[16:19]
    ds_read_b64_tr_b16 v[48:49], v105 offset:51200
    v_mfma_f32_16x16x32_bf16 v[16:19], v[68:71], a[16:19], v[16:19]
    ds_read_b64_tr_b16 v[50:51], v105 offset:53248
    v_mfma_f32_16x16x32_bf16 v[20:23], v[64:67], a[4:7], v[20:23]
    ds_read_b128 a[36:39], v7 offset:35840
    ds_read_b128 a[52:55], v7 offset:37888
    ds_read_b64_tr_b16 v[52:53], v105 offset:55296
    ds_read_b64_tr_b16 v[54:55], v105 offset:57344
    s_add_u32 m0, s29, 34688
    v_mfma_f32_16x16x32_bf16 v[20:23], v[68:71], a[20:23], v[20:23]
    ds_read_b128 a[40:43], v7 offset:38912
    ds_read_b128 a[56:59], v7 offset:40960
    ds_read_b128 a[44:47], v7 offset:39936
    ds_read_b128 a[60:63], v7 offset:41984
    buffer_load_dwordx4 v3, s[8:11], s71 offen offset:128 lds
    v_mfma_f32_16x16x32_bf16 v[24:27], v[64:67], a[8:11], v[24:27]
    v_mfma_f32_16x16x32_bf16 v[24:27], v[68:71], a[24:27], v[24:27]
    s_waitcnt vmcnt(4) lgkmcnt(0)
    s_barrier
    v_mfma_f32_16x16x32_bf16 v[28:31], v[64:67], a[12:15], v[28:31]
    ds_read_b128 a[64:67], v8 offset:2048
    s_add_u32 m0, s29, 42752
    v_mfma_f32_16x16x32_bf16 v[28:31], v[68:71], a[28:31], v[28:31]
    ds_read_b128 a[80:83], v8 offset:4096
    buffer_load_dwordx4 v3, s[16:19], s74 offen offset:256 lds
    v_mfma_f32_16x16x32_bf16 a[128:131], v[48:51], a[32:35], a[128:131]
    ds_read_b64_tr_b16 v[56:57], v105 offset:59392
    v_mfma_f32_16x16x32_bf16 a[128:131], v[52:55], a[48:51], a[128:131]
    ds_read_b64_tr_b16 v[58:59], v105 offset:61440
    v_mfma_f32_16x16x32_bf16 a[132:135], v[48:51], a[36:39], a[132:135]
    ds_read_b128 a[68:71], v8 offset:3072
    s_add_u32 m0, s29, 83712
    v_mfma_f32_16x16x32_bf16 a[132:135], v[52:55], a[52:55], a[132:135]
    ds_read_b128 a[84:87], v8 offset:5120
    buffer_load_dwordx4 v3, s[8:11], s69 offen offset:256 lds
    v_mfma_f32_16x16x32_bf16 a[136:139], v[48:51], a[40:43], a[136:139]
    ds_read_b64_tr_b16 v[60:61], v105 offset:63488
    v_mfma_f32_16x16x32_bf16 a[136:139], v[52:55], a[56:59], a[136:139]
    ds_read_b64_tr_b16 v[62:63], v106 offset:0
    v_mfma_f32_16x16x32_bf16 a[140:143], v[48:51], a[44:47], a[140:143]
    ds_read_b128 a[72:75], v8 offset:6144
    s_add_u32 m0, s29, 91904
    v_mfma_f32_16x16x32_bf16 a[140:143], v[52:55], a[60:63], a[140:143]
    ds_read_b128 a[88:91], v8 offset:8192
    buffer_load_dwordx4 v3, s[8:11], s70 offen offset:256 lds
    s_waitcnt lgkmcnt(2)
    v_mfma_f32_16x16x32_bf16 a[128:131], v[56:59], a[64:67], a[128:131]
    ds_read_b128 a[76:79], v8 offset:7168
    v_mfma_f32_16x16x32_bf16 a[128:131], v[60:63], a[80:83], a[128:131]
    ds_read_b128 a[92:95], v8 offset:9216
    v_mfma_f32_16x16x32_bf16 a[132:135], v[56:59], a[68:71], a[132:135]
    ds_read_b128 a[96:99], v6 offset:18432
    s_add_u32 m0, s29, 116480
    v_mfma_f32_16x16x32_bf16 a[132:135], v[60:63], a[84:87], a[132:135]
    ds_read_b128 a[112:115], v6 offset:20480
    buffer_load_dwordx4 v3, s[8:11], s71 offen offset:256 lds
    s_waitcnt lgkmcnt(4)
    v_mfma_f32_16x16x32_bf16 a[136:139], v[56:59], a[72:75], a[136:139]
    ds_read_b64_tr_b16 v[64:65], v104 offset:10240
    ds_read_b64_tr_b16 v[66:67], v104 offset:12288
    ds_read_b128 a[100:103], v6 offset:19456
    v_mfma_f32_16x16x32_bf16 a[136:139], v[60:63], a[88:91], a[136:139]
    ds_read_b128 a[116:119], v6 offset:21504
    ds_read_b64_tr_b16 v[68:69], v104 offset:14336
    ds_read_b64_tr_b16 v[70:71], v104 offset:16384
    s_waitcnt lgkmcnt(8)
    v_mfma_f32_16x16x32_bf16 a[140:143], v[56:59], a[76:79], a[140:143]
    ds_read_b128 a[104:107], v6 offset:22528
    ds_read_b128 a[120:123], v6 offset:24576
    ds_read_b128 a[108:111], v6 offset:23552
    ds_read_b128 a[124:127], v6 offset:25600
    ds_read_b64 a[0:1], v7 offset:2048
    ds_read_b64 a[2:3], v7 offset:3072
    ds_read_b64 a[4:5], v7 offset:2056
    v_mfma_f32_16x16x32_bf16 a[140:143], v[60:63], a[92:95], a[140:143]
    ds_read_b64 a[6:7], v7 offset:3080
    ds_read_b64_tr_b16 v[48:49], v104 offset:10240
    ds_read_b64_tr_b16 v[50:51], v104 offset:51200
    ds_read_b64 a[8:9], v7 offset:6144
    ds_read_b64 a[10:11], v7 offset:7168
    ds_read_b64 a[12:13], v7 offset:6152
    ds_read_b64 a[14:15], v7 offset:7176
    s_waitcnt lgkmcnt(14)
    v_mfma_f32_16x16x32_bf16 a[128:131], v[64:67], a[96:99], a[128:131]
    v_mfma_f32_16x16x32_bf16 a[128:131], v[68:71], a[112:115], a[128:131]
    s_waitcnt vmcnt(0) lgkmcnt(0)
    s_barrier
    v_mfma_f32_16x16x32_bf16 a[132:135], v[64:67], a[100:103], a[132:135]
    ds_read_b64_tr_b16 v[56:57], v104 offset:2048
    v_mfma_f32_16x16x32_bf16 a[132:135], v[68:71], a[116:119], a[132:135]
    ds_read_b64_tr_b16 v[58:59], v104 offset:4096
    v_mfma_f32_16x16x32_bf16 a[136:139], v[64:67], a[104:107], a[136:139]
    ds_read_b64_tr_b16 v[60:61], v104 offset:6144
    v_mfma_f32_16x16x32_bf16 a[136:139], v[68:71], a[120:123], a[136:139]
    ds_read_b64_tr_b16 v[62:63], v104 offset:8192
    v_mfma_f32_16x16x32_bf16 a[140:143], v[64:67], a[108:111], a[140:143]
    v_mfma_f32_16x16x32_bf16 a[140:143], v[68:71], a[124:127], a[140:143]
    v_mfma_f32_16x16x32_bf16 a[128:131], v[48:51], a[0:3], a[128:131]
    ds_read_b64_tr_b16 v[64:65], v104 offset:59392
    v_mfma_f32_16x16x32_bf16 a[132:135], v[48:51], a[4:7], a[132:135]
    ds_read_b64_tr_b16 v[66:67], v104 offset:61440
    v_mfma_f32_16x16x32_bf16 a[136:139], v[48:51], a[8:11], a[136:139]
    ds_read_b64_tr_b16 v[68:69], v104 offset:63488
    v_mfma_f32_16x16x32_bf16 a[140:143], v[48:51], a[12:15], a[140:143]
    ds_read_b64_tr_b16 v[70:71], v105 offset:0
    s_waitcnt lgkmcnt(4)
    v_mfma_f32_16x16x32_bf16 v[88:91], v[56:59], a[32:35], v[88:91]
    v_mfma_f32_16x16x32_bf16 v[88:91], v[60:63], a[48:51], v[88:91]
    v_mfma_f32_16x16x32_bf16 v[92:95], v[56:59], a[36:39], v[92:95]
    v_accvgpr_read_b32 v32, a128
    v_accvgpr_read_b32 v33, a129
    v_mfma_f32_16x16x32_bf16 v[92:95], v[60:63], a[52:55], v[92:95]
    v_accvgpr_read_b32 v34, a130
    v_accvgpr_read_b32 v35, a131
    v_mfma_f32_16x16x32_bf16 v[96:99], v[56:59], a[40:43], v[96:99]
    ds_read_b64_tr_b16 v[48:49], v106 offset:18432
    v_accvgpr_read_b32 v36, a132
    v_accvgpr_read_b32 v37, a133
    v_mfma_f32_16x16x32_bf16 v[96:99], v[60:63], a[56:59], v[96:99]
    ds_read_b64_tr_b16 v[50:51], v106 offset:20480
    v_accvgpr_read_b32 v38, a134
    v_mfma_f32_16x16x32_bf16 v[100:103], v[56:59], a[44:47], v[100:103]
    ds_read_b64_tr_b16 v[52:53], v106 offset:22528
    v_accvgpr_read_b32 v39, a135
    v_cvt_pk_bf16_f32 v80, v32, v33
    v_mfma_f32_16x16x32_bf16 v[100:103], v[60:63], a[60:63], v[100:103]
    ds_read_b64_tr_b16 v[54:55], v106 offset:24576
    v_cvt_pk_bf16_f32 v81, v34, v35
    v_cvt_pk_bf16_f32 v82, v36, v37
    s_waitcnt lgkmcnt(4)
    v_mfma_f32_16x16x32_bf16 v[88:91], v[64:67], a[64:67], v[88:91]
    v_cvt_pk_bf16_f32 v83, v38, v39
    v_permlane16_swap_b32 v80, v82
    v_mfma_f32_16x16x32_bf16 v[88:91], v[68:71], a[80:83], v[88:91]
    v_permlane16_swap_b32 v81, v83
    s_mov_b32 s33, 0
    buffer_store_dwordx4 v[80:83], v11, s[20:23], s33 offen offset:0 sc1
    v_mfma_f32_16x16x32_bf16 v[92:95], v[64:67], a[68:71], v[92:95]
    v_accvgpr_read_b32 v40, a136
    v_accvgpr_read_b32 v41, a137
    v_mfma_f32_16x16x32_bf16 v[92:95], v[68:71], a[84:87], v[92:95]
    v_accvgpr_read_b32 v42, a138
    v_accvgpr_read_b32 v43, a139
    v_mfma_f32_16x16x32_bf16 v[96:99], v[64:67], a[72:75], v[96:99]
    ds_read_b64_tr_b16 v[56:57], v106 offset:18432
    v_accvgpr_read_b32 v44, a140
    v_accvgpr_read_b32 v45, a141
    v_mfma_f32_16x16x32_bf16 v[96:99], v[68:71], a[88:91], v[96:99]
    ds_read_b64_tr_b16 v[58:59], v104 offset:34816
    v_accvgpr_read_b32 v46, a142
    v_mfma_f32_16x16x32_bf16 v[100:103], v[64:67], a[76:79], v[100:103]
    v_accvgpr_read_b32 v47, a143
    v_cvt_pk_bf16_f32 v84, v40, v41
    v_mfma_f32_16x16x32_bf16 v[100:103], v[68:71], a[92:95], v[100:103]
    v_cvt_pk_bf16_f32 v85, v42, v43
    v_cvt_pk_bf16_f32 v86, v44, v45
    s_waitcnt lgkmcnt(2)
    v_mfma_f32_16x16x32_bf16 v[88:91], v[48:51], a[96:99], v[88:91]
    ds_read_b64_tr_b16 v[64:65], v104 offset:43008
    v_cvt_pk_bf16_f32 v87, v46, v47
    v_permlane16_swap_b32 v84, v86
    v_mfma_f32_16x16x32_bf16 v[88:91], v[52:55], a[112:115], v[88:91]
    ds_read_b64_tr_b16 v[66:67], v104 offset:45056
    v_permlane16_swap_b32 v85, v87
    s_mov_b32 s33, 0
    buffer_store_dwordx4 v[84:87], v11, s[20:23], s33 offen offset:1024 sc1
    v_mfma_f32_16x16x32_bf16 v[92:95], v[48:51], a[100:103], v[92:95]
    ds_read_b64_tr_b16 v[68:69], v104 offset:47104
    v_mfma_f32_16x16x32_bf16 v[92:95], v[52:55], a[116:119], v[92:95]
    ds_read_b64_tr_b16 v[70:71], v104 offset:49152
    v_mfma_f32_16x16x32_bf16 v[96:99], v[48:51], a[104:107], v[96:99]
    v_mfma_f32_16x16x32_bf16 v[96:99], v[52:55], a[120:123], v[96:99]
    v_mfma_f32_16x16x32_bf16 v[100:103], v[48:51], a[108:111], v[100:103]
    v_mfma_f32_16x16x32_bf16 v[100:103], v[52:55], a[124:127], v[100:103]
    s_waitcnt lgkmcnt(4)
    v_mfma_f32_16x16x32_bf16 v[88:91], v[56:59], a[0:3], v[88:91]
    ds_read_b64_tr_b16 v[48:49], v105 offset:18432
    v_mfma_f32_16x16x32_bf16 v[92:95], v[56:59], a[4:7], v[92:95]
    ds_read_b64_tr_b16 v[50:51], v105 offset:20480
    v_mfma_f32_16x16x32_bf16 v[96:99], v[56:59], a[8:11], v[96:99]
    v_mfma_f32_16x16x32_bf16 v[100:103], v[56:59], a[12:15], v[100:103]
    s_waitcnt lgkmcnt(2)
    v_mfma_f32_16x16x32_bf16 v[16:19], v[64:67], a[32:35], v[16:19]
    ds_read_b64_tr_b16 v[52:53], v105 offset:22528
    v_mfma_f32_16x16x32_bf16 v[16:19], v[68:71], a[48:51], v[16:19]
    ds_read_b64_tr_b16 v[54:55], v105 offset:24576
    v_mfma_f32_16x16x32_bf16 v[20:23], v[64:67], a[36:39], v[20:23]
    ds_read_b64_tr_b16 v[56:57], v105 offset:26624
    v_cvt_pk_bf16_f32 v72, v88, v89
    v_cvt_pk_bf16_f32 v73, v90, v91
    v_mfma_f32_16x16x32_bf16 v[20:23], v[68:71], a[52:55], v[20:23]
    ds_read_b64_tr_b16 v[58:59], v105 offset:28672
    v_cvt_pk_bf16_f32 v74, v92, v93
    v_mfma_f32_16x16x32_bf16 v[24:27], v[64:67], a[40:43], v[24:27]
    ds_read_b64_tr_b16 v[60:61], v105 offset:30720
    v_cvt_pk_bf16_f32 v75, v94, v95
    v_permlane16_swap_b32 v72, v74
    v_mfma_f32_16x16x32_bf16 v[24:27], v[68:71], a[56:59], v[24:27]
    ds_read_b64_tr_b16 v[62:63], v105 offset:32768
    v_permlane16_swap_b32 v73, v75
    v_mfma_f32_16x16x32_bf16 v[28:31], v[64:67], a[44:47], v[28:31]
    s_mov_b32 s33, 16384
    buffer_store_dwordx4 v[72:75], v11, s[20:23], s33 offen offset:0 sc1
    v_mfma_f32_16x16x32_bf16 v[28:31], v[68:71], a[60:63], v[28:31]
    v_cvt_pk_bf16_f32 v76, v96, v97
    s_waitcnt lgkmcnt(6)
    v_mfma_f32_16x16x32_bf16 v[16:19], v[48:51], a[64:67], v[16:19]
    v_cvt_pk_bf16_f32 v77, v98, v99
    v_cvt_pk_bf16_f32 v78, v100, v101
    v_mfma_f32_16x16x32_bf16 v[20:23], v[48:51], a[68:71], v[20:23]
    v_cvt_pk_bf16_f32 v79, v102, v103
    s_waitcnt lgkmcnt(4)
    v_mfma_f32_16x16x32_bf16 v[16:19], v[52:55], a[80:83], v[16:19]
    ds_read_b64_tr_b16 v[64:65], v105 offset:26624
    v_permlane16_swap_b32 v76, v78
    v_permlane16_swap_b32 v77, v79
    v_mfma_f32_16x16x32_bf16 v[20:23], v[52:55], a[84:87], v[20:23]
    ds_read_b64_tr_b16 v[66:67], v105 offset:51200
    s_mov_b32 s33, 16384
    buffer_store_dwordx4 v[76:79], v11, s[20:23], s33 offen offset:1024 sc1
    s_waitcnt lgkmcnt(4)
    v_mfma_f32_16x16x32_bf16 v[16:19], v[56:59], a[96:99], v[16:19]
    v_mfma_f32_16x16x32_bf16 v[20:23], v[56:59], a[100:103], v[20:23]
    s_waitcnt lgkmcnt(2)
    v_mfma_f32_16x16x32_bf16 v[16:19], v[60:63], a[112:115], v[16:19]
    v_mfma_f32_16x16x32_bf16 v[20:23], v[60:63], a[116:119], v[20:23]
    s_waitcnt lgkmcnt(0)
    v_mfma_f32_16x16x32_bf16 v[16:19], v[64:67], a[0:3], v[16:19]
    v_mfma_f32_16x16x32_bf16 v[20:23], v[64:67], a[4:7], v[20:23]
    v_mfma_f32_16x16x32_bf16 v[24:27], v[48:51], a[72:75], v[24:27]
    v_mfma_f32_16x16x32_bf16 v[28:31], v[48:51], a[76:79], v[28:31]
    v_mfma_f32_16x16x32_bf16 v[24:27], v[52:55], a[88:91], v[24:27]
    v_mfma_f32_16x16x32_bf16 v[28:31], v[52:55], a[92:95], v[28:31]
    v_mfma_f32_16x16x32_bf16 v[24:27], v[56:59], a[104:107], v[24:27]
    s_nop 1
    v_cvt_pk_bf16_f32 v80, v16, v17
    v_mfma_f32_16x16x32_bf16 v[28:31], v[56:59], a[108:111], v[28:31]
    v_cvt_pk_bf16_f32 v81, v18, v19
    v_mfma_f32_16x16x32_bf16 v[24:27], v[60:63], a[120:123], v[24:27]
    v_cvt_pk_bf16_f32 v82, v20, v21
    v_cvt_pk_bf16_f32 v83, v22, v23
    v_mfma_f32_16x16x32_bf16 v[28:31], v[60:63], a[124:127], v[28:31]
    v_permlane16_swap_b32 v80, v82
    v_mfma_f32_16x16x32_bf16 v[24:27], v[64:67], a[8:11], v[24:27]
    v_permlane16_swap_b32 v81, v83
    v_mfma_f32_16x16x32_bf16 v[28:31], v[64:67], a[12:15], v[28:31]
    s_mov_b32 s33, 32768
    buffer_store_dwordx4 v[80:83], v11, s[20:23], s33 offen offset:0 sc1
    s_nop 7
    v_cvt_pk_bf16_f32 v84, v24, v25
    v_cvt_pk_bf16_f32 v85, v26, v27
    v_cvt_pk_bf16_f32 v86, v28, v29
    v_cvt_pk_bf16_f32 v87, v30, v31
    s_nop 0
    v_permlane16_swap_b32 v84, v86
    v_permlane16_swap_b32 v85, v87
    s_mov_b32 s33, 32768
    buffer_store_dwordx4 v[84:87], v11, s[20:23], s33 offen offset:1024 sc1
    s_branch L_tail
L_arr_o:
    v_mov_b32 v9, 1
    s_mov_b64 exec, 1
    buffer_atomic_add v9, off, s[24:27], s67 sc1
    s_mov_b64 exec, -1
    s_branch L_arr
L_hp1_o:
    v_mov_b32 v9, 2
    s_mov_b64 exec, 1
    buffer_store_dword v9, off, s[20:23], s66 sc1
    s_mov_b64 exec, -1
    s_branch L_hp1
L_inii_o:
    v_mov_b32 v9, 0
    s_mov_b64 exec, 1
    buffer_atomic_add v9, off, s[24:27], s67 sc0 sc1
    s_mov_b64 exec, -1
    s_branch L_inii
L_inic_o:
    s_mov_b32 s48, 0
    s_waitcnt vmcnt(6)
L_ini_l:
    v_cmp_lt_u32 vcc, 15, v9
    s_nop 1
    s_cmp_eq_u32 vcc_lo, 1
    s_cbranch_scc1 L_ini_d
    s_add_u32 s48, s48, 1
    s_cmp_ge_u32 s48, 100000
    s_cbranch_scc1 L_ini_d
    s_sleep 6
    v_mov_b32 v9, 0
    s_mov_b64 exec, 1
    buffer_atomic_add v9, off, s[24:27], s67 sc0 sc1
    s_mov_b64 exec, -1
    s_waitcnt vmcnt(0)
    s_branch L_ini_l
L_ini_d:
    s_branch L_inic
L_hc1i_o:
    v_mov_b32 v9, 0
    s_mov_b64 exec, 7
    buffer_atomic_add v9, v110, s[20:23], s65 offen sc0 sc1
    s_mov_b64 exec, -1
    s_branch L_hc1i
L_hc1c_o:
    s_mov_b32 s48, 0
    s_waitcnt vmcnt(4)
L_hc1_l:
    v_cmp_lt_u32 vcc, 1, v9
    s_nop 1
    s_cmp_eq_u32 vcc_lo, 7
    s_cbranch_scc1 L_hc1_d
    s_add_u32 s48, s48, 1
    s_cmp_ge_u32 s48, 100000
    s_cbranch_scc1 L_hc1_d
    s_sleep 6
    v_mov_b32 v9, 0
    s_mov_b64 exec, 7
    buffer_atomic_add v9, v110, s[20:23], s65 offen sc0 sc1
    s_mov_b64 exec, -1
    s_waitcnt vmcnt(0)
    s_branch L_hc1_l
L_hc1_d:
    s_branch L_hc1c
L_hp3_o:
    v_mov_b32 v9, 4
    s_mov_b64 exec, 1
    buffer_store_dword v9, off, s[20:23], s66 sc1
    s_mov_b64 exec, -1
    s_branch L_hp3
L_hc3i_o:
    v_mov_b32 v9, 0
    s_mov_b64 exec, 7
    buffer_atomic_add v9, v110, s[20:23], s65 offen sc0 sc1
    s_mov_b64 exec, -1
    s_branch L_hc3i
L_hc3c_o:
    s_mov_b32 s48, 0
    s_waitcnt vmcnt(6)
L_hc3_l:
    v_cmp_lt_u32 vcc, 3, v9
    s_nop 1
    s_cmp_eq_u32 vcc_lo, 7
    s_cbranch_scc1 L_hc3_d
    s_add_u32 s48, s48, 1
    s_cmp_ge_u32 s48, 100000
    s_cbranch_scc1 L_hc3_d
    s_sleep 6
    v_mov_b32 v9, 0
    s_mov_b64 exec, 7
    buffer_atomic_add v9, v110, s[20:23], s65 offen sc0 sc1
    s_mov_b64 exec, -1
    s_waitcnt vmcnt(0)
    s_branch L_hc3_l
L_hc3_d:
    s_branch L_hc3c
L_hp5_o:
    v_mov_b32 v9, 6
    s_mov_b64 exec, 1
    buffer_store_dword v9, off, s[20:23], s66 sc1
    s_mov_b64 exec, -1
    s_branch L_hp5
L_hc5i_o:
    v_mov_b32 v9, 0
    s_mov_b64 exec, 7
    buffer_atomic_add v9, v110, s[20:23], s65 offen sc0 sc1
    s_mov_b64 exec, -1
    s_branch L_hc5i
L_hc5c_o:
    s_mov_b32 s48, 0
    s_waitcnt vmcnt(5)
L_hc5_l:
    v_cmp_lt_u32 vcc, 5, v9
    s_nop 1
    s_cmp_eq_u32 vcc_lo, 7
    s_cbranch_scc1 L_hc5_d
    s_add_u32 s48, s48, 1
    s_cmp_ge_u32 s48, 100000
    s_cbranch_scc1 L_hc5_d
    s_sleep 6
    v_mov_b32 v9, 0
    s_mov_b64 exec, 7
    buffer_atomic_add v9, v110, s[20:23], s65 offen sc0 sc1
    s_mov_b64 exec, -1
    s_waitcnt vmcnt(0)
    s_branch L_hc5_l
L_hc5_d:
    s_branch L_hc5c
L_oci_o:
    v_mov_b32 v9, 0
    s_mov_b64 exec, 8
    buffer_atomic_add v9, v110, s[20:23], s65 offen sc0 sc1
    s_mov_b64 exec, -1
    s_branch L_oci
L_occ_o:
    s_mov_b32 s48, 0
    s_waitcnt vmcnt(5)
L_oc_l:
    v_cmp_lt_u32 vcc, 0, v9
    s_nop 1
    s_cmp_eq_u32 vcc_lo, 8
    s_cbranch_scc1 L_oc_d
    s_add_u32 s48, s48, 1
    s_cmp_ge_u32 s48, 100000
    s_cbranch_scc1 L_oc_d
    s_sleep 6
    v_mov_b32 v9, 0
    s_mov_b64 exec, 8
    buffer_atomic_add v9, v110, s[20:23], s65 offen sc0 sc1
    s_mov_b64 exec, -1
    s_waitcnt vmcnt(0)
    s_branch L_oc_l
L_oc_d:
    s_branch L_occ
L_attn:
    v_lshrrev_b32 v16, 3, v1
    s_lshl_b32 s34, s30, 7
    s_lshl_b32 s35, s28, 4
    s_add_u32 s34, s34, s35
    v_add_u32 v17, s34, v16
    v_mul_u32_u24 v17, 1152, v17
    v_and_b32 v18, 7, v1
    v_lshrrev_b32 v109, 4, v1
    v_xor_b32 v18, v18, v109
    v_lshl_add_u32 v108, v18, 4, v17
    v_xor_b32 v109, 64, v108
    v_add_u32 v109, 9216, v109
    s_lshl_b32 s35, s28, 11
    s_and_b32 s6, s28, 3
    s_lshr_b32 s7, s28, 2
    s_mul_i32 s31, s28, 5120
    s_mul_i32 s33, s6, 55296
    s_mul_i32 s34, s3, 288
    s_add_u32 s33, s33, s34
    s_mul_i32 s83, s7, 1152
    s_add_u32 s83, s83, 1152
    s_add_u32 s33, s33, s83
    v_mov_b32 v19, -20
    v_mul_u32_u24 v17, 3277, v1
    v_lshrrev_b32 v17, 16, v17
    v_mad_i32_i24 v16, v17, v19, v1
    v_lshrrev_b32 v18, 2, v17
    v_and_b32 v18, 2, v18
    v_xor_b32 v16, v16, v18
    v_min_u32 v16, 17, v16
    v_mul_u32_u24 v17, 3456, v17
    v_lshl_add_u32 v16, v16, 4, s33
    v_add_u32 v2, v16, v17
    v_add_u32 v16, 64, v1
    v_mul_u32_u24 v17, 3277, v16
    v_lshrrev_b32 v17, 16, v17
    v_mad_i32_i24 v16, v17, v19, v16
    v_lshrrev_b32 v18, 2, v17
    v_and_b32 v18, 2, v18
    v_xor_b32 v16, v16, v18
    v_min_u32 v16, 17, v16
    v_mul_u32_u24 v17, 3456, v17
    v_lshl_add_u32 v16, v16, 4, s33
    v_add_u32 v3, v16, v17
    s_mov_b32 s10, 2359296
    s_mov_b32 s11, 0x20000
    s_mov_b32 s14, 1990656
    s_mov_b32 s15, 0x20000
    s_waitcnt lgkmcnt(0)
    s_mov_b64 s[8:9], s[36:37]
    s_mov_b64 s[12:13], s[38:39]
    s_add_u32 m0, s35, 124928
    s_nop 0
    buffer_load_dwordx4 v108, s[8:11], 0 offen offset:0 lds
    s_add_u32 m0, s35, 125952
    s_nop 0
    buffer_load_dwordx4 v109, s[8:11], 0 offen offset:0 lds
    s_mov_b32 s71, 0
    s_add_u32 m0, s31, 2048
    s_nop 0
    buffer_load_dwordx4 v2, s[12:15], s71 offen lds
    s_add_u32 m0, s31, 3072
    s_nop 0
    buffer_load_dwordx4 v3, s[12:15], s71 offen lds
    s_barrier
    v_add_u32 v16, 128, v1
    v_mul_u32_u24 v17, 3277, v16
    v_lshrrev_b32 v17, 16, v17
    v_mad_i32_i24 v16, v17, v19, v16
    v_lshrrev_b32 v18, 2, v17
    v_and_b32 v18, 2, v18
    v_xor_b32 v16, v16, v18
    v_min_u32 v16, 17, v16
    v_mul_u32_u24 v17, 3456, v17
    v_lshl_add_u32 v16, v16, 4, s33
    v_add_u32 v4, v16, v17
    s_add_u32 m0, s31, 4096
    s_nop 0
    buffer_load_dwordx4 v4, s[12:15], s71 offen lds
    v_add_u32 v16, 192, v1
    v_mul_u32_u24 v17, 3277, v16
    v_lshrrev_b32 v17, 16, v17
    v_mad_i32_i24 v16, v17, v19, v16
    v_lshrrev_b32 v18, 2, v17
    v_and_b32 v18, 2, v18
    v_xor_b32 v16, v16, v18
    v_min_u32 v16, 17, v16
    v_mul_u32_u24 v17, 3456, v17
    v_lshl_add_u32 v16, v16, 4, s33
    v_add_u32 v5, v16, v17
    s_add_u32 m0, s31, 5120
    s_nop 0
    buffer_load_dwordx4 v5, s[12:15], s71 offen lds
    v_add_u32 v16, 256, v1
    v_mul_u32_u24 v17, 3277, v16
    v_lshrrev_b32 v17, 16, v17
    v_mad_i32_i24 v16, v17, v19, v16
    v_lshrrev_b32 v18, 2, v17
    v_and_b32 v18, 2, v18
    v_xor_b32 v16, v16, v18
    v_min_u32 v16, 17, v16
    v_mul_u32_u24 v17, 3456, v17
    v_lshl_add_u32 v16, v16, 4, s33
    v_add_u32 v6, v16, v17
    s_add_u32 m0, s31, 6144
    s_nop 0
    buffer_load_dwordx4 v6, s[12:15], s71 offen lds
    s_barrier
    s_add_u32 m0, s35, 141184
    s_nop 0
    buffer_load_dwordx4 v108, s[8:11], 0 offen offset:128 lds
    s_add_u32 m0, s35, 142208
    s_nop 0
    buffer_load_dwordx4 v109, s[8:11], 0 offen offset:128 lds
    s_barrier
    v_lshrrev_b32 v16, 4, v1
    v_bfe_u32 v17, v1, 2, 2
    v_lshl_add_u32 v17, v16, 3, v17
    v_mul_u32_u24 v17, 320, v17
    v_and_b32 v18, 3, v1
    v_lshl_add_u32 v17, v18, 3, v17
    s_mul_i32 s84, s7, 20480
    v_add_u32 v17, s84, v17
    v_and_b32 v18, 16, v1
    v_lshlrev_b32 v18, 1, v18
    v_add_u32 v7, v17, v18
    v_sub_u32 v8, v17, v18
    v_add_u32 v9, 65536, v7
    v_add_u32 v10, 65536, v8
    v_add_u32 v11, 131072, v7
    v_add_u32 v12, 131072, v8
    v_and_b32 v17, 15, v1
    v_lshrrev_b32 v18, 1, v17
    v_xor_b32 v18, v18, v16
    s_lshl_b32 s84, s6, 12
    s_add_u32 s84, s84, 124928
    v_lshl_add_u32 v17, v17, 7, s84
    v_lshl_add_u32 v110, v18, 4, v17
    v_xor_b32 v111, 64, v110
    s_mov_b32 s71, 221184
    s_add_u32 m0, s31, 43008
    s_nop 0
    buffer_load_dwordx4 v2, s[12:15], s71 offen lds
    s_add_u32 m0, s31, 44032
    s_nop 0
    buffer_load_dwordx4 v3, s[12:15], s71 offen lds
    s_add_u32 m0, s31, 45056
    s_nop 0
    buffer_load_dwordx4 v4, s[12:15], s71 offen lds
    s_add_u32 m0, s31, 46080
    s_nop 0
    buffer_load_dwordx4 v5, s[12:15], s71 offen lds
    s_add_u32 m0, s31, 47104
    s_nop 0
    buffer_load_dwordx4 v6, s[12:15], s71 offen lds
    s_mov_b32 s20, s50
    s_mov_b32 s21, s51
    s_mov_b32 s22, 1152
    s_mov_b32 s23, 0x20000
    s_lshr_b32 s84, s29, 2
    s_add_u32 m0, s84, 158208
    v_lshlrev_b32 v13, 2, v0
    buffer_load_dword v13, s[20:23], 0 offen lds
    s_lshl_b32 s82, s3, 2
    s_add_u32 s82, s82, 3
    s_mov_b64 s[20:21], s[74:75]
    s_mov_b32 s22, 0x10000000
    s_mul_i32 s43, s30, 34816
    s_add_u32 s43, s43, 69206016
    s_mul_i32 s42, s28, 1088
    s_add_u32 s42, s42, s82
    s_lshl_b32 s42, s42, 2
    s_add_u32 s42, s42, s43
    s_lshr_b32 s44, s82, 1
    s_mul_i32 s46, s44, 4352
    s_add_u32 s43, s43, s46
    s_lshl_b32 s65, s3, 3
    s_add_u32 s65, s65, s28
    s_mul_i32 s65, s65, 4352
    s_add_u32 s65, s65, 70778880
    s_lshl_b32 s66, s30, 2
    s_add_u32 s66, s66, s65
    s_sub_u32 s84, s66, s42
    v_mul_lo_u32 v14, v1, s84
    s_lshl_b32 s67, s30, 2
    s_add_u32 s67, s67, s3
    s_mul_i32 s67, s67, 4352
    s_add_u32 s67, s67, 70254592
    s_add_u32 s68, s67, 12
    s_sub_u32 s84, s68, s42
    v_writelane_b32 v14, s84, 2
    v_mov_b32 v13, 0
    s_cmp_eq_u32 s28, 0
    s_cselect_b64 exec, 7, 3
    buffer_store_dword v13, v14, s[20:23], s42 offen sc1
    s_mov_b64 exec, -1
    s_waitcnt vmcnt(9)
    s_barrier
    ds_read_b128 a[0:3], v110 offset:0
    ds_read_b128 a[4:7], v110 offset:2048
    ds_read_b64_tr_b16 v[88:89], v7 offset:2048
    ds_read_b64_tr_b16 v[90:91], v7 offset:3328
    s_waitcnt lgkmcnt(0)
    v_mfma_f32_16x16x32_bf16 v[16:19], a[0:3], v[88:91], 0
    ds_read_b64_tr_b16 v[92:93], v8 offset:2080
    ds_read_b64_tr_b16 v[94:95], v8 offset:3360
    s_mov_b32 s71, 442368
    s_add_u32 m0, s31, 83968
    v_mfma_f32_16x16x32_bf16 v[20:23], a[4:7], v[88:91], 0
    ds_read_b64_tr_b16 v[96:97], v7 offset:2112
    ds_read_b64_tr_b16 v[98:99], v7 offset:3392
    buffer_load_dwordx4 v2, s[12:15], s71 offen lds
    s_waitcnt lgkmcnt(2)
    v_mfma_f32_16x16x32_bf16 v[24:27], a[0:3], v[92:95], 0
    ds_read_b64_tr_b16 v[100:101], v8 offset:2144
    ds_read_b64_tr_b16 v[102:103], v8 offset:3424
    s_add_u32 m0, s31, 84992
    v_mfma_f32_16x16x32_bf16 v[28:31], a[4:7], v[92:95], 0
    ds_read_b64_tr_b16 v[104:105], v7 offset:2176
    buffer_load_dwordx4 v3, s[12:15], s71 offen lds
    s_waitcnt lgkmcnt(3)
    v_mfma_f32_16x16x32_bf16 v[32:35], a[0:3], v[96:99], 0
    ds_read_b64_tr_b16 v[106:107], v7 offset:3456
    ds_read_b64_tr_b16 v[88:89], v8 offset:2208
    s_add_u32 m0, s31, 86016
    v_mfma_f32_16x16x32_bf16 v[36:39], a[4:7], v[96:99], 0
    ds_read_b64_tr_b16 v[90:91], v8 offset:3488
    buffer_load_dwordx4 v4, s[12:15], s71 offen lds
    s_waitcnt lgkmcnt(4)
    v_mfma_f32_16x16x32_bf16 v[40:43], a[0:3], v[100:103], 0
    ds_read_b64_tr_b16 v[92:93], v7 offset:2240
    ds_read_b64_tr_b16 v[94:95], v7 offset:3520
    s_add_u32 m0, s31, 87040
    v_mfma_f32_16x16x32_bf16 v[44:47], a[4:7], v[100:103], 0
    ds_read_b64_tr_b16 v[96:97], v8 offset:2272
    buffer_load_dwordx4 v5, s[12:15], s71 offen lds
    s_waitcnt lgkmcnt(5)
    v_mfma_f32_16x16x32_bf16 v[48:51], a[0:3], v[104:107], 0
    ds_read_b64_tr_b16 v[98:99], v8 offset:3552
    ds_read_b64_tr_b16 v[100:101], v7 offset:2304
    s_mov_b32 s16, s40
    s_add_u32 m0, s31, 88064
    v_mfma_f32_16x16x32_bf16 v[52:55], a[4:7], v[104:107], 0
    ds_read_b64_tr_b16 v[102:103], v7 offset:3584
    buffer_load_dwordx4 v6, s[12:15], s71 offen lds
    s_waitcnt lgkmcnt(6)
    v_mfma_f32_16x16x32_bf16 v[56:59], a[0:3], v[88:91], 0
    ds_read_b128 a[8:11], v111 offset:0
    ds_read_b128 a[12:15], v111 offset:2048
    s_mov_b32 s17, s41
    v_mfma_f32_16x16x32_bf16 v[60:63], a[4:7], v[88:91], 0
    ds_read_b64_tr_b16 v[104:105], v7 offset:12288
    ds_read_b64_tr_b16 v[106:107], v7 offset:13568
    s_waitcnt lgkmcnt(8)
    v_mfma_f32_16x16x32_bf16 v[64:67], a[0:3], v[92:95], 0
    ds_read_b64_tr_b16 v[88:89], v8 offset:12320
    v_mfma_f32_16x16x32_bf16 v[68:71], a[4:7], v[92:95], 0
    ds_read_b64_tr_b16 v[90:91], v8 offset:13600
    s_waitcnt lgkmcnt(8)
    v_mfma_f32_16x16x32_bf16 v[72:75], a[0:3], v[96:99], 0
    ds_read_b64_tr_b16 v[92:93], v7 offset:12352
    s_mov_b32 s18, 663552
    v_mfma_f32_16x16x32_bf16 v[76:79], a[4:7], v[96:99], 0
    ds_read_b64_tr_b16 v[94:95], v7 offset:13632
    s_waitcnt lgkmcnt(8)
    v_mfma_f32_16x16x32_bf16 v[80:83], a[0:3], v[100:103], 0
    ds_read_b64_tr_b16 v[96:97], v8 offset:12384
    s_mov_b32 s19, 0x20000
    v_mfma_f32_16x16x32_bf16 v[84:87], a[4:7], v[100:103], 0
    ds_read_b64_tr_b16 v[98:99], v8 offset:13664
    s_waitcnt lgkmcnt(6)
    v_mfma_f32_16x16x32_bf16 v[16:19], a[8:11], v[104:107], v[16:19]
    ds_read_b64_tr_b16 v[100:101], v7 offset:12416
    s_mov_b32 s24, s54
    v_mfma_f32_16x16x32_bf16 v[20:23], a[12:15], v[104:107], v[20:23]
    ds_read_b64_tr_b16 v[102:103], v7 offset:13696
    s_waitcnt lgkmcnt(6)
    v_mfma_f32_16x16x32_bf16 v[24:27], a[8:11], v[88:91], v[24:27]
    ds_read_b64_tr_b16 v[104:105], v8 offset:12448
    s_mov_b32 s25, s55
    v_mfma_f32_16x16x32_bf16 v[28:31], a[12:15], v[88:91], v[28:31]
    ds_read_b64_tr_b16 v[106:107], v8 offset:13728
    s_waitcnt lgkmcnt(6)
    v_mfma_f32_16x16x32_bf16 v[32:35], a[8:11], v[92:95], v[32:35]
    ds_read_b64_tr_b16 v[88:89], v7 offset:12480
    s_mov_b32 s26, 256
    v_mfma_f32_16x16x32_bf16 v[36:39], a[12:15], v[92:95], v[36:39]
    ds_read_b64_tr_b16 v[90:91], v7 offset:13760
    s_waitcnt lgkmcnt(6)
    v_mfma_f32_16x16x32_bf16 v[40:43], a[8:11], v[96:99], v[40:43]
    ds_read_b64_tr_b16 v[92:93], v8 offset:12512
    v_mfma_f32_16x16x32_bf16 v[44:47], a[12:15], v[96:99], v[44:47]
    ds_read_b64_tr_b16 v[94:95], v8 offset:13792
    s_waitcnt lgkmcnt(6)
    v_mfma_f32_16x16x32_bf16 v[48:51], a[8:11], v[100:103], v[48:51]
    ds_read_b64_tr_b16 v[96:97], v7 offset:12544
    s_mov_b32 s27, 0x20000
    v_mfma_f32_16x16x32_bf16 v[52:55], a[12:15], v[100:103], v[52:55]
    ds_read_b64_tr_b16 v[98:99], v7 offset:13824
    s_waitcnt lgkmcnt(6)
    v_mfma_f32_16x16x32_bf16 v[56:59], a[8:11], v[104:107], v[56:59]
    s_mov_b64 s[72:73], s[48:49]
    v_mfma_f32_16x16x32_bf16 v[60:63], a[12:15], v[104:107], v[60:63]
    s_waitcnt vmcnt(7) lgkmcnt(0)
    s_barrier
    v_mfma_f32_16x16x32_bf16 v[64:67], a[8:11], v[88:91], v[64:67]
    ds_read_b128 a[16:19], v110 offset:16384
    ds_read_b128 a[20:23], v110 offset:18432
    s_mov_b32 s79, 3
    s_add_u32 m0, s35, 124672
    v_mfma_f32_16x16x32_bf16 v[68:71], a[12:15], v[88:91], v[68:71]
    ds_read_b64_tr_b16 v[100:101], v7 offset:43008
    ds_read_b64_tr_b16 v[102:103], v7 offset:44288
    buffer_load_dwordx4 v108, s[8:11], 0 offen offset:256 lds
    v_mfma_f32_16x16x32_bf16 v[72:75], a[8:11], v[92:95], v[72:75]
    ds_read_b64_tr_b16 v[104:105], v8 offset:43040
    ds_read_b64_tr_b16 v[106:107], v8 offset:44320
    s_lshl_b32 s33, s3, 3
    s_add_u32 m0, s35, 125696
    v_mfma_f32_16x16x32_bf16 v[76:79], a[12:15], v[92:95], v[76:79]
    ds_read_b64_tr_b16 v[88:89], v7 offset:43072
    buffer_load_dwordx4 v109, s[8:11], 0 offen offset:256 lds
    v_mfma_f32_16x16x32_bf16 v[80:83], a[8:11], v[96:99], v[80:83]
    ds_read_b64_tr_b16 v[90:91], v7 offset:44352
    ds_read_b64_tr_b16 v[92:93], v8 offset:43104
    s_mov_b32 s71, 663552
    s_add_u32 m0, s31, 2048
    v_mfma_f32_16x16x32_bf16 v[84:87], a[12:15], v[96:99], v[84:87]
    ds_read_b64_tr_b16 v[94:95], v8 offset:44384
    buffer_load_dwordx4 v2, s[12:15], s71 offen lds
    s_waitcnt lgkmcnt(6)
    v_mfma_f32_16x16x32_bf16 v[16:19], a[16:19], v[100:103], v[16:19]
    ds_read_b64_tr_b16 v[96:97], v7 offset:43136
    s_add_u32 s33, s33, s28
    v_mfma_f32_16x16x32_bf16 v[20:23], a[20:23], v[100:103], v[20:23]
    ds_read_b64_tr_b16 v[98:99], v7 offset:44416
    s_waitcnt lgkmcnt(6)
    v_mfma_f32_16x16x32_bf16 v[24:27], a[16:19], v[104:107], v[24:27]
    ds_read_b64_tr_b16 v[100:101], v8 offset:43168
    s_lshl_b32 s34, s33, 11
    s_add_u32 m0, s31, 3072
    v_mfma_f32_16x16x32_bf16 v[28:31], a[20:23], v[104:107], v[28:31]
    ds_read_b64_tr_b16 v[102:103], v8 offset:44448
    buffer_load_dwordx4 v3, s[12:15], s71 offen lds
    s_waitcnt lgkmcnt(6)
    v_mfma_f32_16x16x32_bf16 v[32:35], a[16:19], v[88:91], v[32:35]
    ds_read_b64_tr_b16 v[104:105], v7 offset:43200
    s_add_u32 s34, s34, 68943872
    v_mfma_f32_16x16x32_bf16 v[36:39], a[20:23], v[88:91], v[36:39]
    ds_read_b64_tr_b16 v[106:107], v7 offset:44480
    s_waitcnt lgkmcnt(6)
    v_mfma_f32_16x16x32_bf16 v[40:43], a[16:19], v[92:95], v[40:43]
    ds_read_b64_tr_b16 v[88:89], v8 offset:43232
    s_mul_i32 s33, s33, 35072
    s_add_u32 m0, s31, 4096
    v_mfma_f32_16x16x32_bf16 v[44:47], a[20:23], v[92:95], v[44:47]
    ds_read_b64_tr_b16 v[90:91], v8 offset:44512
    buffer_load_dwordx4 v4, s[12:15], s71 offen lds
    s_waitcnt lgkmcnt(6)
    v_mfma_f32_16x16x32_bf16 v[48:51], a[16:19], v[96:99], v[48:51]
    ds_read_b64_tr_b16 v[92:93], v7 offset:43264
    s_add_u32 s33, s33, 67108864
    v_mfma_f32_16x16x32_bf16 v[52:55], a[20:23], v[96:99], v[52:55]
    ds_read_b64_tr_b16 v[94:95], v7 offset:44544
    s_waitcnt lgkmcnt(6)
    v_mfma_f32_16x16x32_bf16 v[56:59], a[16:19], v[100:103], v[56:59]
    ds_read_b128 a[24:27], v111 offset:16384
    ds_read_b128 a[28:31], v111 offset:18432
    s_add_u32 m0, s31, 5120
    v_mfma_f32_16x16x32_bf16 v[60:63], a[20:23], v[100:103], v[60:63]
    ds_read_b64_tr_b16 v[96:97], v7 offset:53248
    ds_read_b64_tr_b16 v[98:99], v7 offset:54528
    buffer_load_dwordx4 v5, s[12:15], s71 offen lds
    s_waitcnt lgkmcnt(8)
    v_mfma_f32_16x16x32_bf16 v[64:67], a[16:19], v[104:107], v[64:67]
    ds_read_b64_tr_b16 v[100:101], v8 offset:53280
    s_lshl_b32 s32, s30, 11
    v_mfma_f32_16x16x32_bf16 v[68:71], a[20:23], v[104:107], v[68:71]
    ds_read_b64_tr_b16 v[102:103], v8 offset:54560
    s_waitcnt lgkmcnt(8)
    v_mfma_f32_16x16x32_bf16 v[72:75], a[16:19], v[88:91], v[72:75]
    ds_read_b64_tr_b16 v[104:105], v7 offset:53312
    s_add_u32 s32, s32, s33
    s_add_u32 m0, s31, 6144
    v_mfma_f32_16x16x32_bf16 v[76:79], a[20:23], v[88:91], v[76:79]
    ds_read_b64_tr_b16 v[106:107], v7 offset:54592
    buffer_load_dwordx4 v6, s[12:15], s71 offen lds
    s_waitcnt lgkmcnt(8)
    v_mfma_f32_16x16x32_bf16 v[80:83], a[16:19], v[92:95], v[80:83]
    ds_read_b64_tr_b16 v[88:89], v8 offset:53344
    s_cmp_eq_u32 s7, 0
    s_cselect_b32 s36, -1, 0
    s_cselect_b32 s39, 0, -1
    v_mfma_f32_16x16x32_bf16 v[84:87], a[20:23], v[92:95], v[84:87]
    ds_read_b64_tr_b16 v[90:91], v8 offset:54624
    s_waitcnt lgkmcnt(6)
    v_mfma_f32_16x16x32_bf16 v[16:19], a[24:27], v[96:99], v[16:19]
    ds_read_b64_tr_b16 v[92:93], v7 offset:53376
    s_mov_b32 s37, -1
    v_mfma_f32_16x16x32_bf16 v[20:23], a[28:31], v[96:99], v[20:23]
    ds_read_b64_tr_b16 v[94:95], v7 offset:54656
    s_waitcnt lgkmcnt(6)
    v_mfma_f32_16x16x32_bf16 v[24:27], a[24:27], v[100:103], v[24:27]
    ds_read_b64_tr_b16 v[96:97], v8 offset:53408
    v_mfma_f32_16x16x32_bf16 v[28:31], a[28:31], v[100:103], v[28:31]
    ds_read_b64_tr_b16 v[98:99], v8 offset:54688
    s_waitcnt lgkmcnt(6)
    v_mfma_f32_16x16x32_bf16 v[32:35], a[24:27], v[104:107], v[32:35]
    ds_read_b64_tr_b16 v[100:101], v7 offset:53440
    s_mov_b32 s38, -1
    v_mfma_f32_16x16x32_bf16 v[36:39], a[28:31], v[104:107], v[36:39]
    ds_read_b64_tr_b16 v[102:103], v7 offset:54720
    s_waitcnt lgkmcnt(6)
    v_mfma_f32_16x16x32_bf16 v[40:43], a[24:27], v[88:91], v[40:43]
    ds_read_b64_tr_b16 v[104:105], v8 offset:53472
    s_mov_b32 s80, 0x3fb8aa3b
    v_mfma_f32_16x16x32_bf16 v[44:47], a[28:31], v[88:91], v[44:47]
    ds_read_b64_tr_b16 v[106:107], v8 offset:54752
    s_waitcnt lgkmcnt(6)
    v_mfma_f32_16x16x32_bf16 v[48:51], a[24:27], v[92:95], v[48:51]
    ds_read_b64_tr_b16 v[88:89], v7 offset:53504
    s_mov_b32 s81, 0x358637bd
    v_mfma_f32_16x16x32_bf16 v[52:55], a[28:31], v[92:95], v[52:55]
    ds_read_b64_tr_b16 v[90:91], v7 offset:54784
    s_waitcnt lgkmcnt(6)
    v_mfma_f32_16x16x32_bf16 v[56:59], a[24:27], v[96:99], v[56:59]
    s_lshl_b32 s84, s28, 1
    v_mfma_f32_16x16x32_bf16 v[60:63], a[28:31], v[96:99], v[60:63]
    s_waitcnt vmcnt(5) lgkmcnt(0)
    s_barrier
    v_mfma_f32_16x16x32_bf16 v[64:67], a[24:27], v[100:103], v[64:67]
    ds_read_b128 a[32:35], v110 offset:0
    ds_read_b128 a[36:39], v110 offset:2048
    s_add_u32 m0, s35, 140928
    v_mfma_f32_16x16x32_bf16 v[68:71], a[28:31], v[100:103], v[68:71]
    ds_read_b64_tr_b16 v[92:93], v9 offset:18432
    ds_read_b64_tr_b16 v[94:95], v9 offset:19712
    buffer_load_dwordx4 v108, s[8:11], 0 offen offset:384 lds
    v_mfma_f32_16x16x32_bf16 v[72:75], a[24:27], v[104:107], v[72:75]
    ds_read_b64_tr_b16 v[96:97], v10 offset:18464
    ds_read_b64_tr_b16 v[98:99], v10 offset:19744
    v_lshrrev_b32 v13, 4, v1
    v_mfma_f32_16x16x32_bf16 v[76:79], a[28:31], v[104:107], v[76:79]
    ds_read_b64_tr_b16 v[100:101], v9 offset:18496
    v_mfma_f32_16x16x32_bf16 v[80:83], a[24:27], v[88:91], v[80:83]
    ds_read_b64_tr_b16 v[102:103], v9 offset:19776
    ds_read_b64_tr_b16 v[104:105], v10 offset:18528
    v_lshlrev_b32 v13, 2, v13
    s_add_u32 m0, s35, 141952
    v_mfma_f32_16x16x32_bf16 v[84:87], a[28:31], v[88:91], v[84:87]
    ds_read_b64_tr_b16 v[106:107], v10 offset:19808
    buffer_load_dwordx4 v109, s[8:11], 0 offen offset:384 lds
    s_waitcnt lgkmcnt(6)
    v_mfma_f32_16x16x32_bf16 v[16:19], a[32:35], v[92:95], v[16:19]
    ds_read_b64_tr_b16 v[88:89], v9 offset:18560
    v_subrev_u32 v13, s84, v13
    v_mfma_f32_16x16x32_bf16 v[20:23], a[36:39], v[92:95], v[20:23]
    ds_read_b64_tr_b16 v[90:91], v9 offset:19840
    s_waitcnt lgkmcnt(6)
    v_mfma_f32_16x16x32_bf16 v[24:27], a[32:35], v[96:99], v[24:27]
    ds_read_b64_tr_b16 v[92:93], v10 offset:18592
    v_and_b32 v14, 15, v1
    s_mov_b32 s71, 884736
    s_add_u32 m0, s31, 43008
    v_mfma_f32_16x16x32_bf16 v[28:31], a[36:39], v[96:99], v[28:31]
    ds_read_b64_tr_b16 v[94:95], v10 offset:19872
    buffer_load_dwordx4 v2, s[12:15], s71 offen lds
    s_waitcnt lgkmcnt(6)
    v_mfma_f32_16x16x32_bf16 v[32:35], a[32:35], v[100:103], v[32:35]
    ds_read_b64_tr_b16 v[96:97], v9 offset:18624
    v_subrev_u32 v14, s84, v14
    v_mfma_f32_16x16x32_bf16 v[36:39], a[36:39], v[100:103], v[36:39]
    ds_read_b64_tr_b16 v[98:99], v9 offset:19904
    s_waitcnt lgkmcnt(6)
    v_mfma_f32_16x16x32_bf16 v[40:43], a[32:35], v[104:107], v[40:43]
    ds_read_b64_tr_b16 v[100:101], v10 offset:18656
    s_add_u32 m0, s31, 44032
    v_mfma_f32_16x16x32_bf16 v[44:47], a[36:39], v[104:107], v[44:47]
    ds_read_b64_tr_b16 v[102:103], v10 offset:19936
    buffer_load_dwordx4 v3, s[12:15], s71 offen lds
    s_waitcnt lgkmcnt(6)
    v_mfma_f32_16x16x32_bf16 v[48:51], a[32:35], v[88:91], v[48:51]
    ds_read_b64_tr_b16 v[104:105], v9 offset:18688
    v_add_u32 v15, 0, v13
    v_mfma_f32_16x16x32_bf16 v[52:55], a[36:39], v[88:91], v[52:55]
    ds_read_b64_tr_b16 v[106:107], v9 offset:19968
    s_waitcnt lgkmcnt(6)
    v_mfma_f32_16x16x32_bf16 v[56:59], a[32:35], v[92:95], v[56:59]
    ds_read_b128 a[40:43], v111 offset:0
    ds_read_b128 a[44:47], v111 offset:2048
    v_cmp_gt_u32 s[40:41], 18, v15
    s_add_u32 m0, s31, 45056
    v_mfma_f32_16x16x32_bf16 v[60:63], a[36:39], v[92:95], v[60:63]
    ds_read_b64_tr_b16 v[88:89], v9 offset:28672
    ds_read_b64_tr_b16 v[90:91], v9 offset:29952
    buffer_load_dwordx4 v4, s[12:15], s71 offen lds
    s_waitcnt lgkmcnt(8)
    v_mfma_f32_16x16x32_bf16 v[64:67], a[32:35], v[96:99], v[64:67]
    ds_read_b64_tr_b16 v[92:93], v10 offset:28704
    v_add_u32 v15, 2, v13
    v_mfma_f32_16x16x32_bf16 v[68:71], a[36:39], v[96:99], v[68:71]
    ds_read_b64_tr_b16 v[94:95], v10 offset:29984
    s_waitcnt lgkmcnt(8)
    v_mfma_f32_16x16x32_bf16 v[72:75], a[32:35], v[100:103], v[72:75]
    ds_read_b64_tr_b16 v[96:97], v9 offset:28736
    v_cmp_gt_u32 s[42:43], 18, v15
    s_add_u32 m0, s31, 46080
    v_mfma_f32_16x16x32_bf16 v[76:79], a[36:39], v[100:103], v[76:79]
    ds_read_b64_tr_b16 v[98:99], v9 offset:30016
    buffer_load_dwordx4 v5, s[12:15], s71 offen lds
    s_waitcnt lgkmcnt(8)
    v_mfma_f32_16x16x32_bf16 v[80:83], a[32:35], v[104:107], v[80:83]
    ds_read_b64_tr_b16 v[100:101], v10 offset:28768
    v_mfma_f32_16x16x32_bf16 v[84:87], a[36:39], v[104:107], v[84:87]
    ds_read_b64_tr_b16 v[102:103], v10 offset:30048
    s_waitcnt lgkmcnt(6)
    v_mfma_f32_16x16x32_bf16 v[16:19], a[40:43], v[88:91], v[16:19]
    ds_read_b64_tr_b16 v[104:105], v9 offset:28800
    v_add_u32 v15, 16, v13
    s_add_u32 m0, s31, 47104
    v_mfma_f32_16x16x32_bf16 v[20:23], a[44:47], v[88:91], v[20:23]
    ds_read_b64_tr_b16 v[106:107], v9 offset:30080
    buffer_load_dwordx4 v6, s[12:15], s71 offen lds
    s_waitcnt lgkmcnt(6)
    v_mfma_f32_16x16x32_bf16 v[24:27], a[40:43], v[92:95], v[24:27]
    ds_read_b64_tr_b16 v[88:89], v10 offset:28832
    v_cmp_gt_u32 s[44:45], 18, v15
    v_mfma_f32_16x16x32_bf16 v[28:31], a[44:47], v[92:95], v[28:31]
    ds_read_b64_tr_b16 v[90:91], v10 offset:30112
    s_waitcnt lgkmcnt(6)
    v_mfma_f32_16x16x32_bf16 v[32:35], a[40:43], v[96:99], v[32:35]
    ds_read_b64_tr_b16 v[92:93], v9 offset:28864
    v_add_u32 v15, 18, v13
    v_mfma_f32_16x16x32_bf16 v[36:39], a[44:47], v[96:99], v[36:39]
    ds_read_b64_tr_b16 v[94:95], v9 offset:30144
    s_waitcnt lgkmcnt(6)
    v_mfma_f32_16x16x32_bf16 v[40:43], a[40:43], v[100:103], v[40:43]
    ds_read_b64_tr_b16 v[96:97], v10 offset:28896
    v_cmp_gt_u32 s[46:47], 18, v15
    v_mfma_f32_16x16x32_bf16 v[44:47], a[44:47], v[100:103], v[44:47]
    ds_read_b64_tr_b16 v[98:99], v10 offset:30176
    s_waitcnt lgkmcnt(6)
    v_mfma_f32_16x16x32_bf16 v[48:51], a[40:43], v[104:107], v[48:51]
    ds_read_b64_tr_b16 v[100:101], v9 offset:28928
    v_add_u32 v15, 0, v14
    v_mfma_f32_16x16x32_bf16 v[52:55], a[44:47], v[104:107], v[52:55]
    ds_read_b64_tr_b16 v[102:103], v9 offset:30208
    s_waitcnt lgkmcnt(6)
    v_mfma_f32_16x16x32_bf16 v[56:59], a[40:43], v[88:91], v[56:59]
    v_mfma_f32_16x16x32_bf16 v[60:63], a[44:47], v[88:91], v[60:63]
    s_waitcnt vmcnt(5) lgkmcnt(0)
    s_barrier
    v_mfma_f32_16x16x32_bf16 v[64:67], a[40:43], v[92:95], v[64:67]
    ds_read_b128 a[48:51], v110 offset:16384
    ds_read_b128 a[52:55], v110 offset:18432
    v_cmp_gt_u32 s[48:49], 18, v15
    s_add_u32 m0, s35, 124416
    v_mfma_f32_16x16x32_bf16 v[68:71], a[44:47], v[92:95], v[68:71]
    ds_read_b64_tr_b16 v[104:105], v7 offset:2048
    ds_read_b64_tr_b16 v[106:107], v7 offset:3328
    buffer_load_dwordx4 v108, s[8:11], 0 offen offset:512 lds
    v_mfma_f32_16x16x32_bf16 v[72:75], a[40:43], v[96:99], v[72:75]
    ds_read_b64_tr_b16 v[88:89], v8 offset:2080
    ds_read_b64_tr_b16 v[90:91], v8 offset:3360
    v_add_u32 v15, 16, v14
    v_mfma_f32_16x16x32_bf16 v[76:79], a[44:47], v[96:99], v[76:79]
    ds_read_b64_tr_b16 v[92:93], v7 offset:2112
    v_mfma_f32_16x16x32_bf16 v[80:83], a[40:43], v[100:103], v[80:83]
    ds_read_b64_tr_b16 v[94:95], v7 offset:3392
    ds_read_b64_tr_b16 v[96:97], v8 offset:2144
    v_cmp_gt_u32 s[50:51], 18, v15
    s_add_u32 m0, s35, 125440
    v_mfma_f32_16x16x32_bf16 v[84:87], a[44:47], v[100:103], v[84:87]
    ds_read_b64_tr_b16 v[98:99], v8 offset:3424
    buffer_load_dwordx4 v109, s[8:11], 0 offen offset:512 lds
    s_waitcnt lgkmcnt(6)
    v_mfma_f32_16x16x32_bf16 v[16:19], a[48:51], v[104:107], v[16:19]
    ds_read_b64_tr_b16 v[100:101], v7 offset:2176
    s_mul_i32 s84, s7, 36
    v_mfma_f32_16x16x32_bf16 v[20:23], a[52:55], v[104:107], v[20:23]
    ds_read_b64_tr_b16 v[102:103], v7 offset:3456
    s_waitcnt lgkmcnt(6)
    v_mfma_f32_16x16x32_bf16 v[24:27], a[48:51], v[88:91], v[24:27]
    ds_read_b64_tr_b16 v[104:105], v8 offset:2208
    s_mov_b32 s71, 1105920
    s_add_u32 m0, s31, 83968
    v_mfma_f32_16x16x32_bf16 v[28:31], a[52:55], v[88:91], v[28:31]
    ds_read_b64_tr_b16 v[106:107], v8 offset:3488
    buffer_load_dwordx4 v2, s[12:15], s71 offen lds
    s_waitcnt lgkmcnt(6)
    v_mfma_f32_16x16x32_bf16 v[32:35], a[48:51], v[92:95], v[32:35]
    ds_read_b64_tr_b16 v[88:89], v7 offset:2240
    s_add_u32 s84, s84, s6
    v_mfma_f32_16x16x32_bf16 v[36:39], a[52:55], v[92:95], v[36:39]
    ds_read_b64_tr_b16 v[90:91], v7 offset:3520
    s_waitcnt lgkmcnt(6)
    v_mfma_f32_16x16x32_bf16 v[40:43], a[48:51], v[96:99], v[40:43]
    ds_read_b64_tr_b16 v[92:93], v8 offset:2272
    s_lshl_b32 s84, s84, 10
    s_add_u32 m0, s31, 84992
    v_mfma_f32_16x16x32_bf16 v[44:47], a[52:55], v[96:99], v[44:47]
    ds_read_b64_tr_b16 v[94:95], v8 offset:3552
    buffer_load_dwordx4 v3, s[12:15], s71 offen lds
    s_waitcnt lgkmcnt(6)
    v_mfma_f32_16x16x32_bf16 v[48:51], a[48:51], v[100:103], v[48:51]
    ds_read_b64_tr_b16 v[96:97], v7 offset:2304
    s_add_u32 s84, s84, 83968
    v_mfma_f32_16x16x32_bf16 v[52:55], a[52:55], v[100:103], v[52:55]
    ds_read_b64_tr_b16 v[98:99], v7 offset:3584
    s_waitcnt lgkmcnt(6)
    v_mfma_f32_16x16x32_bf16 v[56:59], a[48:51], v[104:107], v[56:59]
    ds_read_b128 a[56:59], v111 offset:16384
    ds_read_b128 a[60:63], v111 offset:18432
    v_lshl_add_u32 v13, v1, 4, s84
    s_add_u32 m0, s31, 86016
    v_mfma_f32_16x16x32_bf16 v[60:63], a[52:55], v[104:107], v[60:63]
    ds_read_b64_tr_b16 v[100:101], v7 offset:12288
    ds_read_b64_tr_b16 v[102:103], v7 offset:13568
    buffer_load_dwordx4 v4, s[12:15], s71 offen lds
    s_waitcnt lgkmcnt(8)
    v_mfma_f32_16x16x32_bf16 v[64:67], a[48:51], v[88:91], v[64:67]
    ds_read_b64_tr_b16 v[104:105], v8 offset:12320
    s_lshl_b32 s84, s28, 12
    v_mfma_f32_16x16x32_bf16 v[68:71], a[52:55], v[88:91], v[68:71]
    ds_read_b64_tr_b16 v[106:107], v8 offset:13600
    s_waitcnt lgkmcnt(8)
    v_mfma_f32_16x16x32_bf16 v[72:75], a[48:51], v[92:95], v[72:75]
    ds_read_b64_tr_b16 v[88:89], v7 offset:12352
    s_add_u32 m0, s31, 87040
    v_mfma_f32_16x16x32_bf16 v[76:79], a[52:55], v[92:95], v[76:79]
    ds_read_b64_tr_b16 v[90:91], v7 offset:13632
    buffer_load_dwordx4 v5, s[12:15], s71 offen lds
    s_waitcnt lgkmcnt(8)
    v_mfma_f32_16x16x32_bf16 v[80:83], a[48:51], v[96:99], v[80:83]
    ds_read_b64_tr_b16 v[92:93], v8 offset:12384
    s_add_u32 s84, s84, 83968
    v_mfma_f32_16x16x32_bf16 v[84:87], a[52:55], v[96:99], v[84:87]
    ds_read_b64_tr_b16 v[94:95], v8 offset:13664
    s_waitcnt lgkmcnt(6)
    v_mfma_f32_16x16x32_bf16 v[16:19], a[56:59], v[100:103], v[16:19]
    ds_read_b64_tr_b16 v[96:97], v7 offset:12416
    v_lshl_add_u32 v14, v1, 4, s84
    s_add_u32 m0, s31, 88064
    v_mfma_f32_16x16x32_bf16 v[20:23], a[60:63], v[100:103], v[20:23]
    ds_read_b64_tr_b16 v[98:99], v7 offset:13696
    buffer_load_dwordx4 v6, s[12:15], s71 offen lds
    s_waitcnt lgkmcnt(6)
    v_mfma_f32_16x16x32_bf16 v[24:27], a[56:59], v[104:107], v[24:27]
    ds_read_b64_tr_b16 v[100:101], v8 offset:12448
    v_mfma_f32_16x16x32_bf16 v[28:31], a[60:63], v[104:107], v[28:31]
    ds_read_b64_tr_b16 v[102:103], v8 offset:13728
    s_waitcnt lgkmcnt(6)
    v_mfma_f32_16x16x32_bf16 v[32:35], a[56:59], v[88:91], v[32:35]
    ds_read_b64_tr_b16 v[104:105], v7 offset:12480
    v_mfma_f32_16x16x32_bf16 v[36:39], a[60:63], v[88:91], v[36:39]
    ds_read_b64_tr_b16 v[106:107], v7 offset:13760
    s_waitcnt lgkmcnt(6)
    v_mfma_f32_16x16x32_bf16 v[40:43], a[56:59], v[92:95], v[40:43]
    ds_read_b64_tr_b16 v[88:89], v8 offset:12512
    v_mfma_f32_16x16x32_bf16 v[44:47], a[60:63], v[92:95], v[44:47]
    ds_read_b64_tr_b16 v[90:91], v8 offset:13792
    s_waitcnt lgkmcnt(6)
    v_mfma_f32_16x16x32_bf16 v[48:51], a[56:59], v[96:99], v[48:51]
    ds_read_b64_tr_b16 v[92:93], v7 offset:12544
    v_mfma_f32_16x16x32_bf16 v[52:55], a[60:63], v[96:99], v[52:55]
    ds_read_b64_tr_b16 v[94:95], v7 offset:13824
    s_waitcnt lgkmcnt(6)
    v_mfma_f32_16x16x32_bf16 v[56:59], a[56:59], v[100:103], v[56:59]
    v_mfma_f32_16x16x32_bf16 v[60:63], a[60:63], v[100:103], v[60:63]
    s_waitcnt vmcnt(5) lgkmcnt(0)
    s_barrier
    v_mfma_f32_16x16x32_bf16 v[64:67], a[56:59], v[104:107], v[64:67]
    ds_read_b128 a[64:67], v110 offset:0
    ds_read_b128 a[68:71], v110 offset:2048
    s_add_u32 m0, s35, 140672
    v_mfma_f32_16x16x32_bf16 v[68:71], a[60:63], v[104:107], v[68:71]
    ds_read_b64_tr_b16 v[96:97], v7 offset:43008
    ds_read_b64_tr_b16 v[98:99], v7 offset:44288
    buffer_load_dwordx4 v108, s[8:11], 0 offen offset:640 lds
    v_mfma_f32_16x16x32_bf16 v[72:75], a[56:59], v[88:91], v[72:75]
    ds_read_b64_tr_b16 v[100:101], v8 offset:43040
    ds_read_b64_tr_b16 v[102:103], v8 offset:44320
    v_mfma_f32_16x16x32_bf16 v[76:79], a[60:63], v[88:91], v[76:79]
    ds_read_b64_tr_b16 v[104:105], v7 offset:43072
    v_mfma_f32_16x16x32_bf16 v[80:83], a[56:59], v[92:95], v[80:83]
    ds_read_b64_tr_b16 v[106:107], v7 offset:44352
    ds_read_b64_tr_b16 v[88:89], v8 offset:43104
    s_add_u32 m0, s35, 141696
    v_mfma_f32_16x16x32_bf16 v[84:87], a[60:63], v[92:95], v[84:87]
    ds_read_b64_tr_b16 v[90:91], v8 offset:44384
    buffer_load_dwordx4 v109, s[8:11], 0 offen offset:640 lds
    s_waitcnt lgkmcnt(6)
    v_mfma_f32_16x16x32_bf16 v[16:19], a[64:67], v[96:99], v[16:19]
    ds_read_b64_tr_b16 v[92:93], v7 offset:43136
    v_mfma_f32_16x16x32_bf16 v[20:23], a[68:71], v[96:99], v[20:23]
    ds_read_b64_tr_b16 v[94:95], v7 offset:44416
    s_cmp_lg_u32 s28, 0
    s_cbranch_scc1 L_arra
    s_lshl_b32 s70, s3, 4
    s_add_u32 s70, s70, 132
    v_mov_b32 v15, s70
    s_lshl_b32 s70, s30, 3
    v_writelane_b32 v15, s70, 0
    v_mov_b32 v0, 1
    s_mov_b64 exec, 3
    buffer_atomic_add v0, v15, s[24:27], 0 offen sc1
    s_mov_b64 exec, -1
L_arra:
    s_waitcnt lgkmcnt(6)
    v_mfma_f32_16x16x32_bf16 v[24:27], a[64:67], v[100:103], v[24:27]
    ds_read_b64_tr_b16 v[96:97], v8 offset:43168
    s_mov_b32 s71, 1327104
    s_add_u32 m0, s31, 2048
    v_mfma_f32_16x16x32_bf16 v[28:31], a[68:71], v[100:103], v[28:31]
    ds_read_b64_tr_b16 v[98:99], v8 offset:44448
    buffer_load_dwordx4 v2, s[12:15], s71 offen lds
    s_waitcnt lgkmcnt(6)
    v_mfma_f32_16x16x32_bf16 v[32:35], a[64:67], v[104:107], v[32:35]
    ds_read_b64_tr_b16 v[100:101], v7 offset:43200
    v_mfma_f32_16x16x32_bf16 v[36:39], a[68:71], v[104:107], v[36:39]
    ds_read_b64_tr_b16 v[102:103], v7 offset:44480
    s_waitcnt lgkmcnt(6)
    v_mfma_f32_16x16x32_bf16 v[40:43], a[64:67], v[88:91], v[40:43]
    ds_read_b64_tr_b16 v[104:105], v8 offset:43232
    s_add_u32 m0, s31, 3072
    v_mfma_f32_16x16x32_bf16 v[44:47], a[68:71], v[88:91], v[44:47]
    ds_read_b64_tr_b16 v[106:107], v8 offset:44512
    buffer_load_dwordx4 v3, s[12:15], s71 offen lds
    s_waitcnt lgkmcnt(6)
    v_mfma_f32_16x16x32_bf16 v[48:51], a[64:67], v[92:95], v[48:51]
    ds_read_b64_tr_b16 v[88:89], v7 offset:43264
    v_mfma_f32_16x16x32_bf16 v[52:55], a[68:71], v[92:95], v[52:55]
    ds_read_b64_tr_b16 v[90:91], v7 offset:44544
    s_waitcnt lgkmcnt(6)
    v_mfma_f32_16x16x32_bf16 v[56:59], a[64:67], v[96:99], v[56:59]
    ds_read_b128 a[72:75], v111 offset:0
    ds_read_b128 a[76:79], v111 offset:2048
    s_add_u32 m0, s31, 4096
    v_mfma_f32_16x16x32_bf16 v[60:63], a[68:71], v[96:99], v[60:63]
    ds_read_b64_tr_b16 v[92:93], v7 offset:53248
    ds_read_b64_tr_b16 v[94:95], v7 offset:54528
    buffer_load_dwordx4 v4, s[12:15], s71 offen lds
    s_waitcnt lgkmcnt(8)
    v_mfma_f32_16x16x32_bf16 v[64:67], a[64:67], v[100:103], v[64:67]
    ds_read_b64_tr_b16 v[96:97], v8 offset:53280
    v_mfma_f32_16x16x32_bf16 v[68:71], a[68:71], v[100:103], v[68:71]
    ds_read_b64_tr_b16 v[98:99], v8 offset:54560
    s_waitcnt lgkmcnt(8)
    v_mfma_f32_16x16x32_bf16 v[72:75], a[64:67], v[104:107], v[72:75]
    ds_read_b64_tr_b16 v[100:101], v7 offset:53312
    s_add_u32 m0, s31, 5120
    v_mfma_f32_16x16x32_bf16 v[76:79], a[68:71], v[104:107], v[76:79]
    ds_read_b64_tr_b16 v[102:103], v7 offset:54592
    buffer_load_dwordx4 v5, s[12:15], s71 offen lds
    s_waitcnt lgkmcnt(8)
    v_mfma_f32_16x16x32_bf16 v[80:83], a[64:67], v[88:91], v[80:83]
    ds_read_b64_tr_b16 v[104:105], v8 offset:53344
    v_mfma_f32_16x16x32_bf16 v[84:87], a[68:71], v[88:91], v[84:87]
    ds_read_b64_tr_b16 v[106:107], v8 offset:54624
    s_waitcnt lgkmcnt(6)
    v_mfma_f32_16x16x32_bf16 v[16:19], a[72:75], v[92:95], v[16:19]
    ds_read_b64_tr_b16 v[88:89], v7 offset:53376
    s_add_u32 m0, s31, 6144
    v_mfma_f32_16x16x32_bf16 v[20:23], a[76:79], v[92:95], v[20:23]
    ds_read_b64_tr_b16 v[90:91], v7 offset:54656
    buffer_load_dwordx4 v6, s[12:15], s71 offen lds
    s_waitcnt lgkmcnt(6)
    v_mfma_f32_16x16x32_bf16 v[24:27], a[72:75], v[96:99], v[24:27]
    ds_read_b64_tr_b16 v[92:93], v8 offset:53408
    v_mfma_f32_16x16x32_bf16 v[28:31], a[76:79], v[96:99], v[28:31]
    ds_read_b64_tr_b16 v[94:95], v8 offset:54688
    s_waitcnt lgkmcnt(6)
    v_mfma_f32_16x16x32_bf16 v[32:35], a[72:75], v[100:103], v[32:35]
    ds_read_b64_tr_b16 v[96:97], v7 offset:53440
    v_mfma_f32_16x16x32_bf16 v[36:39], a[76:79], v[100:103], v[36:39]
    ds_read_b64_tr_b16 v[98:99], v7 offset:54720
    s_waitcnt lgkmcnt(6)
    v_mfma_f32_16x16x32_bf16 v[40:43], a[72:75], v[104:107], v[40:43]
    ds_read_b64_tr_b16 v[100:101], v8 offset:53472
    v_mfma_f32_16x16x32_bf16 v[44:47], a[76:79], v[104:107], v[44:47]
    ds_read_b64_tr_b16 v[102:103], v8 offset:54752
    s_waitcnt lgkmcnt(6)
    v_mfma_f32_16x16x32_bf16 v[48:51], a[72:75], v[88:91], v[48:51]
    ds_read_b64_tr_b16 v[104:105], v7 offset:53504
    v_mfma_f32_16x16x32_bf16 v[52:55], a[76:79], v[88:91], v[52:55]
    ds_read_b64_tr_b16 v[106:107], v7 offset:54784
    s_waitcnt lgkmcnt(6)
    v_mfma_f32_16x16x32_bf16 v[56:59], a[72:75], v[92:95], v[56:59]
    v_mfma_f32_16x16x32_bf16 v[60:63], a[76:79], v[92:95], v[60:63]
    s_waitcnt vmcnt(5) lgkmcnt(0)
    s_barrier
    v_mfma_f32_16x16x32_bf16 v[64:67], a[72:75], v[96:99], v[64:67]
    ds_read_b128 a[80:83], v110 offset:16384
    ds_read_b128 a[84:87], v110 offset:18432
    s_add_u32 m0, s35, 124160
    v_mfma_f32_16x16x32_bf16 v[68:71], a[76:79], v[96:99], v[68:71]
    ds_read_b64_tr_b16 v[88:89], v9 offset:18432
    ds_read_b64_tr_b16 v[90:91], v9 offset:19712
    buffer_load_dwordx4 v108, s[8:11], 0 offen offset:768 lds
    v_mfma_f32_16x16x32_bf16 v[72:75], a[72:75], v[100:103], v[72:75]
    ds_read_b64_tr_b16 v[92:93], v10 offset:18464
    ds_read_b64_tr_b16 v[94:95], v10 offset:19744
    v_mfma_f32_16x16x32_bf16 v[76:79], a[76:79], v[100:103], v[76:79]
    ds_read_b64_tr_b16 v[96:97], v9 offset:18496
    v_mfma_f32_16x16x32_bf16 v[80:83], a[72:75], v[104:107], v[80:83]
    ds_read_b64_tr_b16 v[98:99], v9 offset:19776
    ds_read_b64_tr_b16 v[100:101], v10 offset:18528
    s_add_u32 m0, s35, 125184
    v_mfma_f32_16x16x32_bf16 v[84:87], a[76:79], v[104:107], v[84:87]
    ds_read_b64_tr_b16 v[102:103], v10 offset:19808
    buffer_load_dwordx4 v109, s[8:11], 0 offen offset:768 lds
    s_waitcnt lgkmcnt(6)
    v_mfma_f32_16x16x32_bf16 v[16:19], a[80:83], v[88:91], v[16:19]
    ds_read_b64_tr_b16 v[104:105], v9 offset:18560
    v_mfma_f32_16x16x32_bf16 v[20:23], a[84:87], v[88:91], v[20:23]
    ds_read_b64_tr_b16 v[106:107], v9 offset:19840
    s_waitcnt lgkmcnt(6)
    v_mfma_f32_16x16x32_bf16 v[24:27], a[80:83], v[92:95], v[24:27]
    ds_read_b64_tr_b16 v[88:89], v10 offset:18592
    s_mov_b32 s71, 1548288
    s_add_u32 m0, s31, 43008
    v_mfma_f32_16x16x32_bf16 v[28:31], a[84:87], v[92:95], v[28:31]
    ds_read_b64_tr_b16 v[90:91], v10 offset:19872
    buffer_load_dwordx4 v2, s[12:15], s71 offen lds
    s_waitcnt lgkmcnt(6)
    v_mfma_f32_16x16x32_bf16 v[32:35], a[80:83], v[96:99], v[32:35]
    ds_read_b64_tr_b16 v[92:93], v9 offset:18624
    v_mfma_f32_16x16x32_bf16 v[36:39], a[84:87], v[96:99], v[36:39]
    ds_read_b64_tr_b16 v[94:95], v9 offset:19904
    s_waitcnt lgkmcnt(6)
    v_mfma_f32_16x16x32_bf16 v[40:43], a[80:83], v[100:103], v[40:43]
    ds_read_b64_tr_b16 v[96:97], v10 offset:18656
    s_add_u32 m0, s31, 44032
    v_mfma_f32_16x16x32_bf16 v[44:47], a[84:87], v[100:103], v[44:47]
    ds_read_b64_tr_b16 v[98:99], v10 offset:19936
    buffer_load_dwordx4 v3, s[12:15], s71 offen lds
    s_waitcnt lgkmcnt(6)
    v_mfma_f32_16x16x32_bf16 v[48:51], a[80:83], v[104:107], v[48:51]
    ds_read_b64_tr_b16 v[100:101], v9 offset:18688
    v_mfma_f32_16x16x32_bf16 v[52:55], a[84:87], v[104:107], v[52:55]
    ds_read_b64_tr_b16 v[102:103], v9 offset:19968
    s_waitcnt lgkmcnt(6)
    v_mfma_f32_16x16x32_bf16 v[56:59], a[80:83], v[88:91], v[56:59]
    ds_read_b128 a[88:91], v111 offset:16384
    ds_read_b128 a[92:95], v111 offset:18432
    s_add_u32 m0, s31, 45056
    v_mfma_f32_16x16x32_bf16 v[60:63], a[84:87], v[88:91], v[60:63]
    ds_read_b64_tr_b16 v[104:105], v9 offset:28672
    ds_read_b64_tr_b16 v[106:107], v9 offset:29952
    buffer_load_dwordx4 v4, s[12:15], s71 offen lds
    s_waitcnt lgkmcnt(8)
    v_mfma_f32_16x16x32_bf16 v[64:67], a[80:83], v[92:95], v[64:67]
    ds_read_b64_tr_b16 v[88:89], v10 offset:28704
    v_mfma_f32_16x16x32_bf16 v[68:71], a[84:87], v[92:95], v[68:71]
    ds_read_b64_tr_b16 v[90:91], v10 offset:29984
    s_waitcnt lgkmcnt(8)
    v_mfma_f32_16x16x32_bf16 v[72:75], a[80:83], v[96:99], v[72:75]
    ds_read_b64_tr_b16 v[92:93], v9 offset:28736
    s_add_u32 m0, s31, 46080
    v_mfma_f32_16x16x32_bf16 v[76:79], a[84:87], v[96:99], v[76:79]
    ds_read_b64_tr_b16 v[94:95], v9 offset:30016
    buffer_load_dwordx4 v5, s[12:15], s71 offen lds
    s_waitcnt lgkmcnt(8)
    v_mfma_f32_16x16x32_bf16 v[80:83], a[80:83], v[100:103], v[80:83]
    ds_read_b64_tr_b16 v[96:97], v10 offset:28768
    v_mfma_f32_16x16x32_bf16 v[84:87], a[84:87], v[100:103], v[84:87]
    ds_read_b64_tr_b16 v[98:99], v10 offset:30048
    s_waitcnt lgkmcnt(6)
    v_mfma_f32_16x16x32_bf16 v[16:19], a[88:91], v[104:107], v[16:19]
    ds_read_b64_tr_b16 v[100:101], v9 offset:28800
    s_add_u32 m0, s31, 47104
    v_mfma_f32_16x16x32_bf16 v[20:23], a[92:95], v[104:107], v[20:23]
    ds_read_b64_tr_b16 v[102:103], v9 offset:30080
    buffer_load_dwordx4 v6, s[12:15], s71 offen lds
    s_waitcnt lgkmcnt(6)
    v_mfma_f32_16x16x32_bf16 v[24:27], a[88:91], v[88:91], v[24:27]
    ds_read_b64_tr_b16 v[104:105], v10 offset:28832
    v_mfma_f32_16x16x32_bf16 v[28:31], a[92:95], v[88:91], v[28:31]
    ds_read_b64_tr_b16 v[106:107], v10 offset:30112
    s_waitcnt lgkmcnt(6)
    v_mfma_f32_16x16x32_bf16 v[32:35], a[88:91], v[92:95], v[32:35]
    ds_read_b64_tr_b16 v[88:89], v9 offset:28864
    v_mfma_f32_16x16x32_bf16 v[36:39], a[92:95], v[92:95], v[36:39]
    ds_read_b64_tr_b16 v[90:91], v9 offset:30144
    s_waitcnt lgkmcnt(6)
    v_mfma_f32_16x16x32_bf16 v[40:43], a[88:91], v[96:99], v[40:43]
    ds_read_b64_tr_b16 v[92:93], v10 offset:28896
    v_mfma_f32_16x16x32_bf16 v[44:47], a[92:95], v[96:99], v[44:47]
    ds_read_b64_tr_b16 v[94:95], v10 offset:30176
    s_waitcnt lgkmcnt(6)
    v_mfma_f32_16x16x32_bf16 v[48:51], a[88:91], v[100:103], v[48:51]
    ds_read_b64_tr_b16 v[96:97], v9 offset:28928
    v_mfma_f32_16x16x32_bf16 v[52:55], a[92:95], v[100:103], v[52:55]
    ds_read_b64_tr_b16 v[98:99], v9 offset:30208
    s_waitcnt lgkmcnt(6)
    v_mfma_f32_16x16x32_bf16 v[56:59], a[88:91], v[104:107], v[56:59]
    v_mfma_f32_16x16x32_bf16 v[60:63], a[92:95], v[104:107], v[60:63]
    s_waitcnt vmcnt(5) lgkmcnt(0)
    s_barrier
    v_mfma_f32_16x16x32_bf16 v[64:67], a[88:91], v[88:91], v[64:67]
    ds_read_b128 a[96:99], v110 offset:0
    ds_read_b128 a[100:103], v110 offset:2048
    s_add_u32 m0, s35, 140416
    v_mfma_f32_16x16x32_bf16 v[68:71], a[92:95], v[88:91], v[68:71]
    ds_read_b64_tr_b16 v[100:101], v7 offset:2048
    ds_read_b64_tr_b16 v[102:103], v7 offset:3328
    buffer_load_dwordx4 v108, s[8:11], 0 offen offset:896 lds
    v_mfma_f32_16x16x32_bf16 v[72:75], a[88:91], v[92:95], v[72:75]
    ds_read_b64_tr_b16 v[104:105], v8 offset:2080
    ds_read_b64_tr_b16 v[106:107], v8 offset:3360
    v_mfma_f32_16x16x32_bf16 v[76:79], a[92:95], v[92:95], v[76:79]
    ds_read_b64_tr_b16 v[88:89], v7 offset:2112
    v_mfma_f32_16x16x32_bf16 v[80:83], a[88:91], v[96:99], v[80:83]
    ds_read_b64_tr_b16 v[90:91], v7 offset:3392
    ds_read_b64_tr_b16 v[92:93], v8 offset:2144
    s_add_u32 m0, s35, 141440
    v_mfma_f32_16x16x32_bf16 v[84:87], a[92:95], v[96:99], v[84:87]
    ds_read_b64_tr_b16 v[94:95], v8 offset:3424
    buffer_load_dwordx4 v109, s[8:11], 0 offen offset:896 lds
    s_waitcnt lgkmcnt(6)
    v_mfma_f32_16x16x32_bf16 v[16:19], a[96:99], v[100:103], v[16:19]
    ds_read_b64_tr_b16 v[96:97], v7 offset:2176
    v_mfma_f32_16x16x32_bf16 v[20:23], a[100:103], v[100:103], v[20:23]
    ds_read_b64_tr_b16 v[98:99], v7 offset:3456
    s_waitcnt lgkmcnt(6)
    v_mfma_f32_16x16x32_bf16 v[24:27], a[96:99], v[104:107], v[24:27]
    ds_read_b64_tr_b16 v[100:101], v8 offset:2208
    s_mov_b32 s71, 1769472
    s_add_u32 m0, s31, 83968
    v_mfma_f32_16x16x32_bf16 v[28:31], a[100:103], v[104:107], v[28:31]
    ds_read_b64_tr_b16 v[102:103], v8 offset:3488
    buffer_load_dwordx4 v2, s[12:15], s71 offen lds
    s_waitcnt lgkmcnt(6)
    v_mfma_f32_16x16x32_bf16 v[32:35], a[96:99], v[88:91], v[32:35]
    ds_read_b64_tr_b16 v[104:105], v7 offset:2240
    v_mfma_f32_16x16x32_bf16 v[36:39], a[100:103], v[88:91], v[36:39]
    ds_read_b64_tr_b16 v[106:107], v7 offset:3520
    s_waitcnt lgkmcnt(6)
    v_mfma_f32_16x16x32_bf16 v[40:43], a[96:99], v[92:95], v[40:43]
    ds_read_b64_tr_b16 v[88:89], v8 offset:2272
    s_add_u32 m0, s31, 84992
    v_mfma_f32_16x16x32_bf16 v[44:47], a[100:103], v[92:95], v[44:47]
    ds_read_b64_tr_b16 v[90:91], v8 offset:3552
    buffer_load_dwordx4 v3, s[12:15], s71 offen lds
    s_waitcnt lgkmcnt(6)
    v_mfma_f32_16x16x32_bf16 v[48:51], a[96:99], v[96:99], v[48:51]
    ds_read_b64_tr_b16 v[92:93], v7 offset:2304
    v_mfma_f32_16x16x32_bf16 v[52:55], a[100:103], v[96:99], v[52:55]
    ds_read_b64_tr_b16 v[94:95], v7 offset:3584
    s_waitcnt lgkmcnt(6)
    v_mfma_f32_16x16x32_bf16 v[56:59], a[96:99], v[100:103], v[56:59]
    ds_read_b128 a[104:107], v111 offset:0
    ds_read_b128 a[108:111], v111 offset:2048
    s_add_u32 m0, s31, 86016
    v_mfma_f32_16x16x32_bf16 v[60:63], a[100:103], v[100:103], v[60:63]
    ds_read_b64_tr_b16 v[96:97], v7 offset:12288
    ds_read_b64_tr_b16 v[98:99], v7 offset:13568
    buffer_load_dwordx4 v4, s[12:15], s71 offen lds
    s_waitcnt lgkmcnt(8)
    v_mfma_f32_16x16x32_bf16 v[64:67], a[96:99], v[104:107], v[64:67]
    ds_read_b64_tr_b16 v[100:101], v8 offset:12320
    v_mfma_f32_16x16x32_bf16 v[68:71], a[100:103], v[104:107], v[68:71]
    ds_read_b64_tr_b16 v[102:103], v8 offset:13600
    s_waitcnt lgkmcnt(8)
    v_mfma_f32_16x16x32_bf16 v[72:75], a[96:99], v[88:91], v[72:75]
    ds_read_b64_tr_b16 v[104:105], v7 offset:12352
    s_add_u32 m0, s31, 87040
    v_mfma_f32_16x16x32_bf16 v[76:79], a[100:103], v[88:91], v[76:79]
    ds_read_b64_tr_b16 v[106:107], v7 offset:13632
    buffer_load_dwordx4 v5, s[12:15], s71 offen lds
    s_waitcnt lgkmcnt(8)
    v_mfma_f32_16x16x32_bf16 v[80:83], a[96:99], v[92:95], v[80:83]
    ds_read_b64_tr_b16 v[88:89], v8 offset:12384
    v_mfma_f32_16x16x32_bf16 v[84:87], a[100:103], v[92:95], v[84:87]
    ds_read_b64_tr_b16 v[90:91], v8 offset:13664
    s_waitcnt lgkmcnt(6)
    v_mfma_f32_16x16x32_bf16 v[16:19], a[104:107], v[96:99], v[16:19]
    ds_read_b64_tr_b16 v[92:93], v7 offset:12416
    s_add_u32 m0, s31, 88064
    v_mfma_f32_16x16x32_bf16 v[20:23], a[108:111], v[96:99], v[20:23]
    ds_read_b64_tr_b16 v[94:95], v7 offset:13696
    buffer_load_dwordx4 v6, s[12:15], s71 offen lds
    s_waitcnt lgkmcnt(6)
    v_mfma_f32_16x16x32_bf16 v[24:27], a[104:107], v[100:103], v[24:27]
    ds_read_b64_tr_b16 v[96:97], v8 offset:12448
    v_mfma_f32_16x16x32_bf16 v[28:31], a[108:111], v[100:103], v[28:31]
    ds_read_b64_tr_b16 v[98:99], v8 offset:13728
    s_waitcnt lgkmcnt(6)
    v_mfma_f32_16x16x32_bf16 v[32:35], a[104:107], v[104:107], v[32:35]
    ds_read_b64_tr_b16 v[100:101], v7 offset:12480
    v_mfma_f32_16x16x32_bf16 v[36:39], a[108:111], v[104:107], v[36:39]
    ds_read_b64_tr_b16 v[102:103], v7 offset:13760
    s_waitcnt lgkmcnt(6)
    v_mfma_f32_16x16x32_bf16 v[40:43], a[104:107], v[88:91], v[40:43]
    ds_read_b64_tr_b16 v[104:105], v8 offset:12512
    v_mfma_f32_16x16x32_bf16 v[44:47], a[108:111], v[88:91], v[44:47]
    ds_read_b64_tr_b16 v[106:107], v8 offset:13792
    s_waitcnt lgkmcnt(6)
    v_mfma_f32_16x16x32_bf16 v[48:51], a[104:107], v[92:95], v[48:51]
    ds_read_b64_tr_b16 v[88:89], v7 offset:12544
    v_mfma_f32_16x16x32_bf16 v[52:55], a[108:111], v[92:95], v[52:55]
    ds_read_b64_tr_b16 v[90:91], v7 offset:13824
    s_waitcnt lgkmcnt(6)
    v_mfma_f32_16x16x32_bf16 v[56:59], a[104:107], v[96:99], v[56:59]
    v_mfma_f32_16x16x32_bf16 v[60:63], a[108:111], v[96:99], v[60:63]
    s_waitcnt vmcnt(5) lgkmcnt(0)
    s_barrier
    v_mfma_f32_16x16x32_bf16 v[64:67], a[104:107], v[100:103], v[64:67]
    ds_read_b128 a[112:115], v110 offset:16384
    ds_read_b128 a[116:119], v110 offset:18432
    s_add_u32 m0, s35, 123904
    v_mfma_f32_16x16x32_bf16 v[68:71], a[108:111], v[100:103], v[68:71]
    ds_read_b64_tr_b16 v[92:93], v7 offset:43008
    ds_read_b64_tr_b16 v[94:95], v7 offset:44288
    buffer_load_dwordx4 v108, s[8:11], 0 offen offset:1024 lds
    v_mfma_f32_16x16x32_bf16 v[72:75], a[104:107], v[104:107], v[72:75]
    ds_read_b64_tr_b16 v[96:97], v8 offset:43040
    ds_read_b64_tr_b16 v[98:99], v8 offset:44320
    v_mfma_f32_16x16x32_bf16 v[76:79], a[108:111], v[104:107], v[76:79]
    ds_read_b64_tr_b16 v[100:101], v7 offset:43072
    v_mfma_f32_16x16x32_bf16 v[80:83], a[104:107], v[88:91], v[80:83]
    ds_read_b64_tr_b16 v[102:103], v7 offset:44352
    ds_read_b64_tr_b16 v[104:105], v8 offset:43104
    s_add_u32 m0, s35, 124928
    v_mfma_f32_16x16x32_bf16 v[84:87], a[108:111], v[88:91], v[84:87]
    ds_read_b64_tr_b16 v[106:107], v8 offset:44384
    buffer_load_dwordx4 v109, s[8:11], 0 offen offset:1024 lds
    s_waitcnt lgkmcnt(6)
    v_mfma_f32_16x16x32_bf16 v[16:19], a[112:115], v[92:95], v[16:19]
    ds_read_b64_tr_b16 v[88:89], v7 offset:43136
    v_mfma_f32_16x16x32_bf16 v[20:23], a[116:119], v[92:95], v[20:23]
    ds_read_b64_tr_b16 v[90:91], v7 offset:44416
    s_waitcnt lgkmcnt(6)
    v_mfma_f32_16x16x32_bf16 v[24:27], a[112:115], v[96:99], v[24:27]
    ds_read_b64_tr_b16 v[92:93], v8 offset:43168
    s_mul_i32 s71, s7, 221184
    s_add_u32 s71, s71, 0
    s_add_u32 m0, s31, 2048
    v_mfma_f32_16x16x32_bf16 v[28:31], a[116:119], v[96:99], v[28:31]
    ds_read_b64_tr_b16 v[94:95], v8 offset:44448
    v_subrev_u32 v2, s83, v2
    buffer_load_dwordx4 v2, s[12:15], s71 offen lds
    s_waitcnt lgkmcnt(6)
    v_mfma_f32_16x16x32_bf16 v[32:35], a[112:115], v[100:103], v[32:35]
    ds_read_b64_tr_b16 v[96:97], v7 offset:43200
    v_mfma_f32_16x16x32_bf16 v[36:39], a[116:119], v[100:103], v[36:39]
    ds_read_b64_tr_b16 v[98:99], v7 offset:44480
    s_waitcnt lgkmcnt(6)
    v_mfma_f32_16x16x32_bf16 v[40:43], a[112:115], v[104:107], v[40:43]
    ds_read_b64_tr_b16 v[100:101], v8 offset:43232
    s_add_u32 m0, s31, 3072
    v_mfma_f32_16x16x32_bf16 v[44:47], a[116:119], v[104:107], v[44:47]
    ds_read_b64_tr_b16 v[102:103], v8 offset:44512
    v_subrev_u32 v3, s83, v3
    buffer_load_dwordx4 v3, s[12:15], s71 offen lds
    s_waitcnt lgkmcnt(6)
    v_mfma_f32_16x16x32_bf16 v[48:51], a[112:115], v[88:91], v[48:51]
    ds_read_b64_tr_b16 v[104:105], v7 offset:43264
    v_mfma_f32_16x16x32_bf16 v[52:55], a[116:119], v[88:91], v[52:55]
    ds_read_b64_tr_b16 v[106:107], v7 offset:44544
    s_waitcnt lgkmcnt(6)
    v_mfma_f32_16x16x32_bf16 v[56:59], a[112:115], v[92:95], v[56:59]
    ds_read_b128 a[120:123], v111 offset:16384
    ds_read_b128 a[124:127], v111 offset:18432
    s_add_u32 m0, s31, 4096
    v_mfma_f32_16x16x32_bf16 v[60:63], a[116:119], v[92:95], v[60:63]
    ds_read_b64_tr_b16 v[88:89], v7 offset:53248
    ds_read_b64_tr_b16 v[90:91], v7 offset:54528
    v_subrev_u32 v4, s83, v4
    buffer_load_dwordx4 v4, s[12:15], s71 offen lds
    s_waitcnt lgkmcnt(8)
    v_mfma_f32_16x16x32_bf16 v[64:67], a[112:115], v[96:99], v[64:67]
    ds_read_b64_tr_b16 v[92:93], v8 offset:53280
    v_mfma_f32_16x16x32_bf16 v[68:71], a[116:119], v[96:99], v[68:71]
    ds_read_b64_tr_b16 v[94:95], v8 offset:54560
    s_waitcnt lgkmcnt(8)
    v_mfma_f32_16x16x32_bf16 v[72:75], a[112:115], v[100:103], v[72:75]
    ds_read_b64_tr_b16 v[96:97], v7 offset:53312
    s_add_u32 m0, s31, 5120
    v_mfma_f32_16x16x32_bf16 v[76:79], a[116:119], v[100:103], v[76:79]
    ds_read_b64_tr_b16 v[98:99], v7 offset:54592
    v_subrev_u32 v5, s83, v5
    buffer_load_dwordx4 v5, s[12:15], s71 offen lds
    s_waitcnt lgkmcnt(8)
    v_mfma_f32_16x16x32_bf16 v[80:83], a[112:115], v[104:107], v[80:83]
    ds_read_b64_tr_b16 v[100:101], v8 offset:53344
    v_mfma_f32_16x16x32_bf16 v[84:87], a[116:119], v[104:107], v[84:87]
    ds_read_b64_tr_b16 v[102:103], v8 offset:54624
    s_waitcnt lgkmcnt(6)
    v_mfma_f32_16x16x32_bf16 v[16:19], a[120:123], v[88:91], v[16:19]
    ds_read_b64_tr_b16 v[104:105], v7 offset:53376
    s_add_u32 m0, s31, 6144
    v_mfma_f32_16x16x32_bf16 v[20:23], a[124:127], v[88:91], v[20:23]
    ds_read_b64_tr_b16 v[106:107], v7 offset:54656
    v_subrev_u32 v6, s83, v6
    buffer_load_dwordx4 v6, s[12:15], s71 offen lds
    s_waitcnt lgkmcnt(6)
    v_mfma_f32_16x16x32_bf16 v[24:27], a[120:123], v[92:95], v[24:27]
    ds_read_b64_tr_b16 v[88:89], v8 offset:53408
    v_mfma_f32_16x16x32_bf16 v[28:31], a[124:127], v[92:95], v[28:31]
    ds_read_b64_tr_b16 v[90:91], v8 offset:54688
    s_waitcnt lgkmcnt(6)
    v_mfma_f32_16x16x32_bf16 v[32:35], a[120:123], v[96:99], v[32:35]
    ds_read_b64_tr_b16 v[92:93], v7 offset:53440
    v_mfma_f32_16x16x32_bf16 v[36:39], a[124:127], v[96:99], v[36:39]
    ds_read_b64_tr_b16 v[94:95], v7 offset:54720
    s_waitcnt lgkmcnt(6)
    v_mfma_f32_16x16x32_bf16 v[40:43], a[120:123], v[100:103], v[40:43]
    ds_read_b64_tr_b16 v[96:97], v8 offset:53472
    v_mfma_f32_16x16x32_bf16 v[44:47], a[124:127], v[100:103], v[44:47]
    ds_read_b64_tr_b16 v[98:99], v8 offset:54752
    s_waitcnt lgkmcnt(6)
    v_mfma_f32_16x16x32_bf16 v[48:51], a[120:123], v[104:107], v[48:51]
    ds_read_b64_tr_b16 v[100:101], v7 offset:53504
    v_mfma_f32_16x16x32_bf16 v[52:55], a[124:127], v[104:107], v[52:55]
    ds_read_b64_tr_b16 v[102:103], v7 offset:54784
    s_waitcnt lgkmcnt(6)
    v_mfma_f32_16x16x32_bf16 v[56:59], a[120:123], v[88:91], v[56:59]
    v_mfma_f32_16x16x32_bf16 v[60:63], a[124:127], v[88:91], v[60:63]
    s_waitcnt vmcnt(5) lgkmcnt(0)
    s_barrier
    v_mfma_f32_16x16x32_bf16 v[64:67], a[120:123], v[92:95], v[64:67]
    ds_read_b128 a[128:131], v110 offset:0
    ds_read_b128 a[132:135], v110 offset:2048
    s_mul_i32 s71, s7, 221184
    s_add_u32 s71, s71, 442368
    s_add_u32 m0, s31, 43008
    v_mfma_f32_16x16x32_bf16 v[68:71], a[124:127], v[92:95], v[68:71]
    ds_read_b64_tr_b16 v[104:105], v9 offset:18432
    ds_read_b64_tr_b16 v[106:107], v9 offset:19712
    buffer_load_dwordx4 v2, s[12:15], s71 offen lds
    v_mfma_f32_16x16x32_bf16 v[72:75], a[120:123], v[96:99], v[72:75]
    ds_read_b64_tr_b16 v[88:89], v10 offset:18464
    ds_read_b64_tr_b16 v[90:91], v10 offset:19744
    v_mfma_f32_16x16x32_bf16 v[76:79], a[124:127], v[96:99], v[76:79]
    ds_read_b64_tr_b16 v[92:93], v9 offset:18496
    v_mfma_f32_16x16x32_bf16 v[80:83], a[120:123], v[100:103], v[80:83]
    ds_read_b64_tr_b16 v[94:95], v9 offset:19776
    ds_read_b64_tr_b16 v[96:97], v10 offset:18528
    s_add_u32 m0, s31, 44032
    v_mfma_f32_16x16x32_bf16 v[84:87], a[124:127], v[100:103], v[84:87]
    ds_read_b64_tr_b16 v[98:99], v10 offset:19808
    buffer_load_dwordx4 v3, s[12:15], s71 offen lds
    s_waitcnt lgkmcnt(6)
    v_mfma_f32_16x16x32_bf16 v[16:19], a[128:131], v[104:107], v[16:19]
    ds_read_b64_tr_b16 v[100:101], v9 offset:18560
    v_mfma_f32_16x16x32_bf16 v[20:23], a[132:135], v[104:107], v[20:23]
    ds_read_b64_tr_b16 v[102:103], v9 offset:19840
    s_cmp_lg_u32 s28, 7
    s_cbranch_scc1 L_iniai
    s_lshl_b32 s70, s3, 4
    s_add_u32 s70, s70, 132
    v_mov_b32 v15, s70
    s_lshl_b32 s70, s30, 3
    v_writelane_b32 v15, s70, 0
    v_mov_b32 v0, 0
    s_mov_b64 exec, 3
    buffer_atomic_add v0, v15, s[24:27], 0 offen sc0 sc1
    s_mov_b64 exec, -1
L_iniai:
    s_waitcnt lgkmcnt(6)
    v_mfma_f32_16x16x32_bf16 v[24:27], a[128:131], v[88:91], v[24:27]
    ds_read_b64_tr_b16 v[104:105], v10 offset:18592
    s_add_u32 m0, s31, 45056
    v_mfma_f32_16x16x32_bf16 v[28:31], a[132:135], v[88:91], v[28:31]
    ds_read_b64_tr_b16 v[106:107], v10 offset:19872
    buffer_load_dwordx4 v4, s[12:15], s71 offen lds
    s_waitcnt lgkmcnt(6)
    v_mfma_f32_16x16x32_bf16 v[32:35], a[128:131], v[92:95], v[32:35]
    ds_read_b64_tr_b16 v[88:89], v9 offset:18624
    v_mfma_f32_16x16x32_bf16 v[36:39], a[132:135], v[92:95], v[36:39]
    ds_read_b64_tr_b16 v[90:91], v9 offset:19904
    s_waitcnt lgkmcnt(6)
    v_mfma_f32_16x16x32_bf16 v[40:43], a[128:131], v[96:99], v[40:43]
    ds_read_b64_tr_b16 v[92:93], v10 offset:18656
    s_add_u32 m0, s31, 46080
    v_mfma_f32_16x16x32_bf16 v[44:47], a[132:135], v[96:99], v[44:47]
    ds_read_b64_tr_b16 v[94:95], v10 offset:19936
    buffer_load_dwordx4 v5, s[12:15], s71 offen lds
    s_waitcnt lgkmcnt(6)
    v_mfma_f32_16x16x32_bf16 v[48:51], a[128:131], v[100:103], v[48:51]
    ds_read_b64_tr_b16 v[96:97], v9 offset:18688
    v_mfma_f32_16x16x32_bf16 v[52:55], a[132:135], v[100:103], v[52:55]
    ds_read_b64_tr_b16 v[98:99], v9 offset:19968
    s_waitcnt lgkmcnt(6)
    v_mfma_f32_16x16x32_bf16 v[56:59], a[128:131], v[104:107], v[56:59]
    ds_read_b128 a[136:139], v111 offset:0
    ds_read_b128 a[140:143], v111 offset:2048
    s_add_u32 m0, s31, 47104
    v_mfma_f32_16x16x32_bf16 v[60:63], a[132:135], v[104:107], v[60:63]
    ds_read_b64_tr_b16 v[100:101], v9 offset:28672
    ds_read_b64_tr_b16 v[102:103], v9 offset:29952
    buffer_load_dwordx4 v6, s[12:15], s71 offen lds
    s_waitcnt lgkmcnt(8)
    v_mfma_f32_16x16x32_bf16 v[64:67], a[128:131], v[88:91], v[64:67]
    ds_read_b64_tr_b16 v[104:105], v10 offset:28704
    v_mfma_f32_16x16x32_bf16 v[68:71], a[132:135], v[88:91], v[68:71]
    ds_read_b64_tr_b16 v[106:107], v10 offset:29984
    s_waitcnt lgkmcnt(8)
    v_mfma_f32_16x16x32_bf16 v[72:75], a[128:131], v[92:95], v[72:75]
    ds_read_b64_tr_b16 v[88:89], v9 offset:28736
    v_mfma_f32_16x16x32_bf16 v[76:79], a[132:135], v[92:95], v[76:79]
    ds_read_b64_tr_b16 v[90:91], v9 offset:30016
    s_waitcnt lgkmcnt(8)
    v_mfma_f32_16x16x32_bf16 v[80:83], a[128:131], v[96:99], v[80:83]
    ds_read_b64_tr_b16 v[92:93], v10 offset:28768
    v_mfma_f32_16x16x32_bf16 v[84:87], a[132:135], v[96:99], v[84:87]
    ds_read_b64_tr_b16 v[94:95], v10 offset:30048
    s_waitcnt lgkmcnt(6)
    v_mfma_f32_16x16x32_bf16 v[16:19], a[136:139], v[100:103], v[16:19]
    ds_read_b64_tr_b16 v[96:97], v9 offset:28800
    v_mfma_f32_16x16x32_bf16 v[20:23], a[140:143], v[100:103], v[20:23]
    ds_read_b64_tr_b16 v[98:99], v9 offset:30080
    s_waitcnt lgkmcnt(6)
    v_mfma_f32_16x16x32_bf16 v[24:27], a[136:139], v[104:107], v[24:27]
    ds_read_b64_tr_b16 v[100:101], v10 offset:28832
    v_mfma_f32_16x16x32_bf16 v[28:31], a[140:143], v[104:107], v[28:31]
    ds_read_b64_tr_b16 v[102:103], v10 offset:30112
    s_waitcnt lgkmcnt(6)
    v_mfma_f32_16x16x32_bf16 v[32:35], a[136:139], v[88:91], v[32:35]
    ds_read_b64_tr_b16 v[104:105], v9 offset:28864
    v_mfma_f32_16x16x32_bf16 v[36:39], a[140:143], v[88:91], v[36:39]
    ds_read_b64_tr_b16 v[106:107], v9 offset:30144
    s_waitcnt lgkmcnt(6)
    v_mfma_f32_16x16x32_bf16 v[40:43], a[136:139], v[92:95], v[40:43]
    ds_read_b64_tr_b16 v[88:89], v10 offset:28896
    v_mfma_f32_16x16x32_bf16 v[44:47], a[140:143], v[92:95], v[44:47]
    ds_read_b64_tr_b16 v[90:91], v10 offset:30176
    s_waitcnt lgkmcnt(6)
    v_mfma_f32_16x16x32_bf16 v[48:51], a[136:139], v[96:99], v[48:51]
    ds_read_b64_tr_b16 v[92:93], v9 offset:28928
    v_mfma_f32_16x16x32_bf16 v[52:55], a[140:143], v[96:99], v[52:55]
    ds_read_b64_tr_b16 v[94:95], v9 offset:30208
    s_waitcnt lgkmcnt(6)
    v_mfma_f32_16x16x32_bf16 v[56:59], a[136:139], v[100:103], v[56:59]
    v_mfma_f32_16x16x32_bf16 v[60:63], a[140:143], v[100:103], v[60:63]
    s_waitcnt lgkmcnt(4)
    v_mfma_f32_16x16x32_bf16 v[64:67], a[136:139], v[104:107], v[64:67]
    v_mfma_f32_16x16x32_bf16 v[68:71], a[140:143], v[104:107], v[68:71]
    s_cmp_lg_u32 s28, 7
    s_cbranch_scc1 L_iniac
    s_mov_b32 s5, 0
    s_waitcnt vmcnt(3)
L_inia_l:
    v_cmp_lt_u32 vcc, 15, v0
    s_nop 1
    s_cmp_eq_u32 vcc_lo, 3
    s_cbranch_scc1 L_inia_d
    s_add_u32 s5, s5, 1
    s_cmp_ge_u32 s5, 100000
    s_cbranch_scc1 L_inia_d
    s_sleep 6
    s_lshl_b32 s70, s3, 4
    s_add_u32 s70, s70, 132
    v_mov_b32 v15, s70
    s_lshl_b32 s70, s30, 3
    v_writelane_b32 v15, s70, 0
    v_mov_b32 v0, 0
    s_mov_b64 exec, 3
    buffer_atomic_add v0, v15, s[24:27], 0 offen sc0 sc1
    s_mov_b64 exec, -1
    s_waitcnt vmcnt(0)
    s_branch L_inia_l
L_inia_d:
L_iniac:
    s_waitcnt lgkmcnt(0)
    s_barrier
    v_mfma_f32_16x16x32_bf16 v[72:75], a[136:139], v[88:91], v[72:75]
    v_mfma_f32_16x16x32_bf16 v[76:79], a[140:143], v[88:91], v[76:79]
    v_mfma_f32_16x16x32_bf16 v[80:83], a[136:139], v[92:95], v[80:83]
    v_mfma_f32_16x16x32_bf16 v[84:87], a[140:143], v[92:95], v[84:87]
    s_nop 4
    s_cmp_eq_u32 s7, 0
    s_cbranch_scc0 L_s2_v
    v_mul_f32 v88, s80, v16
    v_mul_f32 v89, s80, v17
    v_mul_f32 v90, s80, v18
    v_mul_f32 v91, s80, v19
    v_mul_f32 v92, s80, v20
    v_mul_f32 v93, s80, v21
    v_mul_f32 v94, s80, v22
    v_mul_f32 v95, s80, v23
    v_exp_f32_e64 v88, v88 clamp
    v_exp_f32_e64 v89, v89 clamp
    v_exp_f32_e64 v90, v90 clamp
    v_exp_f32_e64 v91, v91 clamp
    v_exp_f32_e64 v92, v92 clamp
    v_exp_f32_e64 v93, v93 clamp
    v_exp_f32_e64 v94, v94 clamp
    v_exp_f32_e64 v95, v95 clamp
    v_max_f32 v16, s81, v16
    v_max_f32 v17, s81, v17
    v_max_f32 v18, s81, v18
    v_max_f32 v19, s81, v19
    v_max_f32 v20, s81, v20
    v_max_f32 v21, s81, v21
    v_max_f32 v22, s81, v22
    v_max_f32 v23, s81, v23
    v_add_f32 v16, v16, v88
    v_add_f32 v17, v17, v89
    v_add_f32 v18, v18, v90
    v_add_f32 v19, v19, v91
    v_add_f32 v20, v20, v92
    v_add_f32 v21, v21, v93
    v_add_f32 v22, v22, v94
    v_add_f32 v23, v23, v95
    v_cvt_pk_bf16_f32 v96, v16, v17
    v_cvt_pk_bf16_f32 v97, v18, v19
    v_cvt_pk_bf16_f32 v98, v20, v21
    v_cvt_pk_bf16_f32 v99, v22, v23
    ds_write_b128 v13, v[96:99] offset:0
    v_mul_f32 v88, s80, v24
    v_mul_f32 v89, s80, v25
    v_mul_f32 v90, s80, v26
    v_mul_f32 v91, s80, v27
    v_mul_f32 v92, s80, v28
    v_mul_f32 v93, s80, v29
    v_mul_f32 v94, s80, v30
    v_mul_f32 v95, s80, v31
    v_exp_f32_e64 v88, v88 clamp
    v_exp_f32_e64 v89, v89 clamp
    v_exp_f32_e64 v90, v90 clamp
    v_exp_f32_e64 v91, v91 clamp
    v_exp_f32_e64 v92, v92 clamp
    v_exp_f32_e64 v93, v93 clamp
    v_exp_f32_e64 v94, v94 clamp
    v_exp_f32_e64 v95, v95 clamp
    v_max_f32 v24, s81, v24
    v_max_f32 v25, s81, v25
    v_max_f32 v26, s81, v26
    v_max_f32 v27, s81, v27
    v_max_f32 v28, s81, v28
    v_max_f32 v29, s81, v29
    v_max_f32 v30, s81, v30
    v_max_f32 v31, s81, v31
    v_add_f32 v24, v24, v88
    v_add_f32 v25, v25, v89
    v_add_f32 v26, v26, v90
    v_add_f32 v27, v27, v91
    v_add_f32 v28, v28, v92
    v_add_f32 v29, v29, v93
    v_add_f32 v30, v30, v94
    v_add_f32 v31, v31, v95
    v_cvt_pk_bf16_f32 v100, v24, v25
    v_cvt_pk_bf16_f32 v101, v26, v27
    v_cvt_pk_bf16_f32 v102, v28, v29
    v_cvt_pk_bf16_f32 v103, v30, v31
    ds_write_b128 v13, v[100:103] offset:4096
    v_mul_f32 v88, s80, v32
    v_mul_f32 v89, s80, v33
    v_mul_f32 v90, s80, v34
    v_mul_f32 v91, s80, v35
    v_mul_f32 v92, s80, v36
    v_mul_f32 v93, s80, v37
    v_mul_f32 v94, s80, v38
    v_mul_f32 v95, s80, v39
    v_exp_f32_e64 v88, v88 clamp
    v_exp_f32_e64 v89, v89 clamp
    v_exp_f32_e64 v90, v90 clamp
    v_exp_f32_e64 v91, v91 clamp
    v_exp_f32_e64 v92, v92 clamp
    v_exp_f32_e64 v93, v93 clamp
    v_exp_f32_e64 v94, v94 clamp
    v_exp_f32_e64 v95, v95 clamp
    v_max_f32 v32, s81, v32
    v_max_f32 v33, s81, v33
    v_max_f32 v34, s81, v34
    v_max_f32 v35, s81, v35
    v_max_f32 v36, s81, v36
    v_max_f32 v37, s81, v37
    v_max_f32 v38, s81, v38
    v_max_f32 v39, s81, v39
    v_add_f32 v32, v32, v88
    v_add_f32 v33, v33, v89
    v_add_f32 v34, v34, v90
    v_add_f32 v35, v35, v91
    v_add_f32 v36, v36, v92
    v_add_f32 v37, v37, v93
    v_add_f32 v38, v38, v94
    v_add_f32 v39, v39, v95
    v_cvt_pk_bf16_f32 v104, v32, v33
    v_cvt_pk_bf16_f32 v105, v34, v35
    v_cvt_pk_bf16_f32 v106, v36, v37
    v_cvt_pk_bf16_f32 v107, v38, v39
    ds_write_b128 v13, v[104:107] offset:8192
    v_mul_f32 v88, s80, v40
    v_mul_f32 v89, s80, v41
    v_mul_f32 v90, s80, v42
    v_mul_f32 v91, s80, v43
    v_mul_f32 v92, s80, v44
    v_mul_f32 v93, s80, v45
    v_mul_f32 v94, s80, v46
    v_mul_f32 v95, s80, v47
    v_exp_f32_e64 v88, v88 clamp
    v_exp_f32_e64 v89, v89 clamp
    v_exp_f32_e64 v90, v90 clamp
    v_exp_f32_e64 v91, v91 clamp
    v_exp_f32_e64 v92, v92 clamp
    v_exp_f32_e64 v93, v93 clamp
    v_exp_f32_e64 v94, v94 clamp
    v_exp_f32_e64 v95, v95 clamp
    v_max_f32 v40, s81, v40
    v_max_f32 v41, s81, v41
    v_max_f32 v42, s81, v42
    v_max_f32 v43, s81, v43
    v_max_f32 v44, s81, v44
    v_max_f32 v45, s81, v45
    v_max_f32 v46, s81, v46
    v_max_f32 v47, s81, v47
    v_add_f32 v40, v40, v88
    v_add_f32 v41, v41, v89
    v_add_f32 v42, v42, v90
    v_add_f32 v43, v43, v91
    v_add_f32 v44, v44, v92
    v_add_f32 v45, v45, v93
    v_add_f32 v46, v46, v94
    v_add_f32 v47, v47, v95
    v_cvt_pk_bf16_f32 v96, v40, v41
    v_cvt_pk_bf16_f32 v97, v42, v43
    v_cvt_pk_bf16_f32 v98, v44, v45
    v_cvt_pk_bf16_f32 v99, v46, v47
    ds_write_b128 v13, v[96:99] offset:12288
    v_mul_f32 v88, s80, v48
    v_mul_f32 v89, s80, v49
    v_mul_f32 v90, s80, v50
    v_mul_f32 v91, s80, v51
    v_mul_f32 v92, s80, v52
    v_mul_f32 v93, s80, v53
    v_mul_f32 v94, s80, v54
    v_mul_f32 v95, s80, v55
    v_exp_f32_e64 v88, v88 clamp
    v_exp_f32_e64 v89, v89 clamp
    v_exp_f32_e64 v90, v90 clamp
    v_exp_f32_e64 v91, v91 clamp
    v_exp_f32_e64 v92, v92 clamp
    v_exp_f32_e64 v93, v93 clamp
    v_exp_f32_e64 v94, v94 clamp
    v_exp_f32_e64 v95, v95 clamp
    v_max_f32 v48, s81, v48
    v_max_f32 v49, s81, v49
    v_max_f32 v50, s81, v50
    v_max_f32 v51, s81, v51
    v_max_f32 v52, s81, v52
    v_max_f32 v53, s81, v53
    v_max_f32 v54, s81, v54
    v_max_f32 v55, s81, v55
    v_add_f32 v48, v48, v88
    v_add_f32 v49, v49, v89
    v_add_f32 v50, v50, v90
    v_add_f32 v51, v51, v91
    v_add_f32 v52, v52, v92
    v_add_f32 v53, v53, v93
    v_add_f32 v54, v54, v94
    v_add_f32 v55, v55, v95
    v_cvt_pk_bf16_f32 v100, v48, v49
    v_cvt_pk_bf16_f32 v101, v50, v51
    v_cvt_pk_bf16_f32 v102, v52, v53
    v_cvt_pk_bf16_f32 v103, v54, v55
    ds_write_b128 v13, v[100:103] offset:16384
    v_mul_f32 v88, s80, v56
    v_mul_f32 v89, s80, v57
    v_mul_f32 v90, s80, v58
    v_mul_f32 v91, s80, v59
    v_mul_f32 v92, s80, v60
    v_mul_f32 v93, s80, v61
    v_mul_f32 v94, s80, v62
    v_mul_f32 v95, s80, v63
    v_exp_f32_e64 v88, v88 clamp
    v_exp_f32_e64 v89, v89 clamp
    v_exp_f32_e64 v90, v90 clamp
    v_exp_f32_e64 v91, v91 clamp
    v_exp_f32_e64 v92, v92 clamp
    v_exp_f32_e64 v93, v93 clamp
    v_exp_f32_e64 v94, v94 clamp
    v_exp_f32_e64 v95, v95 clamp
    v_max_f32 v56, s81, v56
    v_max_f32 v57, s81, v57
    v_max_f32 v58, s81, v58
    v_max_f32 v59, s81, v59
    v_max_f32 v60, s81, v60
    v_max_f32 v61, s81, v61
    v_max_f32 v62, s81, v62
    v_max_f32 v63, s81, v63
    v_add_f32 v56, v56, v88
    v_add_f32 v57, v57, v89
    v_add_f32 v58, v58, v90
    v_add_f32 v59, v59, v91
    v_add_f32 v60, v60, v92
    v_add_f32 v61, v61, v93
    v_add_f32 v62, v62, v94
    v_add_f32 v63, v63, v95
    v_cvt_pk_bf16_f32 v104, v56, v57
    v_cvt_pk_bf16_f32 v105, v58, v59
    v_cvt_pk_bf16_f32 v106, v60, v61
    v_cvt_pk_bf16_f32 v107, v62, v63
    ds_write_b128 v13, v[104:107] offset:20480
    v_mul_f32 v88, s80, v64
    v_mul_f32 v89, s80, v65
    v_mul_f32 v90, s80, v66
    v_mul_f32 v91, s80, v67
    v_mul_f32 v92, s80, v68
    v_mul_f32 v93, s80, v69
    v_mul_f32 v94, s80, v70
    v_mul_f32 v95, s80, v71
    v_exp_f32_e64 v88, v88 clamp
    v_exp_f32_e64 v89, v89 clamp
    v_exp_f32_e64 v90, v90 clamp
    v_exp_f32_e64 v91, v91 clamp
    v_exp_f32_e64 v92, v92 clamp
    v_exp_f32_e64 v93, v93 clamp
    v_exp_f32_e64 v94, v94 clamp
    v_exp_f32_e64 v95, v95 clamp
    v_max_f32 v64, s81, v64
    v_max_f32 v65, s81, v65
    v_max_f32 v66, s81, v66
    v_max_f32 v67, s81, v67
    v_max_f32 v68, s81, v68
    v_max_f32 v69, s81, v69
    v_max_f32 v70, s81, v70
    v_max_f32 v71, s81, v71
    v_add_f32 v64, v64, v88
    v_add_f32 v65, v65, v89
    v_add_f32 v66, v66, v90
    v_add_f32 v67, v67, v91
    v_add_f32 v68, v68, v92
    v_add_f32 v69, v69, v93
    v_add_f32 v70, v70, v94
    v_add_f32 v71, v71, v95
    v_cvt_pk_bf16_f32 v96, v64, v65
    v_cvt_pk_bf16_f32 v97, v66, v67
    v_cvt_pk_bf16_f32 v98, v68, v69
    v_cvt_pk_bf16_f32 v99, v70, v71
    ds_write_b128 v13, v[96:99] offset:24576
    v_mul_f32 v88, s80, v72
    v_mul_f32 v89, s80, v73
    v_mul_f32 v90, s80, v74
    v_mul_f32 v91, s80, v75
    v_mul_f32 v92, s80, v76
    v_mul_f32 v93, s80, v77
    v_mul_f32 v94, s80, v78
    v_mul_f32 v95, s80, v79
    v_exp_f32_e64 v88, v88 clamp
    v_exp_f32_e64 v89, v89 clamp
    v_exp_f32_e64 v90, v90 clamp
    v_exp_f32_e64 v91, v91 clamp
    v_exp_f32_e64 v92, v92 clamp
    v_exp_f32_e64 v93, v93 clamp
    v_exp_f32_e64 v94, v94 clamp
    v_exp_f32_e64 v95, v95 clamp
    v_max_f32 v72, s81, v72
    v_max_f32 v73, s81, v73
    v_max_f32 v74, s81, v74
    v_max_f32 v75, s81, v75
    v_max_f32 v76, s81, v76
    v_max_f32 v77, s81, v77
    v_max_f32 v78, s81, v78
    v_max_f32 v79, s81, v79
    v_add_f32 v72, v72, v88
    v_add_f32 v73, v73, v89
    v_add_f32 v74, v74, v90
    v_add_f32 v75, v75, v91
    v_add_f32 v76, v76, v92
    v_add_f32 v77, v77, v93
    v_add_f32 v78, v78, v94
    v_add_f32 v79, v79, v95
    v_cvt_pk_bf16_f32 v100, v72, v73
    v_cvt_pk_bf16_f32 v101, v74, v75
    v_cvt_pk_bf16_f32 v102, v76, v77
    v_cvt_pk_bf16_f32 v103, v78, v79
    ds_write_b128 v13, v[100:103] offset:28672
    v_mul_f32 v88, s80, v80
    v_mul_f32 v89, s80, v81
    v_mul_f32 v90, s80, v82
    v_mul_f32 v91, s80, v83
    v_mul_f32 v92, s80, v84
    v_mul_f32 v93, s80, v85
    v_mul_f32 v94, s80, v86
    v_mul_f32 v95, s80, v87
    v_exp_f32_e64 v88, v88 clamp
    v_exp_f32_e64 v89, v89 clamp
    v_exp_f32_e64 v90, v90 clamp
    v_exp_f32_e64 v91, v91 clamp
    v_exp_f32_e64 v92, v92 clamp
    v_exp_f32_e64 v93, v93 clamp
    v_exp_f32_e64 v94, v94 clamp
    v_exp_f32_e64 v95, v95 clamp
    v_max_f32 v80, s81, v80
    v_max_f32 v81, s81, v81
    v_max_f32 v82, s81, v82
    v_max_f32 v83, s81, v83
    v_max_f32 v84, s81, v84
    v_max_f32 v85, s81, v85
    v_max_f32 v86, s81, v86
    v_max_f32 v87, s81, v87
    v_add_f32 v80, v80, v88
    v_add_f32 v81, v81, v89
    v_add_f32 v82, v82, v90
    v_add_f32 v83, v83, v91
    v_add_f32 v84, v84, v92
    v_add_f32 v85, v85, v93
    v_add_f32 v86, v86, v94
    v_add_f32 v87, v87, v95
    v_cvt_pk_bf16_f32 v104, v80, v81
    v_cvt_pk_bf16_f32 v105, v82, v83
    v_cvt_pk_bf16_f32 v106, v84, v85
    v_cvt_pk_bf16_f32 v107, v86, v87
    ds_write_b128 v13, v[104:107] offset:32768
    s_branch L_s2_done
L_s2_v:
    v_lshrrev_b32 v15, 4, v1
    v_lshlrev_b32 v15, 4, v15
    v_add_u32 v15, 158208, v15
    v_cvt_pk_bf16_f32 v96, v16, v17
    v_cvt_pk_bf16_f32 v97, v18, v19
    v_cvt_pk_bf16_f32 v98, v20, v21
    v_cvt_pk_bf16_f32 v99, v22, v23
    ds_write_b128 v13, v[96:99] offset:0
    ds_read_b128 v[16:19], v15 offset:0
    ds_read_b128 v[20:23], v15 offset:64
    v_cvt_pk_bf16_f32 v100, v24, v25
    v_cvt_pk_bf16_f32 v101, v26, v27
    v_cvt_pk_bf16_f32 v102, v28, v29
    v_cvt_pk_bf16_f32 v103, v30, v31
    ds_write_b128 v13, v[100:103] offset:4096
    ds_read_b128 v[24:27], v15 offset:128
    ds_read_b128 v[28:31], v15 offset:192
    v_cvt_pk_bf16_f32 v104, v32, v33
    v_cvt_pk_bf16_f32 v105, v34, v35
    v_cvt_pk_bf16_f32 v106, v36, v37
    v_cvt_pk_bf16_f32 v107, v38, v39
    ds_write_b128 v13, v[104:107] offset:8192
    ds_read_b128 v[32:35], v15 offset:256
    ds_read_b128 v[36:39], v15 offset:320
    s_waitcnt lgkmcnt(6)
    v_mfma_f32_16x16x32_bf16 v[88:91], v[16:19], a[0:3], 0
    v_mfma_f32_16x16x32_bf16 v[92:95], v[16:19], a[4:7], 0
    v_mfma_f32_16x16x32_bf16 v[88:91], v[20:23], a[8:11], v[88:91]
    v_mfma_f32_16x16x32_bf16 v[92:95], v[20:23], a[12:15], v[92:95]
    v_cvt_pk_bf16_f32 v96, v40, v41
    v_cvt_pk_bf16_f32 v97, v42, v43
    v_cvt_pk_bf16_f32 v98, v44, v45
    v_cvt_pk_bf16_f32 v99, v46, v47
    ds_write_b128 v13, v[96:99] offset:12288
    ds_read_b128 v[40:43], v15 offset:384
    ds_read_b128 v[44:47], v15 offset:448
    s_waitcnt lgkmcnt(6)
    v_mfma_f32_16x16x32_bf16 v[88:91], v[24:27], a[16:19], v[88:91]
    v_mfma_f32_16x16x32_bf16 v[92:95], v[24:27], a[20:23], v[92:95]
    v_mfma_f32_16x16x32_bf16 v[88:91], v[28:31], a[24:27], v[88:91]
    v_mfma_f32_16x16x32_bf16 v[92:95], v[28:31], a[28:31], v[92:95]
    v_cvt_pk_bf16_f32 v100, v48, v49
    v_cvt_pk_bf16_f32 v101, v50, v51
    v_cvt_pk_bf16_f32 v102, v52, v53
    v_cvt_pk_bf16_f32 v103, v54, v55
    ds_write_b128 v13, v[100:103] offset:16384
    ds_read_b128 v[48:51], v15 offset:512
    ds_read_b128 v[52:55], v15 offset:576
    s_waitcnt lgkmcnt(6)
    v_mfma_f32_16x16x32_bf16 v[88:91], v[32:35], a[32:35], v[88:91]
    v_mfma_f32_16x16x32_bf16 v[92:95], v[32:35], a[36:39], v[92:95]
    v_mfma_f32_16x16x32_bf16 v[88:91], v[36:39], a[40:43], v[88:91]
    v_mfma_f32_16x16x32_bf16 v[92:95], v[36:39], a[44:47], v[92:95]
    v_cvt_pk_bf16_f32 v104, v56, v57
    v_cvt_pk_bf16_f32 v105, v58, v59
    v_cvt_pk_bf16_f32 v106, v60, v61
    v_cvt_pk_bf16_f32 v107, v62, v63
    ds_write_b128 v13, v[104:107] offset:20480
    ds_read_b128 v[56:59], v15 offset:640
    ds_read_b128 v[60:63], v15 offset:704
    s_waitcnt lgkmcnt(6)
    v_mfma_f32_16x16x32_bf16 v[88:91], v[40:43], a[48:51], v[88:91]
    v_mfma_f32_16x16x32_bf16 v[92:95], v[40:43], a[52:55], v[92:95]
    v_mfma_f32_16x16x32_bf16 v[88:91], v[44:47], a[56:59], v[88:91]
    v_mfma_f32_16x16x32_bf16 v[92:95], v[44:47], a[60:63], v[92:95]
    v_cvt_pk_bf16_f32 v96, v64, v65
    v_cvt_pk_bf16_f32 v97, v66, v67
    v_cvt_pk_bf16_f32 v98, v68, v69
    v_cvt_pk_bf16_f32 v99, v70, v71
    ds_write_b128 v13, v[96:99] offset:24576
    ds_read_b128 v[64:67], v15 offset:768
    ds_read_b128 v[68:71], v15 offset:832
    s_waitcnt lgkmcnt(6)
    v_mfma_f32_16x16x32_bf16 v[88:91], v[48:51], a[64:67], v[88:91]
    v_mfma_f32_16x16x32_bf16 v[92:95], v[48:51], a[68:71], v[92:95]
    v_mfma_f32_16x16x32_bf16 v[88:91], v[52:55], a[72:75], v[88:91]
    v_mfma_f32_16x16x32_bf16 v[92:95], v[52:55], a[76:79], v[92:95]
    v_cvt_pk_bf16_f32 v100, v72, v73
    v_cvt_pk_bf16_f32 v101, v74, v75
    v_cvt_pk_bf16_f32 v102, v76, v77
    v_cvt_pk_bf16_f32 v103, v78, v79
    ds_write_b128 v13, v[100:103] offset:28672
    ds_read_b128 v[72:75], v15 offset:896
    ds_read_b128 v[76:79], v15 offset:960
    s_waitcnt lgkmcnt(6)
    v_mfma_f32_16x16x32_bf16 v[88:91], v[56:59], a[80:83], v[88:91]
    v_mfma_f32_16x16x32_bf16 v[92:95], v[56:59], a[84:87], v[92:95]
    v_mfma_f32_16x16x32_bf16 v[88:91], v[60:63], a[88:91], v[88:91]
    v_mfma_f32_16x16x32_bf16 v[92:95], v[60:63], a[92:95], v[92:95]
    v_cvt_pk_bf16_f32 v104, v80, v81
    v_cvt_pk_bf16_f32 v105, v82, v83
    v_cvt_pk_bf16_f32 v106, v84, v85
    v_cvt_pk_bf16_f32 v107, v86, v87
    ds_write_b128 v13, v[104:107] offset:32768
    ds_read_b128 v[80:83], v15 offset:1024
    ds_read_b128 v[84:87], v15 offset:1088
    s_waitcnt lgkmcnt(6)
    v_mfma_f32_16x16x32_bf16 v[88:91], v[64:67], a[96:99], v[88:91]
    v_mfma_f32_16x16x32_bf16 v[92:95], v[64:67], a[100:103], v[92:95]
    v_mfma_f32_16x16x32_bf16 v[88:91], v[68:71], a[104:107], v[88:91]
    v_mfma_f32_16x16x32_bf16 v[92:95], v[68:71], a[108:111], v[92:95]
    s_lshl_b32 s84, s6, 7
    s_add_u32 s84, s84, 160256
    v_and_b32 v15, 15, v1
    v_lshl_add_u32 v15, v15, 2, s84
    s_waitcnt lgkmcnt(0)
    v_mfma_f32_16x16x32_bf16 v[88:91], v[72:75], a[112:115], v[88:91]
    v_mfma_f32_16x16x32_bf16 v[92:95], v[72:75], a[116:119], v[92:95]
    v_mfma_f32_16x16x32_bf16 v[88:91], v[76:79], a[120:123], v[88:91]
    v_mfma_f32_16x16x32_bf16 v[92:95], v[76:79], a[124:127], v[92:95]
    v_mfma_f32_16x16x32_bf16 v[88:91], v[80:83], a[128:131], v[88:91]
    v_mfma_f32_16x16x32_bf16 v[92:95], v[80:83], a[132:135], v[92:95]
    v_mfma_f32_16x16x32_bf16 v[88:91], v[84:87], a[136:139], v[88:91]
    v_mfma_f32_16x16x32_bf16 v[92:95], v[84:87], a[140:143], v[92:95]
    s_nop 6
    ds_write_b32 v15, v88 offset:0
    ds_write_b32 v15, v92 offset:64
    s_waitcnt lgkmcnt(0)
L_s2_done:
    s_waitcnt lgkmcnt(0)
    s_barrier
    ds_read_b128 v[16:19], v14 offset:0
    ds_read_b128 v[20:23], v14 offset:4096
    ds_read_b128 v[24:27], v14 offset:36864
    ds_read_b128 v[28:31], v14 offset:40960
    ds_read_b128 v[32:35], v14 offset:1024
    ds_read_b128 v[36:39], v14 offset:5120
    ds_read_b128 v[40:43], v14 offset:37888
    ds_read_b128 v[44:47], v14 offset:41984
    ds_read_b128 v[48:51], v14 offset:2048
    ds_read_b128 v[52:55], v14 offset:6144
    ds_read_b128 v[84:87], v14 offset:38912
    ds_read_b128 v[88:91], v14 offset:43008
    ds_read_b128 v[92:95], v14 offset:3072
    ds_read_b128 v[96:99], v14 offset:7168
    ds_read_b128 v[100:103], v14 offset:39936
    ds_read_b128 v[104:107], v14 offset:44032
    v_mov_b32 v80, 0x3f803f80
    v_mov_b32 v81, 0x3f803f80
    v_mov_b32 v82, 0x3f803f80
    v_mov_b32 v83, 0x3f803f80
    v_lshlrev_b32 v13, 4, v1
    v_and_b32 v15, 15, v1
    v_cmp_eq_u32 vcc, s30, v15
    s_mul_i32 s84, s7, 20352
    v_subrev_u32 v7, s84, v7
    v_subrev_u32 v8, s84, v8
    v_subrev_u32 v9, s84, v9
    v_subrev_u32 v10, s84, v10
    v_subrev_u32 v11, s84, v11
    v_subrev_u32 v12, s84, v12
    s_waitcnt lgkmcnt(12)
    v_mfma_f32_16x16x32_bf16 v[72:75], v[16:19], v[80:83], 0
    v_mfma_f32_16x16x32_bf16 v[76:79], v[20:23], v[80:83], 0
    v_mfma_f32_16x16x32_bf16 v[56:59], v[16:19], v[24:27], 0
    v_mfma_f32_16x16x32_bf16 v[60:63], v[20:23], v[24:27], 0
    v_mfma_f32_16x16x32_bf16 v[64:67], v[16:19], v[28:31], 0
    v_mfma_f32_16x16x32_bf16 v[68:71], v[20:23], v[28:31], 0
    s_waitcnt lgkmcnt(8)
    v_mfma_f32_16x16x32_bf16 v[72:75], v[32:35], v[80:83], v[72:75]
    v_mfma_f32_16x16x32_bf16 v[76:79], v[36:39], v[80:83], v[76:79]
    v_mfma_f32_16x16x32_bf16 v[56:59], v[32:35], v[40:43], v[56:59]
    v_mfma_f32_16x16x32_bf16 v[60:63], v[36:39], v[40:43], v[60:63]
    v_mfma_f32_16x16x32_bf16 v[64:67], v[32:35], v[44:47], v[64:67]
    v_mfma_f32_16x16x32_bf16 v[68:71], v[36:39], v[44:47], v[68:71]
    s_waitcnt lgkmcnt(4)
    v_mfma_f32_16x16x32_bf16 v[72:75], v[48:51], v[80:83], v[72:75]
    v_mfma_f32_16x16x32_bf16 v[76:79], v[52:55], v[80:83], v[76:79]
    v_mfma_f32_16x16x32_bf16 v[56:59], v[48:51], v[84:87], v[56:59]
    v_mfma_f32_16x16x32_bf16 v[60:63], v[52:55], v[84:87], v[60:63]
    v_mfma_f32_16x16x32_bf16 v[64:67], v[48:51], v[88:91], v[64:67]
    v_mfma_f32_16x16x32_bf16 v[68:71], v[52:55], v[88:91], v[68:71]
    s_waitcnt lgkmcnt(0)
    v_mfma_f32_16x16x32_bf16 v[72:75], v[92:95], v[80:83], v[72:75]
    v_mfma_f32_16x16x32_bf16 v[76:79], v[96:99], v[80:83], v[76:79]
    v_mfma_f32_16x16x32_bf16 v[56:59], v[92:95], v[100:103], v[56:59]
    v_mfma_f32_16x16x32_bf16 v[60:63], v[96:99], v[100:103], v[60:63]
    v_mfma_f32_16x16x32_bf16 v[64:67], v[92:95], v[104:107], v[64:67]
    v_mfma_f32_16x16x32_bf16 v[68:71], v[96:99], v[104:107], v[68:71]
    s_waitcnt vmcnt(5)
    s_barrier
    ds_read_b64_tr_b16 v[96:97], v7 offset:2048
    ds_read_b64_tr_b16 v[98:99], v7 offset:3328
    s_waitcnt lgkmcnt(0)
    v_mfma_f32_16x16x32_bf16 v[16:19], v[96:99], a[0:3], 0
    ds_read_b64_tr_b16 v[100:101], v8 offset:2080
    ds_read_b64_tr_b16 v[102:103], v8 offset:3360
    s_mul_i32 s71, s7, 221184
    s_add_u32 s71, s71, 884736
    s_add_u32 m0, s31, 83968
    v_mfma_f32_16x16x32_bf16 v[20:23], v[96:99], a[4:7], 0
    ds_read_b64_tr_b16 v[104:105], v7 offset:2112
    ds_read_b64_tr_b16 v[106:107], v7 offset:3392
    buffer_load_dwordx4 v2, s[12:15], s71 offen lds
    s_waitcnt lgkmcnt(2)
    v_mfma_f32_16x16x32_bf16 v[24:27], v[100:103], a[0:3], 0
    ds_read_b64_tr_b16 v[88:89], v8 offset:2144
    ds_read_b64_tr_b16 v[90:91], v8 offset:3424
    s_mov_b64 exec, vcc
    buffer_store_dwordx4 v[72:75], v13, s[20:23], s34 offen offset:0 sc1
    buffer_store_dwordx4 v[76:79], v13, s[20:23], s34 offen offset:1024 sc1
    s_mov_b64 exec, -1
    s_or_b64 vcc, s[40:41], s[42:43]
    v_cndmask_b32 v110, 2.0, v13, vcc
    s_add_u32 m0, s31, 84992
    v_mfma_f32_16x16x32_bf16 v[28:31], v[100:103], a[4:7], 0
    ds_read_b64_tr_b16 v[92:93], v7 offset:2176
    buffer_load_dwordx4 v3, s[12:15], s71 offen lds
    v_cvt_pk_bf16_f32 v80, v56, v57
    s_waitcnt lgkmcnt(3)
    v_mfma_f32_16x16x32_bf16 v[32:35], v[104:107], a[0:3], 0
    ds_read_b64_tr_b16 v[94:95], v7 offset:3456
    ds_read_b64_tr_b16 v[96:97], v7 offset:12288
    v_cvt_pk_bf16_f32 v81, v58, v59
    v_cvt_pk_bf16_f32 v82, v64, v65
    s_add_u32 m0, s31, 86016
    v_mfma_f32_16x16x32_bf16 v[36:39], v[104:107], a[4:7], 0
    ds_read_b64_tr_b16 v[98:99], v7 offset:13568
    buffer_load_dwordx4 v4, s[12:15], s71 offen lds
    v_cvt_pk_bf16_f32 v83, v66, v67
    s_waitcnt lgkmcnt(4)
    v_mfma_f32_16x16x32_bf16 v[40:43], v[88:91], a[0:3], 0
    ds_read_b64_tr_b16 v[100:101], v8 offset:12320
    ds_read_b64_tr_b16 v[102:103], v8 offset:13600
    buffer_store_dwordx4 v[80:83], v110, s[20:23], s32 offen offset:0 sc1
    s_or_b64 vcc, s[44:45], s[46:47]
    v_cndmask_b32 v111, 2.0, v13, vcc
    s_add_u32 m0, s31, 87040
    v_mfma_f32_16x16x32_bf16 v[44:47], v[88:91], a[4:7], 0
    ds_read_b64_tr_b16 v[104:105], v7 offset:12352
    buffer_load_dwordx4 v5, s[12:15], s71 offen lds
    v_cvt_pk_bf16_f32 v84, v60, v61
    v_cvt_pk_bf16_f32 v85, v62, v63
    s_waitcnt lgkmcnt(5)
    v_mfma_f32_16x16x32_bf16 v[48:51], v[92:95], a[0:3], 0
    ds_read_b64_tr_b16 v[106:107], v7 offset:13632
    ds_read_b64_tr_b16 v[88:89], v8 offset:12384
    v_cvt_pk_bf16_f32 v86, v68, v69
    v_cvt_pk_bf16_f32 v87, v70, v71
    s_add_u32 m0, s31, 88064
    v_mfma_f32_16x16x32_bf16 v[52:55], v[92:95], a[4:7], 0
    ds_read_b64_tr_b16 v[90:91], v8 offset:13664
    buffer_load_dwordx4 v6, s[12:15], s71 offen lds
    buffer_store_dwordx4 v[84:87], v111, s[20:23], s32 offen offset:1024 sc1
    s_waitcnt lgkmcnt(6)
    v_mfma_f32_16x16x32_bf16 v[16:19], v[96:99], a[8:11], v[16:19]
    ds_read_b64_tr_b16 v[92:93], v7 offset:12416
    v_mfma_f32_16x16x32_bf16 v[20:23], v[96:99], a[12:15], v[20:23]
    ds_read_b64_tr_b16 v[94:95], v7 offset:13696
    s_waitcnt lgkmcnt(6)
    v_mfma_f32_16x16x32_bf16 v[24:27], v[100:103], a[8:11], v[24:27]
    ds_read_b64_tr_b16 v[96:97], v7 offset:22528
    v_mfma_f32_16x16x32_bf16 v[28:31], v[100:103], a[12:15], v[28:31]
    ds_read_b64_tr_b16 v[98:99], v7 offset:23808
    s_waitcnt lgkmcnt(6)
    v_mfma_f32_16x16x32_bf16 v[32:35], v[104:107], a[8:11], v[32:35]
    ds_read_b64_tr_b16 v[100:101], v8 offset:22560
    v_mfma_f32_16x16x32_bf16 v[36:39], v[104:107], a[12:15], v[36:39]
    ds_read_b64_tr_b16 v[102:103], v8 offset:23840
    s_waitcnt lgkmcnt(6)
    v_mfma_f32_16x16x32_bf16 v[40:43], v[88:91], a[8:11], v[40:43]
    ds_read_b64_tr_b16 v[104:105], v7 offset:22592
    v_mfma_f32_16x16x32_bf16 v[44:47], v[88:91], a[12:15], v[44:47]
    ds_read_b64_tr_b16 v[106:107], v7 offset:23872
    s_waitcnt lgkmcnt(6)
    v_mfma_f32_16x16x32_bf16 v[48:51], v[92:95], a[8:11], v[48:51]
    ds_read_b64_tr_b16 v[88:89], v8 offset:22624
    v_mfma_f32_16x16x32_bf16 v[52:55], v[92:95], a[12:15], v[52:55]
    ds_read_b64_tr_b16 v[90:91], v8 offset:23904
    s_waitcnt lgkmcnt(6)
    v_mfma_f32_16x16x32_bf16 v[16:19], v[96:99], a[16:19], v[16:19]
    ds_read_b64_tr_b16 v[92:93], v7 offset:22656
    v_mfma_f32_16x16x32_bf16 v[20:23], v[96:99], a[20:23], v[20:23]
    ds_read_b64_tr_b16 v[94:95], v7 offset:23936
    s_waitcnt lgkmcnt(6)
    v_mfma_f32_16x16x32_bf16 v[24:27], v[100:103], a[16:19], v[24:27]
    ds_read_b64_tr_b16 v[96:97], v7 offset:32768
    v_mfma_f32_16x16x32_bf16 v[28:31], v[100:103], a[20:23], v[28:31]
    ds_read_b64_tr_b16 v[98:99], v7 offset:34048
    s_waitcnt lgkmcnt(6)
    v_mfma_f32_16x16x32_bf16 v[32:35], v[104:107], a[16:19], v[32:35]
    ds_read_b64_tr_b16 v[100:101], v8 offset:32800
    v_mfma_f32_16x16x32_bf16 v[36:39], v[104:107], a[20:23], v[36:39]
    ds_read_b64_tr_b16 v[102:103], v8 offset:34080
    s_waitcnt lgkmcnt(6)
    v_mfma_f32_16x16x32_bf16 v[40:43], v[88:91], a[16:19], v[40:43]
    ds_read_b64_tr_b16 v[104:105], v7 offset:32832
    v_mfma_f32_16x16x32_bf16 v[44:47], v[88:91], a[20:23], v[44:47]
    ds_read_b64_tr_b16 v[106:107], v7 offset:34112
    s_waitcnt lgkmcnt(6)
    v_mfma_f32_16x16x32_bf16 v[48:51], v[92:95], a[16:19], v[48:51]
    ds_read_b64_tr_b16 v[88:89], v8 offset:32864
    v_mfma_f32_16x16x32_bf16 v[52:55], v[92:95], a[20:23], v[52:55]
    ds_read_b64_tr_b16 v[90:91], v8 offset:34144
    s_waitcnt lgkmcnt(6)
    v_mfma_f32_16x16x32_bf16 v[16:19], v[96:99], a[24:27], v[16:19]
    ds_read_b64_tr_b16 v[92:93], v7 offset:32896
    v_mfma_f32_16x16x32_bf16 v[20:23], v[96:99], a[28:31], v[20:23]
    ds_read_b64_tr_b16 v[94:95], v7 offset:34176
    s_waitcnt lgkmcnt(6)
    v_mfma_f32_16x16x32_bf16 v[24:27], v[100:103], a[24:27], v[24:27]
    v_mfma_f32_16x16x32_bf16 v[28:31], v[100:103], a[28:31], v[28:31]
    s_waitcnt vmcnt(9) lgkmcnt(0)
    s_barrier
    v_mfma_f32_16x16x32_bf16 v[32:35], v[104:107], a[24:27], v[32:35]
    ds_read_b64_tr_b16 v[96:97], v7 offset:43008
    ds_read_b64_tr_b16 v[98:99], v7 offset:44288
    s_mul_i32 s71, s7, 221184
    s_add_u32 s71, s71, 1327104
    s_add_u32 m0, s31, 2048
    v_mfma_f32_16x16x32_bf16 v[36:39], v[104:107], a[28:31], v[36:39]
    ds_read_b64_tr_b16 v[100:101], v8 offset:43040
    buffer_load_dwordx4 v2, s[12:15], s71 offen lds
    v_mfma_f32_16x16x32_bf16 v[40:43], v[88:91], a[24:27], v[40:43]
    ds_read_b64_tr_b16 v[102:103], v8 offset:44320
    ds_read_b64_tr_b16 v[104:105], v7 offset:43072
    s_mul_i32 s84, s28, 3072
    v_mfma_f32_16x16x32_bf16 v[44:47], v[88:91], a[28:31], v[44:47]
    ds_read_b64_tr_b16 v[106:107], v7 offset:44352
    v_mfma_f32_16x16x32_bf16 v[48:51], v[92:95], a[24:27], v[48:51]
    ds_read_b64_tr_b16 v[88:89], v8 offset:43104
    s_add_u32 s84, s84, 124928
    s_add_u32 m0, s31, 3072
    v_mfma_f32_16x16x32_bf16 v[52:55], v[92:95], a[28:31], v[52:55]
    ds_read_b64_tr_b16 v[90:91], v8 offset:44384
    buffer_load_dwordx4 v3, s[12:15], s71 offen lds
    v_add_u32 v83, s84, v13
    s_waitcnt lgkmcnt(6)
    v_mfma_f32_16x16x32_bf16 v[16:19], v[96:99], a[32:35], v[16:19]
    ds_read_b64_tr_b16 v[92:93], v7 offset:43136
    v_mov_b32 v14, 1
    s_waitcnt vmcnt(2)
    v_mfma_f32_16x16x32_bf16 v[20:23], v[96:99], a[36:39], v[20:23]
    ds_read_b64_tr_b16 v[94:95], v7 offset:44416
    s_mov_b64 exec, 1
    buffer_store_dword v14, off, s[20:23], s66 sc1
    s_mov_b64 exec, -1
    s_mul_i32 s84, s7, 12288
    s_waitcnt lgkmcnt(6)
    v_mfma_f32_16x16x32_bf16 v[24:27], v[100:103], a[32:35], v[24:27]
    ds_read_b64_tr_b16 v[96:97], v7 offset:53248
    s_add_u32 s84, s84, 124928
    s_add_u32 m0, s31, 4096
    v_mfma_f32_16x16x32_bf16 v[28:31], v[100:103], a[36:39], v[28:31]
    ds_read_b64_tr_b16 v[98:99], v7 offset:54528
    buffer_load_dwordx4 v4, s[12:15], s71 offen lds
    s_waitcnt lgkmcnt(6)
    v_mfma_f32_16x16x32_bf16 v[32:35], v[104:107], a[32:35], v[32:35]
    ds_read_b64_tr_b16 v[100:101], v8 offset:53280
    v_add_u32 v84, s84, v13
    v_mfma_f32_16x16x32_bf16 v[36:39], v[104:107], a[36:39], v[36:39]
    ds_read_b64_tr_b16 v[102:103], v8 offset:54560
    s_waitcnt lgkmcnt(6)
    v_mfma_f32_16x16x32_bf16 v[40:43], v[88:91], a[32:35], v[40:43]
    ds_read_b64_tr_b16 v[104:105], v7 offset:53312
    s_lshl_b32 s69, s30, 2
    s_add_u32 m0, s31, 5120
    v_mfma_f32_16x16x32_bf16 v[44:47], v[88:91], a[36:39], v[44:47]
    ds_read_b64_tr_b16 v[106:107], v7 offset:54592
    buffer_load_dwordx4 v5, s[12:15], s71 offen lds
    s_add_u32 s69, s69, s3
    s_waitcnt lgkmcnt(6)
    v_mfma_f32_16x16x32_bf16 v[48:51], v[92:95], a[32:35], v[48:51]
    ds_read_b64_tr_b16 v[88:89], v8 offset:53344
    s_mul_i32 s69, s69, 344064
    v_mfma_f32_16x16x32_bf16 v[52:55], v[92:95], a[36:39], v[52:55]
    ds_read_b64_tr_b16 v[90:91], v8 offset:54624
    s_waitcnt lgkmcnt(6)
    v_mfma_f32_16x16x32_bf16 v[16:19], v[96:99], a[40:43], v[16:19]
    ds_read_b64_tr_b16 v[92:93], v7 offset:53376
    s_add_u32 s69, s69, 83886080
    s_add_u32 m0, s31, 6144
    v_mfma_f32_16x16x32_bf16 v[20:23], v[96:99], a[44:47], v[20:23]
    ds_read_b64_tr_b16 v[94:95], v7 offset:54656
    buffer_load_dwordx4 v6, s[12:15], s71 offen lds
    s_waitcnt lgkmcnt(6)
    v_mfma_f32_16x16x32_bf16 v[24:27], v[100:103], a[40:43], v[24:27]
    ds_read_b64_tr_b16 v[96:97], v7 offset:63488
    v_and_b32 v86, 1, v1
    v_mfma_f32_16x16x32_bf16 v[28:31], v[100:103], a[44:47], v[28:31]
    ds_read_b64_tr_b16 v[98:99], v7 offset:64768
    s_waitcnt lgkmcnt(6)
    v_mfma_f32_16x16x32_bf16 v[32:35], v[104:107], a[40:43], v[32:35]
    ds_read_b64_tr_b16 v[100:101], v8 offset:63520
    v_lshlrev_b32 v86, 4, v86
    v_mfma_f32_16x16x32_bf16 v[36:39], v[104:107], a[44:47], v[36:39]
    ds_read_b64_tr_b16 v[102:103], v8 offset:64800
    v_mov_b32 v87, 0x3f80
    s_waitcnt lgkmcnt(6)
    v_mfma_f32_16x16x32_bf16 v[40:43], v[88:91], a[40:43], v[40:43]
    ds_read_b64_tr_b16 v[104:105], v7 offset:63552
    v_lshlrev_b32 v87, v86, v87
    v_mfma_f32_16x16x32_bf16 v[44:47], v[88:91], a[44:47], v[44:47]
    ds_read_b64_tr_b16 v[106:107], v7 offset:64832
    s_waitcnt lgkmcnt(6)
    v_mfma_f32_16x16x32_bf16 v[48:51], v[92:95], a[40:43], v[48:51]
    ds_read_b64_tr_b16 v[88:89], v8 offset:63584
    v_bfe_u32 v86, v1, 1, 2
    v_mfma_f32_16x16x32_bf16 v[52:55], v[92:95], a[44:47], v[52:55]
    ds_read_b64_tr_b16 v[90:91], v8 offset:64864
    s_waitcnt lgkmcnt(6)
    v_mfma_f32_16x16x32_bf16 v[16:19], v[96:99], a[48:51], v[16:19]
    ds_read_b64_tr_b16 v[92:93], v7 offset:63616
    v_lshlrev_b32 v15, 2, v1
    v_mov_b32 v0, 0
    v_mfma_f32_16x16x32_bf16 v[20:23], v[96:99], a[52:55], v[20:23]
    ds_read_b64_tr_b16 v[94:95], v7 offset:64896
    s_mov_b64 exec, 0xffff
    buffer_atomic_add v0, v15, s[20:23], s65 offen sc0 sc1
    s_mov_b64 exec, -1
    v_cmp_eq_u32 vcc, 0, v86
    s_nop 1
    v_cndmask_b32 v72, 0, v87, vcc
    s_waitcnt lgkmcnt(6)
    v_mfma_f32_16x16x32_bf16 v[24:27], v[100:103], a[48:51], v[24:27]
    ds_read_b64_tr_b16 v[96:97], v9 offset:8192
    v_cmp_eq_u32 vcc, 1, v86
    s_nop 1
    v_cndmask_b32 v73, 0, v87, vcc
    v_mfma_f32_16x16x32_bf16 v[28:31], v[100:103], a[52:55], v[28:31]
    ds_read_b64_tr_b16 v[98:99], v9 offset:9472
    v_cmp_eq_u32 vcc, 2, v86
    s_nop 1
    v_cndmask_b32 v74, 0, v87, vcc
    s_waitcnt lgkmcnt(6)
    v_mfma_f32_16x16x32_bf16 v[32:35], v[104:107], a[48:51], v[32:35]
    ds_read_b64_tr_b16 v[100:101], v10 offset:8224
    v_cmp_eq_u32 vcc, 3, v86
    s_nop 1
    v_cndmask_b32 v75, 0, v87, vcc
    v_mfma_f32_16x16x32_bf16 v[36:39], v[104:107], a[52:55], v[36:39]
    ds_read_b64_tr_b16 v[102:103], v10 offset:9504
    s_waitcnt lgkmcnt(6)
    v_mfma_f32_16x16x32_bf16 v[40:43], v[88:91], a[48:51], v[40:43]
    ds_read_b64_tr_b16 v[104:105], v9 offset:8256
    v_and_b32 v87, 7, v1
    v_mfma_f32_16x16x32_bf16 v[44:47], v[88:91], a[52:55], v[44:47]
    ds_read_b64_tr_b16 v[106:107], v9 offset:9536
    s_waitcnt lgkmcnt(6)
    v_mfma_f32_16x16x32_bf16 v[48:51], v[92:95], a[48:51], v[48:51]
    ds_read_b64_tr_b16 v[88:89], v10 offset:8288
    v_lshlrev_b32 v87, 4, v87
    v_mfma_f32_16x16x32_bf16 v[52:55], v[92:95], a[52:55], v[52:55]
    ds_read_b64_tr_b16 v[90:91], v10 offset:9568
    s_waitcnt lgkmcnt(6)
    v_mfma_f32_16x16x32_bf16 v[16:19], v[96:99], a[56:59], v[16:19]
    ds_read_b64_tr_b16 v[92:93], v9 offset:8320
    v_lshrrev_b32 v86, 3, v1
    v_mfma_f32_16x16x32_bf16 v[20:23], v[96:99], a[60:63], v[20:23]
    ds_read_b64_tr_b16 v[94:95], v9 offset:9600
    v_lshl_add_u32 v86, v86, 11, v87
    s_waitcnt lgkmcnt(6)
    v_mfma_f32_16x16x32_bf16 v[24:27], v[100:103], a[56:59], v[24:27]
    v_bfe_u32 v76, v1, 4, 1
    v_mfma_f32_16x16x32_bf16 v[28:31], v[100:103], a[60:63], v[28:31]
    s_waitcnt lgkmcnt(0)
    s_barrier
    v_mfma_f32_16x16x32_bf16 v[32:35], v[104:107], a[56:59], v[32:35]
    ds_read_b64_tr_b16 v[96:97], v9 offset:18432
    ds_read_b64_tr_b16 v[98:99], v9 offset:19712
    v_lshl_add_u32 v87, v76, 3, v87
    s_mul_i32 s71, s7, 1073741824
    s_add_u32 s71, s71, 1769472
    s_add_u32 m0, s31, 43008
    v_mfma_f32_16x16x32_bf16 v[36:39], v[104:107], a[60:63], v[36:39]
    ds_read_b64_tr_b16 v[100:101], v10 offset:18464
    buffer_load_dwordx4 v2, s[12:15], s71 offen lds
    v_mfma_f32_16x16x32_bf16 v[40:43], v[88:91], a[56:59], v[40:43]
    ds_read_b64_tr_b16 v[102:103], v10 offset:19744
    ds_read_b64_tr_b16 v[104:105], v9 offset:18496
    s_lshl_b32 s74, s30, 7
    v_mfma_f32_16x16x32_bf16 v[44:47], v[88:91], a[60:63], v[44:47]
    ds_read_b64_tr_b16 v[106:107], v9 offset:19776
    v_mfma_f32_16x16x32_bf16 v[48:51], v[92:95], a[56:59], v[48:51]
    ds_read_b64_tr_b16 v[88:89], v10 offset:18528
    s_add_u32 s74, s74, s33
    s_add_u32 m0, s31, 44032
    v_mfma_f32_16x16x32_bf16 v[52:55], v[92:95], a[60:63], v[52:55]
    ds_read_b64_tr_b16 v[90:91], v10 offset:19808
    buffer_load_dwordx4 v3, s[12:15], s71 offen lds
    s_lshr_b32 s84, s30, 1
    s_waitcnt lgkmcnt(6)
    v_mfma_f32_16x16x32_bf16 v[16:19], v[96:99], a[64:67], v[16:19]
    ds_read_b64_tr_b16 v[92:93], v9 offset:18560
    s_lshr_b32 s75, s28, 1
    v_mfma_f32_16x16x32_bf16 v[20:23], v[96:99], a[68:71], v[20:23]
    ds_read_b64_tr_b16 v[94:95], v9 offset:19840
    s_waitcnt lgkmcnt(6)
    v_mfma_f32_16x16x32_bf16 v[24:27], v[100:103], a[64:67], v[24:27]
    ds_read_b64_tr_b16 v[96:97], v9 offset:28672
    s_sub_u32 s84, s84, s75
    s_add_u32 m0, s31, 45056
    v_mfma_f32_16x16x32_bf16 v[28:31], v[100:103], a[68:71], v[28:31]
    ds_read_b64_tr_b16 v[98:99], v9 offset:29952
    buffer_load_dwordx4 v4, s[12:15], s71 offen lds
    s_waitcnt lgkmcnt(6)
    v_mfma_f32_16x16x32_bf16 v[32:35], v[104:107], a[64:67], v[32:35]
    ds_read_b64_tr_b16 v[100:101], v10 offset:28704
    s_cmp_le_u32 s84, 4
    s_cselect_b32 s74, s74, 1073741824
    v_mfma_f32_16x16x32_bf16 v[36:39], v[104:107], a[68:71], v[36:39]
    ds_read_b64_tr_b16 v[102:103], v10 offset:29984
    s_waitcnt lgkmcnt(6)
    v_mfma_f32_16x16x32_bf16 v[40:43], v[88:91], a[64:67], v[40:43]
    ds_read_b64_tr_b16 v[104:105], v9 offset:28736
    s_add_u32 s75, s74, 16384
    s_add_u32 m0, s31, 46080
    v_mfma_f32_16x16x32_bf16 v[44:47], v[88:91], a[68:71], v[44:47]
    ds_read_b64_tr_b16 v[106:107], v9 offset:30016
    buffer_load_dwordx4 v5, s[12:15], s71 offen lds
    s_add_u32 s76, s74, 32768
    s_waitcnt lgkmcnt(6)
    v_mfma_f32_16x16x32_bf16 v[48:51], v[92:95], a[64:67], v[48:51]
    ds_read_b64_tr_b16 v[88:89], v10 offset:28768
    s_add_u32 s33, s33, 32768
    v_mfma_f32_16x16x32_bf16 v[52:55], v[92:95], a[68:71], v[52:55]
    ds_read_b64_tr_b16 v[90:91], v10 offset:30048
    s_waitcnt lgkmcnt(6)
    v_mfma_f32_16x16x32_bf16 v[16:19], v[96:99], a[72:75], v[16:19]
    ds_read_b64_tr_b16 v[92:93], v9 offset:28800
    s_add_u32 m0, s31, 47104
    v_mfma_f32_16x16x32_bf16 v[20:23], v[96:99], a[76:79], v[20:23]
    ds_read_b64_tr_b16 v[94:95], v9 offset:30080
    buffer_load_dwordx4 v6, s[12:15], s71 offen lds
    s_waitcnt vmcnt(5)
    s_mov_b32 s5, 0
    s_waitcnt vmcnt(63)
L_kc1_l:
    v_cmp_lt_u32 vcc, 0, v0
    s_nop 1
    s_cmp_eq_u32 vcc_lo, 0xffff
    s_cbranch_scc1 L_kc1_d
    s_add_u32 s5, s5, 1
    s_cmp_ge_u32 s5, 100000
    s_cbranch_scc1 L_kc1_d
    s_sleep 6
    v_mov_b32 v0, 0
    s_mov_b64 exec, 0xffff
    buffer_atomic_add v0, v15, s[20:23], s65 offen sc0 sc1
    s_mov_b64 exec, -1
    s_waitcnt vmcnt(0)
    s_branch L_kc1_l
L_kc1_d:
    s_waitcnt lgkmcnt(6)
    v_mfma_f32_16x16x32_bf16 v[24:27], v[100:103], a[72:75], v[24:27]
    ds_read_b64_tr_b16 v[96:97], v9 offset:38912
    buffer_load_dwordx4 v[56:59], v86, s[20:23], s74 offen sc1
    v_mfma_f32_16x16x32_bf16 v[28:31], v[100:103], a[76:79], v[28:31]
    ds_read_b64_tr_b16 v[98:99], v9 offset:40192
    buffer_load_dwordx4 v[60:63], v86, s[20:23], s75 offen sc1
    s_waitcnt lgkmcnt(6)
    v_mfma_f32_16x16x32_bf16 v[32:35], v[104:107], a[72:75], v[32:35]
    ds_read_b64_tr_b16 v[100:101], v10 offset:38944
    buffer_load_dwordx4 v[64:67], v13, s[20:23], s34 offen offset:0 sc1
    v_mfma_f32_16x16x32_bf16 v[36:39], v[104:107], a[76:79], v[36:39]
    ds_read_b64_tr_b16 v[102:103], v10 offset:40224
    buffer_load_dwordx4 v[68:71], v13, s[20:23], s34 offen offset:1024 sc1
    s_waitcnt lgkmcnt(6)
    v_mfma_f32_16x16x32_bf16 v[40:43], v[88:91], a[72:75], v[40:43]
    ds_read_b64_tr_b16 v[104:105], v9 offset:38976
    v_mfma_f32_16x16x32_bf16 v[44:47], v[88:91], a[76:79], v[44:47]
    ds_read_b64_tr_b16 v[106:107], v9 offset:40256
    s_waitcnt lgkmcnt(6)
    v_mfma_f32_16x16x32_bf16 v[48:51], v[92:95], a[72:75], v[48:51]
    ds_read_b64_tr_b16 v[88:89], v10 offset:39008
    v_mfma_f32_16x16x32_bf16 v[52:55], v[92:95], a[76:79], v[52:55]
    ds_read_b64_tr_b16 v[90:91], v10 offset:40288
    s_waitcnt lgkmcnt(6)
    v_mfma_f32_16x16x32_bf16 v[16:19], v[96:99], a[80:83], v[16:19]
    ds_read_b64_tr_b16 v[92:93], v9 offset:39040
    v_mfma_f32_16x16x32_bf16 v[20:23], v[96:99], a[84:87], v[20:23]
    ds_read_b64_tr_b16 v[94:95], v9 offset:40320
    s_waitcnt lgkmcnt(6)
    v_mfma_f32_16x16x32_bf16 v[24:27], v[100:103], a[80:83], v[24:27]
    ds_read_b64_tr_b16 v[96:97], v9 offset:49152
    v_mfma_f32_16x16x32_bf16 v[28:31], v[100:103], a[84:87], v[28:31]
    ds_read_b64_tr_b16 v[98:99], v9 offset:50432
    s_waitcnt lgkmcnt(6)
    v_mfma_f32_16x16x32_bf16 v[32:35], v[104:107], a[80:83], v[32:35]
    ds_read_b64_tr_b16 v[100:101], v10 offset:49184
    v_mfma_f32_16x16x32_bf16 v[36:39], v[104:107], a[84:87], v[36:39]
    ds_read_b64_tr_b16 v[102:103], v10 offset:50464
    s_waitcnt lgkmcnt(6)
    v_mfma_f32_16x16x32_bf16 v[40:43], v[88:91], a[80:83], v[40:43]
    ds_read_b64_tr_b16 v[104:105], v9 offset:49216
    v_mfma_f32_16x16x32_bf16 v[44:47], v[88:91], a[84:87], v[44:47]
    ds_read_b64_tr_b16 v[106:107], v9 offset:50496
    s_waitcnt lgkmcnt(6)
    v_mfma_f32_16x16x32_bf16 v[48:51], v[92:95], a[80:83], v[48:51]
    ds_read_b64_tr_b16 v[88:89], v10 offset:49248
    v_mfma_f32_16x16x32_bf16 v[52:55], v[92:95], a[84:87], v[52:55]
    ds_read_b64_tr_b16 v[90:91], v10 offset:50528
    s_waitcnt lgkmcnt(6)
    v_mfma_f32_16x16x32_bf16 v[16:19], v[96:99], a[88:91], v[16:19]
    ds_read_b64_tr_b16 v[92:93], v9 offset:49280
    v_mfma_f32_16x16x32_bf16 v[20:23], v[96:99], a[92:95], v[20:23]
    ds_read_b64_tr_b16 v[94:95], v9 offset:50560
    s_waitcnt lgkmcnt(6)
    v_mfma_f32_16x16x32_bf16 v[24:27], v[100:103], a[88:91], v[24:27]
    v_mfma_f32_16x16x32_bf16 v[28:31], v[100:103], a[92:95], v[28:31]
    s_waitcnt lgkmcnt(0)
    s_barrier
    v_mfma_f32_16x16x32_bf16 v[32:35], v[104:107], a[88:91], v[32:35]
    ds_read_b64_tr_b16 v[96:97], v7 offset:2048
    ds_read_b64_tr_b16 v[98:99], v7 offset:3328
    v_mfma_f32_16x16x32_bf16 v[36:39], v[104:107], a[92:95], v[36:39]
    ds_read_b64_tr_b16 v[100:101], v8 offset:2080
    v_mfma_f32_16x16x32_bf16 v[40:43], v[88:91], a[88:91], v[40:43]
    ds_read_b64_tr_b16 v[102:103], v8 offset:3360
    ds_read_b64_tr_b16 v[104:105], v7 offset:2112
    s_waitcnt vmcnt(2)
    v_mfma_f32_16x16x32_bf16 v[76:79], v[72:75], v[56:59], 0
    v_mfma_f32_16x16x32_bf16 v[44:47], v[88:91], a[92:95], v[44:47]
    ds_read_b64_tr_b16 v[106:107], v7 offset:3392
    v_mfma_f32_16x16x32_bf16 v[76:79], v[72:75], v[60:63], v[76:79]
    v_mfma_f32_16x16x32_bf16 v[48:51], v[92:95], a[88:91], v[48:51]
    ds_read_b64_tr_b16 v[88:89], v8 offset:2144
    v_mfma_f32_16x16x32_bf16 v[52:55], v[92:95], a[92:95], v[52:55]
    ds_read_b64_tr_b16 v[90:91], v8 offset:3424
    s_waitcnt lgkmcnt(6)
    v_mfma_f32_16x16x32_bf16 v[16:19], v[96:99], a[96:99], v[16:19]
    ds_read_b64_tr_b16 v[92:93], v7 offset:2176
    s_nop 0
    v_add_f32_dpp v76, v76, v76 row_ror:8 row_mask:0xf bank_mask:0xf
    v_add_f32_dpp v77, v77, v77 row_ror:8 row_mask:0xf bank_mask:0xf
    v_mfma_f32_16x16x32_bf16 v[20:23], v[96:99], a[100:103], v[20:23]
    ds_read_b64_tr_b16 v[94:95], v7 offset:3456
    v_add_f32_dpp v78, v78, v78 row_ror:8 row_mask:0xf bank_mask:0xf
    v_add_f32_dpp v79, v79, v79 row_ror:8 row_mask:0xf bank_mask:0xf
    s_waitcnt lgkmcnt(6)
    v_mfma_f32_16x16x32_bf16 v[24:27], v[100:103], a[96:99], v[24:27]
    ds_read_b64_tr_b16 v[96:97], v7 offset:12288
    v_cvt_pk_bf16_f32 v76, v76, v77
    v_cvt_pk_bf16_f32 v77, v78, v79
    v_mfma_f32_16x16x32_bf16 v[28:31], v[100:103], a[100:103], v[28:31]
    ds_read_b64_tr_b16 v[98:99], v7 offset:13568
    buffer_store_dwordx2 v[76:77], v87, s[20:23], s76 offen sc1
    s_waitcnt lgkmcnt(6)
    v_mfma_f32_16x16x32_bf16 v[32:35], v[104:107], a[96:99], v[32:35]
    ds_read_b64_tr_b16 v[100:101], v8 offset:12320
    s_waitcnt vmcnt(1)
    v_mfma_f32_16x16x32_bf16 v[36:39], v[104:107], a[100:103], v[36:39]
    ds_read_b64_tr_b16 v[102:103], v8 offset:13600
    v_add_f32_dpp v64, v64, v64 row_ror:8 row_mask:0xf bank_mask:0xf
    s_waitcnt lgkmcnt(6)
    v_mfma_f32_16x16x32_bf16 v[40:43], v[88:91], a[96:99], v[40:43]
    ds_read_b64_tr_b16 v[104:105], v7 offset:12352
    v_add_f32_dpp v65, v65, v65 row_ror:8 row_mask:0xf bank_mask:0xf
    v_add_f32_dpp v66, v66, v66 row_ror:8 row_mask:0xf bank_mask:0xf
    v_add_f32_dpp v67, v67, v67 row_ror:8 row_mask:0xf bank_mask:0xf
    v_mfma_f32_16x16x32_bf16 v[44:47], v[88:91], a[100:103], v[44:47]
    ds_read_b64_tr_b16 v[106:107], v7 offset:13632
    s_lshl_b32 s84, s6, 7
    s_add_u32 s84, s84, 160256
    s_waitcnt lgkmcnt(6)
    v_mfma_f32_16x16x32_bf16 v[48:51], v[92:95], a[96:99], v[48:51]
    ds_read_b64_tr_b16 v[88:89], v8 offset:12384
    v_add_f32_dpp v68, v68, v68 row_ror:8 row_mask:0xf bank_mask:0xf
    v_add_f32_dpp v69, v69, v69 row_ror:8 row_mask:0xf bank_mask:0xf
    v_mfma_f32_16x16x32_bf16 v[52:55], v[92:95], a[100:103], v[52:55]
    ds_read_b64_tr_b16 v[90:91], v8 offset:13664
    v_and_b32 v85, 15, v1
    s_waitcnt lgkmcnt(6)
    v_mfma_f32_16x16x32_bf16 v[16:19], v[96:99], a[104:107], v[16:19]
    ds_read_b64_tr_b16 v[92:93], v7 offset:12416
    v_add_f32_dpp v70, v70, v70 row_ror:8 row_mask:0xf bank_mask:0xf
    v_add_f32_dpp v71, v71, v71 row_ror:8 row_mask:0xf bank_mask:0xf
    v_mfma_f32_16x16x32_bf16 v[20:23], v[96:99], a[108:111], v[20:23]
    ds_read_b64_tr_b16 v[94:95], v7 offset:13696
    v_lshl_add_u32 v85, v85, 2, s84
    ds_read_b32 v86, v85 offset:0
    s_waitcnt lgkmcnt(7)
    v_mfma_f32_16x16x32_bf16 v[24:27], v[100:103], a[104:107], v[24:27]
    ds_read_b64_tr_b16 v[96:97], v7 offset:22528
    v_add_f32_dpp v64, v64, v64 row_ror:4 row_mask:0xf bank_mask:0xf
    v_add_f32_dpp v65, v65, v65 row_ror:4 row_mask:0xf bank_mask:0xf
    v_mfma_f32_16x16x32_bf16 v[28:31], v[100:103], a[108:111], v[28:31]
    ds_read_b64_tr_b16 v[98:99], v7 offset:23808
    v_add_f32_dpp v66, v66, v66 row_ror:4 row_mask:0xf bank_mask:0xf
    ds_read_b32 v87, v85 offset:64
    s_waitcnt lgkmcnt(8)
    v_mfma_f32_16x16x32_bf16 v[32:35], v[104:107], a[104:107], v[32:35]
    ds_read_b64_tr_b16 v[100:101], v8 offset:22560
    v_add_f32_dpp v67, v67, v67 row_ror:4 row_mask:0xf bank_mask:0xf
    v_add_f32_dpp v68, v68, v68 row_ror:4 row_mask:0xf bank_mask:0xf
    v_mfma_f32_16x16x32_bf16 v[36:39], v[104:107], a[108:111], v[36:39]
    ds_read_b64_tr_b16 v[102:103], v8 offset:23840
    s_lshl_b32 s84, s6, 12
    s_add_u32 s84, s84, s69
    s_waitcnt lgkmcnt(8)
    v_mfma_f32_16x16x32_bf16 v[40:43], v[88:91], a[104:107], v[40:43]
    ds_read_b64_tr_b16 v[104:105], v7 offset:22592
    v_add_f32_dpp v69, v69, v69 row_ror:4 row_mask:0xf bank_mask:0xf
    v_add_f32_dpp v70, v70, v70 row_ror:4 row_mask:0xf bank_mask:0xf
    v_mfma_f32_16x16x32_bf16 v[44:47], v[88:91], a[108:111], v[44:47]
    ds_read_b64_tr_b16 v[106:107], v7 offset:23872
    s_lshl_b32 s56, s7, 14
    s_waitcnt lgkmcnt(8)
    v_mfma_f32_16x16x32_bf16 v[48:51], v[92:95], a[104:107], v[48:51]
    ds_read_b64_tr_b16 v[88:89], v8 offset:22624
    v_add_f32_dpp v71, v71, v71 row_ror:4 row_mask:0xf bank_mask:0xf
    v_add_f32_dpp v64, v64, v64 row_ror:2 row_mask:0xf bank_mask:0xf
    v_mfma_f32_16x16x32_bf16 v[52:55], v[92:95], a[108:111], v[52:55]
    ds_read_b64_tr_b16 v[90:91], v8 offset:23904
    s_add_u32 s56, s56, 294912
    s_lshl_b32 s57, s7, 10
    s_waitcnt lgkmcnt(7)
    v_mfma_f32_16x16x32_bf16 v[16:19], v[96:99], a[112:115], v[16:19]
    ds_read_b64_tr_b16 v[92:93], v7 offset:22656
    v_add_f32_dpp v65, v65, v65 row_ror:2 row_mask:0xf bank_mask:0xf
    v_add_f32_dpp v66, v66, v66 row_ror:2 row_mask:0xf bank_mask:0xf
    v_mfma_f32_16x16x32_bf16 v[20:23], v[96:99], a[116:119], v[20:23]
    ds_read_b64_tr_b16 v[94:95], v7 offset:23936
    v_add_f32_dpp v67, v67, v67 row_ror:2 row_mask:0xf bank_mask:0xf
    s_add_u32 s57, s57, 327680
    s_waitcnt lgkmcnt(6)
    v_mfma_f32_16x16x32_bf16 v[24:27], v[100:103], a[112:115], v[24:27]
    ds_read_b64_tr_b16 v[96:97], v7 offset:32768
    v_add_f32_dpp v68, v68, v68 row_ror:2 row_mask:0xf bank_mask:0xf
    v_add_f32_dpp v69, v69, v69 row_ror:2 row_mask:0xf bank_mask:0xf
    v_mfma_f32_16x16x32_bf16 v[28:31], v[100:103], a[116:119], v[28:31]
    ds_read_b64_tr_b16 v[98:99], v7 offset:34048
    v_add_u32 v85, s84, v13
    s_waitcnt lgkmcnt(6)
    v_mfma_f32_16x16x32_bf16 v[32:35], v[104:107], a[112:115], v[32:35]
    ds_read_b64_tr_b16 v[100:101], v8 offset:32800
    v_add_f32_dpp v70, v70, v70 row_ror:2 row_mask:0xf bank_mask:0xf
    v_add_f32_dpp v71, v71, v71 row_ror:2 row_mask:0xf bank_mask:0xf
    v_mfma_f32_16x16x32_bf16 v[36:39], v[104:107], a[116:119], v[36:39]
    ds_read_b64_tr_b16 v[102:103], v8 offset:34080
    v_min_f32 v86, 0x41f00000, v86
    s_waitcnt lgkmcnt(6)
    v_mfma_f32_16x16x32_bf16 v[40:43], v[88:91], a[112:115], v[40:43]
    ds_read_b64_tr_b16 v[104:105], v7 offset:32832
    v_add_f32_dpp v64, v64, v64 row_ror:1 row_mask:0xf bank_mask:0xf
    v_add_f32_dpp v65, v65, v65 row_ror:1 row_mask:0xf bank_mask:0xf
    v_add_f32_dpp v66, v66, v66 row_ror:1 row_mask:0xf bank_mask:0xf
    v_mfma_f32_16x16x32_bf16 v[44:47], v[88:91], a[116:119], v[44:47]
    ds_read_b64_tr_b16 v[106:107], v7 offset:34112
    v_min_f32 v87, 0x41f00000, v87
    v_mul_f32 v86, s80, v86
    s_waitcnt lgkmcnt(6)
    v_mfma_f32_16x16x32_bf16 v[48:51], v[92:95], a[112:115], v[48:51]
    ds_read_b64_tr_b16 v[88:89], v8 offset:32864
    v_add_f32_dpp v67, v67, v67 row_ror:1 row_mask:0xf bank_mask:0xf
    v_add_f32_dpp v68, v68, v68 row_ror:1 row_mask:0xf bank_mask:0xf
    v_mfma_f32_16x16x32_bf16 v[52:55], v[92:95], a[116:119], v[52:55]
    ds_read_b64_tr_b16 v[90:91], v8 offset:34144
    v_mul_f32 v87, s80, v87
    s_waitcnt lgkmcnt(6)
    v_mfma_f32_16x16x32_bf16 v[16:19], v[96:99], a[120:123], v[16:19]
    ds_read_b64_tr_b16 v[92:93], v7 offset:32896
    v_add_f32_dpp v69, v69, v69 row_ror:1 row_mask:0xf bank_mask:0xf
    v_add_f32_dpp v70, v70, v70 row_ror:1 row_mask:0xf bank_mask:0xf
    v_mfma_f32_16x16x32_bf16 v[20:23], v[96:99], a[124:127], v[20:23]
    ds_read_b64_tr_b16 v[94:95], v7 offset:34176
    v_exp_f32 v86, v86
    v_exp_f32 v87, v87
    s_waitcnt lgkmcnt(6)
    v_mfma_f32_16x16x32_bf16 v[24:27], v[100:103], a[120:123], v[24:27]
    v_add_f32_dpp v71, v71, v71 row_ror:1 row_mask:0xf bank_mask:0xf
    v_cvt_pk_bf16_f32 v2, v64, v65
    v_mfma_f32_16x16x32_bf16 v[28:31], v[100:103], a[124:127], v[28:31]
    v_cvt_pk_bf16_f32 v3, v66, v67
    s_waitcnt lgkmcnt(0)
    s_barrier
    v_mfma_f32_16x16x32_bf16 v[32:35], v[104:107], a[120:123], v[32:35]
    ds_read_b64_tr_b16 v[96:97], v7 offset:43008
    ds_read_b64_tr_b16 v[98:99], v7 offset:44288
    v_cvt_pk_bf16_f32 v4, v68, v69
    v_mfma_f32_16x16x32_bf16 v[36:39], v[104:107], a[124:127], v[36:39]
    ds_read_b64_tr_b16 v[100:101], v8 offset:43040
    v_cvt_pk_bf16_f32 v5, v70, v71
    v_mfma_f32_16x16x32_bf16 v[40:43], v[88:91], a[120:123], v[40:43]
    ds_read_b64_tr_b16 v[102:103], v8 offset:44320
    ds_read_b64_tr_b16 v[104:105], v7 offset:43072
    v_mfma_f32_16x16x32_bf16 v[44:47], v[88:91], a[124:127], v[44:47]
    ds_read_b64_tr_b16 v[106:107], v7 offset:44352
    v_mfma_f32_16x16x32_bf16 v[48:51], v[92:95], a[120:123], v[48:51]
    ds_read_b64_tr_b16 v[88:89], v8 offset:43104
    v_mfma_f32_16x16x32_bf16 v[52:55], v[92:95], a[124:127], v[52:55]
    ds_read_b64_tr_b16 v[90:91], v8 offset:44384
    s_waitcnt lgkmcnt(6)
    v_mfma_f32_16x16x32_bf16 v[16:19], v[96:99], a[128:131], v[16:19]
    ds_read_b64_tr_b16 v[92:93], v7 offset:43136
    v_mov_b32 v14, 2
    s_waitcnt vmcnt(0)
    v_mfma_f32_16x16x32_bf16 v[20:23], v[96:99], a[132:135], v[20:23]
    ds_read_b64_tr_b16 v[94:95], v7 offset:44416
    s_mov_b64 exec, 1
    buffer_store_dword v14, off, s[20:23], s66 sc1
    s_mov_b64 exec, -1
    s_waitcnt lgkmcnt(6)
    v_mfma_f32_16x16x32_bf16 v[24:27], v[100:103], a[128:131], v[24:27]
    ds_read_b64_tr_b16 v[96:97], v7 offset:53248
    v_mfma_f32_16x16x32_bf16 v[28:31], v[100:103], a[132:135], v[28:31]
    ds_read_b64_tr_b16 v[98:99], v7 offset:54528
    s_waitcnt lgkmcnt(6)
    v_mfma_f32_16x16x32_bf16 v[32:35], v[104:107], a[128:131], v[32:35]
    ds_read_b64_tr_b16 v[100:101], v8 offset:53280
    v_mfma_f32_16x16x32_bf16 v[36:39], v[104:107], a[132:135], v[36:39]
    ds_read_b64_tr_b16 v[102:103], v8 offset:54560
    s_waitcnt lgkmcnt(6)
    v_mfma_f32_16x16x32_bf16 v[40:43], v[88:91], a[128:131], v[40:43]
    ds_read_b64_tr_b16 v[104:105], v7 offset:53312
    v_mfma_f32_16x16x32_bf16 v[44:47], v[88:91], a[132:135], v[44:47]
    ds_read_b64_tr_b16 v[106:107], v7 offset:54592
    s_waitcnt lgkmcnt(6)
    v_mfma_f32_16x16x32_bf16 v[48:51], v[92:95], a[128:131], v[48:51]
    ds_read_b64_tr_b16 v[88:89], v8 offset:53344
    v_mfma_f32_16x16x32_bf16 v[52:55], v[92:95], a[132:135], v[52:55]
    ds_read_b64_tr_b16 v[90:91], v8 offset:54624
    s_waitcnt lgkmcnt(6)
    v_mfma_f32_16x16x32_bf16 v[16:19], v[96:99], a[136:139], v[16:19]
    ds_read_b64_tr_b16 v[92:93], v7 offset:53376
    v_mfma_f32_16x16x32_bf16 v[20:23], v[96:99], a[140:143], v[20:23]
    ds_read_b64_tr_b16 v[94:95], v7 offset:54656
    s_waitcnt lgkmcnt(6)
    v_mfma_f32_16x16x32_bf16 v[24:27], v[100:103], a[136:139], v[24:27]
    v_mfma_f32_16x16x32_bf16 v[28:31], v[100:103], a[140:143], v[28:31]
    s_waitcnt lgkmcnt(4)
    v_mfma_f32_16x16x32_bf16 v[32:35], v[104:107], a[136:139], v[32:35]
    v_mfma_f32_16x16x32_bf16 v[36:39], v[104:107], a[140:143], v[36:39]
    s_waitcnt lgkmcnt(0)
    s_barrier
    v_mfma_f32_16x16x32_bf16 v[40:43], v[88:91], a[136:139], v[40:43]
    v_mfma_f32_16x16x32_bf16 v[44:47], v[88:91], a[140:143], v[44:47]
    v_mfma_f32_16x16x32_bf16 v[48:51], v[92:95], a[136:139], v[48:51]
    v_mov_b32 v0, 0
    v_mfma_f32_16x16x32_bf16 v[52:55], v[92:95], a[140:143], v[52:55]
    s_mov_b64 exec, 0xffff
    buffer_atomic_add v0, v15, s[20:23], s65 offen sc0 sc1
    s_mov_b64 exec, -1
    s_nop 4
    v_mul_f32 v76, s80, v16
    v_mul_f32 v77, s80, v17
    v_mul_f32 v78, s80, v18
    v_mul_f32 v79, s80, v19
    v_exp_f32_e64 v76, v76 clamp
    v_exp_f32_e64 v77, v77 clamp
    v_exp_f32_e64 v78, v78 clamp
    v_exp_f32_e64 v79, v79 clamp
    v_max_f32 v16, s81, v16
    v_max_f32 v17, s81, v17
    v_max_f32 v18, s81, v18
    v_max_f32 v19, s81, v19
    v_add_f32 v16, v16, v76
    v_add_f32 v17, v17, v77
    v_add_f32 v18, v18, v78
    v_add_f32 v19, v19, v79
    v_cvt_pk_bf16_f32 v56, v16, v17
    v_cvt_pk_bf16_f32 v57, v18, v19
    v_mul_f32 v76, s80, v20
    v_mul_f32 v77, s80, v21
    v_mul_f32 v78, s80, v22
    v_mul_f32 v79, s80, v23
    v_exp_f32_e64 v76, v76 clamp
    v_exp_f32_e64 v77, v77 clamp
    v_exp_f32_e64 v78, v78 clamp
    v_exp_f32_e64 v79, v79 clamp
    v_max_f32 v20, s81, v20
    v_max_f32 v21, s81, v21
    v_max_f32 v22, s81, v22
    v_max_f32 v23, s81, v23
    v_add_f32 v20, v20, v76
    v_add_f32 v21, v21, v77
    v_add_f32 v22, v22, v78
    v_add_f32 v23, v23, v79
    v_cvt_pk_bf16_f32 v58, v20, v21
    v_cvt_pk_bf16_f32 v59, v22, v23
    v_mul_f32 v76, s80, v24
    v_mul_f32 v77, s80, v25
    v_mul_f32 v78, s80, v26
    v_mul_f32 v79, s80, v27
    v_exp_f32_e64 v76, v76 clamp
    v_exp_f32_e64 v77, v77 clamp
    v_exp_f32_e64 v78, v78 clamp
    v_exp_f32_e64 v79, v79 clamp
    v_max_f32 v24, s81, v24
    v_max_f32 v25, s81, v25
    v_max_f32 v26, s81, v26
    v_max_f32 v27, s81, v27
    v_add_f32 v24, v24, v76
    v_add_f32 v25, v25, v77
    v_add_f32 v26, v26, v78
    v_add_f32 v27, v27, v79
    v_cvt_pk_bf16_f32 v60, v24, v25
    v_cvt_pk_bf16_f32 v61, v26, v27
    v_mul_f32 v76, s80, v28
    v_mul_f32 v77, s80, v29
    v_mul_f32 v78, s80, v30
    v_mul_f32 v79, s80, v31
    v_exp_f32_e64 v76, v76 clamp
    v_exp_f32_e64 v77, v77 clamp
    v_exp_f32_e64 v78, v78 clamp
    v_exp_f32_e64 v79, v79 clamp
    v_max_f32 v28, s81, v28
    v_max_f32 v29, s81, v29
    v_max_f32 v30, s81, v30
    v_max_f32 v31, s81, v31
    v_add_f32 v28, v28, v76
    v_add_f32 v29, v29, v77
    v_add_f32 v30, v30, v78
    v_add_f32 v31, v31, v79
    v_cvt_pk_bf16_f32 v62, v28, v29
    v_cvt_pk_bf16_f32 v63, v30, v31
    v_mul_f32 v76, s80, v32
    v_mul_f32 v77, s80, v33
    v_mul_f32 v78, s80, v34
    v_mul_f32 v79, s80, v35
    v_exp_f32_e64 v76, v76 clamp
    v_exp_f32_e64 v77, v77 clamp
    v_exp_f32_e64 v78, v78 clamp
    v_exp_f32_e64 v79, v79 clamp
    v_max_f32 v32, s81, v32
    v_max_f32 v33, s81, v33
    v_max_f32 v34, s81, v34
    v_max_f32 v35, s81, v35
    v_add_f32 v32, v32, v76
    v_add_f32 v33, v33, v77
    v_add_f32 v34, v34, v78
    v_add_f32 v35, v35, v79
    v_cvt_pk_bf16_f32 v64, v32, v33
    v_cvt_pk_bf16_f32 v65, v34, v35
    s_waitcnt vmcnt(0)
    s_mov_b32 s5, 0
    s_waitcnt vmcnt(63)
L_kc2_l:
    v_cmp_lt_u32 vcc, 1, v0
    s_nop 1
    s_cmp_eq_u32 vcc_lo, 0xffff
    s_cbranch_scc1 L_kc2_d
    s_add_u32 s5, s5, 1
    s_cmp_ge_u32 s5, 100000
    s_cbranch_scc1 L_kc2_d
    s_sleep 6
    v_mov_b32 v0, 0
    s_mov_b64 exec, 0xffff
    buffer_atomic_add v0, v15, s[20:23], s65 offen sc0 sc1
    s_mov_b64 exec, -1
    s_waitcnt vmcnt(0)
    s_branch L_kc2_l
L_kc2_d:
    buffer_load_dwordx4 v[88:91], v110, s[20:23], s33 offen offset:0 sc1
    buffer_load_dwordx4 v[92:95], v111, s[20:23], s33 offen offset:1024 sc1
    v_mul_f32 v76, s80, v36
    v_mul_f32 v77, s80, v37
    v_mul_f32 v78, s80, v38
    v_mul_f32 v79, s80, v39
    v_exp_f32_e64 v76, v76 clamp
    v_exp_f32_e64 v77, v77 clamp
    v_exp_f32_e64 v78, v78 clamp
    v_exp_f32_e64 v79, v79 clamp
    v_max_f32 v36, s81, v36
    v_max_f32 v37, s81, v37
    v_max_f32 v38, s81, v38
    v_max_f32 v39, s81, v39
    v_add_f32 v36, v36, v76
    v_add_f32 v37, v37, v77
    v_add_f32 v38, v38, v78
    v_add_f32 v39, v39, v79
    v_cvt_pk_bf16_f32 v66, v36, v37
    v_cvt_pk_bf16_f32 v67, v38, v39
    v_mul_f32 v76, s80, v40
    v_mul_f32 v77, s80, v41
    v_mul_f32 v78, s80, v42
    v_mul_f32 v79, s80, v43
    v_exp_f32_e64 v76, v76 clamp
    v_exp_f32_e64 v77, v77 clamp
    v_exp_f32_e64 v78, v78 clamp
    v_exp_f32_e64 v79, v79 clamp
    v_max_f32 v40, s81, v40
    v_max_f32 v41, s81, v41
    v_max_f32 v42, s81, v42
    v_max_f32 v43, s81, v43
    v_add_f32 v40, v40, v76
    v_add_f32 v41, v41, v77
    v_add_f32 v42, v42, v78
    v_add_f32 v43, v43, v79
    v_cvt_pk_bf16_f32 v68, v40, v41
    v_cvt_pk_bf16_f32 v69, v42, v43
    v_mul_f32 v76, s80, v44
    v_mul_f32 v77, s80, v45
    v_mul_f32 v78, s80, v46
    v_mul_f32 v79, s80, v47
    v_exp_f32_e64 v76, v76 clamp
    v_exp_f32_e64 v77, v77 clamp
    v_exp_f32_e64 v78, v78 clamp
    v_exp_f32_e64 v79, v79 clamp
    v_max_f32 v44, s81, v44
    v_max_f32 v45, s81, v45
    v_max_f32 v46, s81, v46
    v_max_f32 v47, s81, v47
    v_add_f32 v44, v44, v76
    v_add_f32 v45, v45, v77
    v_add_f32 v46, v46, v78
    v_add_f32 v47, v47, v79
    v_cvt_pk_bf16_f32 v70, v44, v45
    v_cvt_pk_bf16_f32 v71, v46, v47
    v_mul_f32 v76, s80, v48
    v_mul_f32 v77, s80, v49
    v_mul_f32 v78, s80, v50
    v_mul_f32 v79, s80, v51
    v_exp_f32_e64 v76, v76 clamp
    v_exp_f32_e64 v77, v77 clamp
    v_exp_f32_e64 v78, v78 clamp
    v_exp_f32_e64 v79, v79 clamp
    v_max_f32 v48, s81, v48
    v_max_f32 v49, s81, v49
    v_max_f32 v50, s81, v50
    v_max_f32 v51, s81, v51
    v_add_f32 v48, v48, v76
    v_add_f32 v49, v49, v77
    v_add_f32 v50, v50, v78
    v_add_f32 v51, v51, v79
    v_cvt_pk_bf16_f32 v72, v48, v49
    v_cvt_pk_bf16_f32 v73, v50, v51
    v_mul_f32 v76, s80, v52
    v_mul_f32 v77, s80, v53
    v_mul_f32 v78, s80, v54
    v_mul_f32 v79, s80, v55
    v_exp_f32_e64 v76, v76 clamp
    v_exp_f32_e64 v77, v77 clamp
    v_exp_f32_e64 v78, v78 clamp
    v_exp_f32_e64 v79, v79 clamp
    v_max_f32 v52, s81, v52
    v_max_f32 v53, s81, v53
    v_max_f32 v54, s81, v54
    v_max_f32 v55, s81, v55
    v_add_f32 v52, v52, v76
    v_add_f32 v53, v53, v77
    v_add_f32 v54, v54, v78
    v_add_f32 v55, v55, v79
    v_cvt_pk_bf16_f32 v74, v52, v53
    v_cvt_pk_bf16_f32 v75, v54, v55
    s_waitcnt vmcnt(0)
    s_and_b64 vcc, s[40:41], s[48:49]
    v_cndmask_b32 v32, 0, v88, vcc
    v_cndmask_b32 v34, 0, v2, vcc
    s_and_b64 vcc, s[42:43], s[48:49]
    v_cndmask_b32 v33, 0, v89, vcc
    v_cndmask_b32 v35, 0, v3, vcc
    s_mov_b64 exec, s[48:49]
    ds_write_b128 v83, v[32:35] offset:1024
    s_mov_b64 exec, -1
    s_and_b64 vcc, s[44:45], s[48:49]
    v_cndmask_b32 v36, 0, v92, vcc
    v_cndmask_b32 v38, 0, v4, vcc
    s_and_b64 vcc, s[46:47], s[48:49]
    v_cndmask_b32 v37, 0, v93, vcc
    v_cndmask_b32 v39, 0, v5, vcc
    ds_write_b128 v83, v[36:39] offset:2048
    s_and_b64 vcc, s[40:41], s[50:51]
    v_cndmask_b32 v40, 0, v90, vcc
    v_cndmask_b32 v42, 0, v2, vcc
    s_and_b64 vcc, s[42:43], s[50:51]
    v_cndmask_b32 v41, 0, v91, vcc
    v_cndmask_b32 v43, 0, v3, vcc
    ds_write_b128 v83, v[40:43] offset:3072
    s_and_b64 vcc, s[44:45], s[50:51]
    v_cndmask_b32 v44, 0, v94, vcc
    v_cndmask_b32 v46, 0, v4, vcc
    s_and_b64 vcc, s[46:47], s[50:51]
    v_cndmask_b32 v45, 0, v95, vcc
    v_cndmask_b32 v47, 0, v5, vcc
    s_mov_b64 exec, s[50:51]
    ds_write_b128 v83, v[44:47] offset:4096
    s_mov_b64 exec, -1
    s_mul_i32 s43, s30, 34816
    s_add_u32 s43, s43, 69206016
    s_mul_i32 s42, s28, 1088
    s_add_u32 s42, s42, s82
    s_lshl_b32 s42, s42, 2
    s_add_u32 s42, s42, s43
    s_lshr_b32 s44, s82, 1
    s_mul_i32 s46, s44, 4352
    s_add_u32 s43, s43, s46
    s_waitcnt lgkmcnt(0)
    s_barrier
    ds_read_b128 a[0:3], v84 offset:1024
    ds_read_b128 a[4:7], v84 offset:2048
    ds_read_b128 a[8:11], v84 offset:3072
    ds_read_b128 a[12:15], v84 offset:4096
    ds_read_b128 a[16:19], v84 offset:5120
    ds_read_b128 a[20:23], v84 offset:6144
    ds_read_b128 a[24:27], v84 offset:7168
    ds_read_b128 a[28:31], v84 offset:8192
    ds_read_b128 a[32:35], v84 offset:9216
    ds_read_b128 a[36:39], v84 offset:10240
    ds_read_b128 a[40:43], v84 offset:11264
    ds_read_b128 a[44:47], v84 offset:12288
    ds_read_b128 a[48:51], v84 offset:13312
    v_mov_b32 v76, s81
    v_mov_b32 v77, s81
    v_mov_b32 v78, s81
    v_mov_b32 v79, s81
    v_cndmask_b32 v80, v87, v86, s[36:37]
    s_lshl_b32 s84, s6, 1
    v_add_f32 v80, 1.0, v80
    s_add_u32 s84, s84, s7
    v_rcp_f32 v80, v80
    s_lshl_b32 s84, s84, 6
    s_add_u32 s84, s84, s69
    s_add_u32 s84, s84, 329728
    s_mov_b64 exec, 0xffff
    buffer_store_dword v80, v15, s[20:23], s84 offen sc1
    s_mov_b64 exec, -1
    s_waitcnt lgkmcnt(11)
    v_mfma_f32_16x16x16_bf16 v[16:19], a[0:1], v[56:57], 0
    v_mfma_f32_16x16x16_bf16 v[20:23], a[2:3], v[56:57], v[76:79]
    v_mfma_f32_16x16x16_bf16 v[16:19], a[4:5], v[60:61], v[16:19]
    v_mfma_f32_16x16x16_bf16 v[20:23], a[6:7], v[60:61], v[20:23]
    v_mfma_f32_16x16x16_bf16 v[24:27], a[0:1], v[58:59], 0
    v_mfma_f32_16x16x16_bf16 v[28:31], a[2:3], v[58:59], v[76:79]
    v_mfma_f32_16x16x16_bf16 v[24:27], a[4:5], v[62:63], v[24:27]
    v_mfma_f32_16x16x16_bf16 v[28:31], a[6:7], v[62:63], v[28:31]
    s_waitcnt lgkmcnt(8)
    v_mfma_f32_16x16x16_bf16 v[32:35], a[8:9], v[56:57], 0
    v_mfma_f32_16x16x16_bf16 v[36:39], a[10:11], v[56:57], v[76:79]
    v_mfma_f32_16x16x16_bf16 v[32:35], a[12:13], v[60:61], v[32:35]
    v_mfma_f32_16x16x16_bf16 v[36:39], a[14:15], v[60:61], v[36:39]
    v_mfma_f32_16x16x16_bf16 v[32:35], a[16:17], v[64:65], v[32:35]
    v_mfma_f32_16x16x16_bf16 v[36:39], a[18:19], v[64:65], v[36:39]
    v_mfma_f32_16x16x16_bf16 v[40:43], a[8:9], v[58:59], 0
    v_rcp_f32 v20, v20
    v_rcp_f32 v21, v21
    v_rcp_f32 v22, v22
    v_mfma_f32_16x16x16_bf16 v[44:47], a[10:11], v[58:59], v[76:79]
    v_rcp_f32 v23, v23
    v_mul_f32 v16, v86, v16
    v_mul_f32 v17, v86, v17
    v_mfma_f32_16x16x16_bf16 v[40:43], a[12:13], v[62:63], v[40:43]
    v_mul_f32 v18, v86, v18
    v_mul_f32 v19, v86, v19
    v_mul_f32 v16, v16, v20
    v_mfma_f32_16x16x16_bf16 v[44:47], a[14:15], v[62:63], v[44:47]
    v_mul_f32 v17, v17, v21
    v_mul_f32 v18, v18, v22
    v_mul_f32 v19, v19, v23
    v_mfma_f32_16x16x16_bf16 v[40:43], a[16:17], v[66:67], v[40:43]
    v_cvt_pk_bf16_f32 v88, v16, v17
    v_cvt_pk_bf16_f32 v89, v18, v19
    v_mfma_f32_16x16x16_bf16 v[44:47], a[18:19], v[66:67], v[44:47]
    v_cndmask_b32 v88, 0, v88, s[36:37]
    v_cndmask_b32 v89, 0, v89, s[36:37]
    s_waitcnt lgkmcnt(5)
    v_mfma_f32_16x16x16_bf16 v[48:51], a[20:21], v[60:61], 0
    v_rcp_f32 v28, v28
    v_rcp_f32 v29, v29
    v_rcp_f32 v30, v30
    v_mfma_f32_16x16x16_bf16 v[52:55], a[22:23], v[60:61], v[76:79]
    v_rcp_f32 v31, v31
    v_mul_f32 v24, v87, v24
    v_mul_f32 v25, v87, v25
    v_mfma_f32_16x16x16_bf16 v[48:51], a[24:25], v[64:65], v[48:51]
    v_mul_f32 v26, v87, v26
    v_mul_f32 v27, v87, v27
    v_mul_f32 v24, v24, v28
    v_mfma_f32_16x16x16_bf16 v[52:55], a[26:27], v[64:65], v[52:55]
    v_mul_f32 v25, v25, v29
    v_mul_f32 v26, v26, v30
    v_mul_f32 v27, v27, v31
    v_mfma_f32_16x16x16_bf16 v[48:51], a[28:29], v[68:69], v[48:51]
    v_cvt_pk_bf16_f32 v92, v24, v25
    v_cvt_pk_bf16_f32 v93, v26, v27
    v_mfma_f32_16x16x16_bf16 v[52:55], a[30:31], v[68:69], v[52:55]
    v_cndmask_b32 v92, 0, v92, s[36:37]
    v_cndmask_b32 v93, 0, v93, s[36:37]
    v_mfma_f32_16x16x16_bf16 v[16:19], a[20:21], v[62:63], 0
    v_rcp_f32 v36, v36
    v_rcp_f32 v37, v37
    v_rcp_f32 v38, v38
    v_mfma_f32_16x16x16_bf16 v[20:23], a[22:23], v[62:63], v[76:79]
    v_rcp_f32 v39, v39
    v_mul_f32 v32, v86, v32
    v_mul_f32 v33, v86, v33
    v_mfma_f32_16x16x16_bf16 v[16:19], a[24:25], v[66:67], v[16:19]
    v_mul_f32 v34, v86, v34
    v_mul_f32 v35, v86, v35
    v_mul_f32 v32, v32, v36
    v_mfma_f32_16x16x16_bf16 v[20:23], a[26:27], v[66:67], v[20:23]
    v_mul_f32 v33, v33, v37
    v_mul_f32 v34, v34, v38
    v_mfma_f32_16x16x16_bf16 v[16:19], a[28:29], v[70:71], v[16:19]
    v_mul_f32 v35, v35, v39
    v_cvt_pk_bf16_f32 v90, v32, v33
    v_mfma_f32_16x16x16_bf16 v[20:23], a[30:31], v[70:71], v[20:23]
    v_cvt_pk_bf16_f32 v91, v34, v35
    buffer_store_dwordx4 v[88:91], v85, s[20:23], s56 offen offset:0 sc1
    s_waitcnt lgkmcnt(2)
    v_mfma_f32_16x16x16_bf16 v[24:27], a[32:33], v[64:65], 0
    v_rcp_f32 v44, v44
    v_rcp_f32 v45, v45
    v_rcp_f32 v46, v46
    v_mfma_f32_16x16x16_bf16 v[28:31], a[34:35], v[64:65], v[76:79]
    v_rcp_f32 v47, v47
    v_mul_f32 v40, v87, v40
    v_mul_f32 v41, v87, v41
    v_mfma_f32_16x16x16_bf16 v[24:27], a[36:37], v[68:69], v[24:27]
    v_mul_f32 v42, v87, v42
    v_mul_f32 v43, v87, v43
    v_mul_f32 v40, v40, v44
    v_mfma_f32_16x16x16_bf16 v[28:31], a[38:39], v[68:69], v[28:31]
    v_mul_f32 v41, v41, v45
    v_mul_f32 v42, v42, v46
    v_mfma_f32_16x16x16_bf16 v[24:27], a[40:41], v[72:73], v[24:27]
    v_mul_f32 v43, v43, v47
    v_cvt_pk_bf16_f32 v94, v40, v41
    v_mfma_f32_16x16x16_bf16 v[28:31], a[42:43], v[72:73], v[28:31]
    v_cvt_pk_bf16_f32 v95, v42, v43
    buffer_store_dwordx4 v[92:95], v85, s[20:23], s56 offen offset:1024 sc1
    v_mfma_f32_16x16x16_bf16 v[32:35], a[32:33], v[66:67], 0
    v_rcp_f32 v52, v52
    v_rcp_f32 v53, v53
    v_rcp_f32 v54, v54
    v_mfma_f32_16x16x16_bf16 v[36:39], a[34:35], v[66:67], v[76:79]
    v_rcp_f32 v55, v55
    v_mul_f32 v48, v86, v48
    v_mul_f32 v49, v86, v49
    v_mfma_f32_16x16x16_bf16 v[32:35], a[36:37], v[70:71], v[32:35]
    v_mul_f32 v50, v86, v50
    v_mul_f32 v51, v86, v51
    v_mfma_f32_16x16x16_bf16 v[36:39], a[38:39], v[70:71], v[36:39]
    v_mul_f32 v48, v48, v52
    v_mul_f32 v49, v49, v53
    v_mfma_f32_16x16x16_bf16 v[32:35], a[40:41], v[74:75], v[32:35]
    v_mul_f32 v50, v50, v54
    v_mul_f32 v51, v51, v55
    v_mfma_f32_16x16x16_bf16 v[36:39], a[42:43], v[74:75], v[36:39]
    v_cvt_pk_bf16_f32 v96, v48, v49
    v_cvt_pk_bf16_f32 v97, v50, v51
    s_waitcnt lgkmcnt(0)
    v_mfma_f32_16x16x16_bf16 v[40:43], a[44:45], v[68:69], 0
    v_rcp_f32 v20, v20
    v_rcp_f32 v21, v21
    v_rcp_f32 v22, v22
    v_rcp_f32 v23, v23
    v_mfma_f32_16x16x16_bf16 v[44:47], a[46:47], v[68:69], v[76:79]
    v_mul_f32 v16, v87, v16
    v_mul_f32 v17, v87, v17
    v_mul_f32 v18, v87, v18
    v_mul_f32 v19, v87, v19
    v_mfma_f32_16x16x16_bf16 v[40:43], a[48:49], v[72:73], v[40:43]
    v_mul_f32 v16, v16, v20
    v_mul_f32 v17, v17, v21
    v_mul_f32 v18, v18, v22
    v_mfma_f32_16x16x16_bf16 v[44:47], a[50:51], v[72:73], v[44:47]
    v_mul_f32 v19, v19, v23
    v_cvt_pk_bf16_f32 v100, v16, v17
    v_cvt_pk_bf16_f32 v101, v18, v19
    v_mfma_f32_16x16x16_bf16 v[48:51], a[44:45], v[70:71], 0
    v_rcp_f32 v28, v28
    v_rcp_f32 v29, v29
    v_rcp_f32 v30, v30
    v_rcp_f32 v31, v31
    v_mfma_f32_16x16x16_bf16 v[52:55], a[46:47], v[70:71], v[76:79]
    v_mul_f32 v24, v86, v24
    v_mul_f32 v25, v86, v25
    v_mul_f32 v26, v86, v26
    v_mul_f32 v27, v86, v27
    v_mfma_f32_16x16x16_bf16 v[48:51], a[48:49], v[74:75], v[48:51]
    v_mul_f32 v24, v24, v28
    v_mul_f32 v25, v25, v29
    v_mul_f32 v26, v26, v30
    v_mul_f32 v27, v27, v31
    v_mfma_f32_16x16x16_bf16 v[52:55], a[50:51], v[74:75], v[52:55]
    v_cvt_pk_bf16_f32 v98, v24, v25
    v_cvt_pk_bf16_f32 v99, v26, v27
    buffer_store_dwordx4 v[96:99], v85, s[20:23], s56 offen offset:2048 sc1
    v_rcp_f32 v36, v36
    v_rcp_f32 v37, v37
    v_rcp_f32 v38, v38
    v_rcp_f32 v39, v39
    v_mul_f32 v32, v87, v32
    v_mul_f32 v33, v87, v33
    v_mul_f32 v34, v87, v34
    v_mul_f32 v35, v87, v35
    v_mul_f32 v32, v32, v36
    v_mul_f32 v33, v33, v37
    v_mul_f32 v34, v34, v38
    v_mul_f32 v35, v35, v39
    v_cvt_pk_bf16_f32 v102, v32, v33
    v_cvt_pk_bf16_f32 v103, v34, v35
    buffer_store_dwordx4 v[100:103], v85, s[20:23], s56 offen offset:3072 sc1
    v_rcp_f32 v44, v44
    v_rcp_f32 v45, v45
    v_rcp_f32 v46, v46
    v_rcp_f32 v47, v47
    v_mul_f32 v40, v86, v40
    v_mul_f32 v41, v86, v41
    v_mul_f32 v42, v86, v42
    v_mul_f32 v43, v86, v43
    v_mul_f32 v40, v40, v44
    v_mul_f32 v41, v41, v45
    v_mul_f32 v42, v42, v46
    v_mul_f32 v43, v43, v47
    v_cvt_pk_bf16_f32 v104, v40, v41
    v_cvt_pk_bf16_f32 v105, v42, v43
    v_cndmask_b32 v104, 0, v104, s[38:39]
    v_cndmask_b32 v105, 0, v105, s[38:39]
    v_rcp_f32 v52, v52
    v_rcp_f32 v53, v53
    v_rcp_f32 v54, v54
    v_rcp_f32 v55, v55
    v_mul_f32 v48, v87, v48
    v_mul_f32 v49, v87, v49
    v_mul_f32 v50, v87, v50
    v_mul_f32 v51, v87, v51
    v_mul_f32 v48, v48, v52
    v_mul_f32 v49, v49, v53
    v_mul_f32 v50, v50, v54
    v_mul_f32 v51, v51, v55
    v_cvt_pk_bf16_f32 v106, v48, v49
    v_cvt_pk_bf16_f32 v107, v50, v51
    v_cndmask_b32 v106, 0, v106, s[38:39]
    v_cndmask_b32 v107, 0, v107, s[38:39]
    buffer_store_dwordx4 v[104:107], v85, s[20:23], s57 offen sc1
    v_mov_b32 v14, 1
    s_waitcnt vmcnt(0)
    s_barrier
    s_cmp_lg_u32 s28, 0
    s_cbranch_scc1 L_osig
    s_mov_b64 exec, 1
    buffer_store_dword v14, off, s[20:23], s68 sc1
    s_mov_b64 exec, -1
L_osig:
    s_nop 7
L_tail:
    s_setprio 0
    v_and_b32 v111, 15, v1
    v_lshlrev_b32 v111, 2, v111
    v_mov_b32 v2, 0
    s_mov_b64 exec, 0xffff
    buffer_atomic_add v2, v111, s[20:23], s43 offen sc0 sc1
    s_mov_b64 exec, -1
    s_and_b32 s46, s28, 1
    s_lshl_b32 s47, s82, 1
    s_add_u32 s46, s46, s47
    s_lshr_b32 s47, s28, 2
    s_mul_i32 s47, s47, 10
    s_bfe_u32 s48, s28, 0x10001
    s_add_u32 s47, s47, s48
    s_lshl_b32 s48, s30, 5
    s_add_u32 s48, s48, s46
    s_mul_i32 s48, s48, 72
    s_add_u32 s48, s48, s47
    s_lshl_b32 s48, s48, 6
    v_bfe_u32 v4, v1, 1, 2
    v_mul_u32_u24 v4, 1152, v4
    v_and_b32 v5, 1, v1
    v_lshl_add_u32 v4, v5, 4, v4
    v_bfe_u32 v5, v1, 4, 1
    v_lshl_add_u32 v4, v5, 3, v4
    v_lshrrev_b32 v5, 5, v1
    v_lshl_add_u32 v4, v5, 5, v4
    v_add_u32 v110, s48, v4
    s_lshl_b32 s48, s30, 2
    s_add_u32 s48, s48, s3
    s_mul_i32 s48, s48, 344064
    s_add_u32 s48, s48, 83886080
    s_lshl_b32 s49, s46, 4
    s_add_u32 s48, s48, s49
    s_add_u32 s48, s48, 329728
    v_and_b32 v4, 6, v1
    v_lshlrev_b32 v4, 1, v4
    buffer_load_dword v15, v4, s[20:23], s48 offen sc1
    s_lshl_b32 s47, s47, 6
    s_add_u32 s47, s47, s46
    s_lshl_b32 s47, s47, 7
    s_mul_i32 s46, s30, 589824
    s_add_u32 s46, s46, s47
    v_lshl_add_u32 v13, v5, 12, s46
    v_bfe_u32 v4, v1, 3, 2
    v_lshlrev_b32 v3, 2, v4
    v_mul_u32_u24 v4, 147456, v4
    v_add_u32 v13, v13, v4
    v_and_b32 v4, 7, v1
    v_lshl_add_u32 v13, v4, 4, v13
    s_mov_b32 s12, s52
    s_mov_b32 s13, s53
    s_mov_b32 s14, 2359296
    s_mov_b32 s15, 0x20000
    v_bfe_u32 v4, v1, 3, 1
    v_lshl_add_u32 v7, v4, 7, v110
    v_cmp_eq_u32 vcc, v4, v5
    v_and_b32 v4, 1, v1
    v_lshlrev_b32 v4, 4, v4
    v_mov_b32 v5, 0x3f80
    v_lshlrev_b32 v5, v4, v5
    v_cndmask_b32 v5, 0, v5, vcc
    v_bfe_u32 v4, v1, 1, 2
    v_cmp_eq_u32 vcc, 0, v4
    v_mov_b32 v32, 0
    s_nop 0
    v_cndmask_b32 v8, 0, v5, vcc
    v_cmp_eq_u32 vcc, 1, v4
    v_mov_b32 v33, 0
    s_nop 0
    v_cndmask_b32 v9, 0, v5, vcc
    v_cmp_eq_u32 vcc, 2, v4
    v_mov_b32 v34, 0
    s_nop 0
    v_cndmask_b32 v10, 0, v5, vcc
    v_cmp_eq_u32 vcc, 3, v4
    v_mov_b32 v35, 0
    s_nop 0
    v_cndmask_b32 v11, 0, v5, vcc
    s_mov_b32 s58, 16384
    s_mov_b32 s59, 32768
    s_mov_b32 s60, 49152
    s_mov_b32 s61, 65536
    s_cmp_lt_u32 s28, 4
    s_cselect_b32 s61, s61, 1073741824
    s_cselect_b32 s62, 0, 1073741824
    s_mov_b64 s[56:57], 0
    s_mov_b32 s48, 0
    s_lshl_b32 s49, 1, s82
    v_mov_b32 v6, 1
    s_waitcnt vmcnt(2)
    s_barrier
    s_mov_b64 exec, 1
    buffer_store_dword v6, off, s[20:23], s42 sc1
    s_mov_b64 exec, -1
    s_waitcnt vmcnt(1)
    s_branch L_tl_in
L_tl:
    s_waitcnt vmcnt(0)
L_tl_in:
    v_cmp_lt_u32 vcc, 0, v2
    s_nop 1
    s_or_b32 s46, vcc_lo, s49
    v_bfe_u32 v4, s46, v3, 4
    v_cmp_eq_u32 vcc, 15, v4
    s_nop 1
    s_andn2_b64 exec, vcc, s[56:57]
    s_cbranch_execz L_tl_skip
    buffer_load_dwordx4 v[16:19], v13, s[20:23], 0 offen sc1
    buffer_load_dwordx4 v[20:23], v13, s[20:23], s58 offen sc1
    buffer_load_dwordx4 v[24:27], v13, s[20:23], s59 offen sc1
    buffer_load_dwordx4 v[28:31], v13, s[20:23], s60 offen sc1
    buffer_load_dwordx4 v[32:35], v13, s[20:23], s61 offen sc1
L_tl_skip:
    s_mov_b64 s[56:57], vcc
    s_mov_b64 exec, -1
    s_cmp_eq_u32 s46, 0xffff
    s_cbranch_scc1 L_tl_all
    s_add_u32 s48, s48, 1
    s_cmp_ge_u32 s48, 100000
    s_cbranch_scc1 L_tl_all
    v_mov_b32 v2, 0
    s_mov_b64 exec, 0xffff
    buffer_atomic_add v2, v111, s[20:23], s43 offen sc0 sc1
    s_mov_b64 exec, -1
    s_branch L_tl
L_tl_all:
    s_waitcnt vmcnt(0)
    v_mfma_f32_16x16x32_bf16 v[36:39], v[8:11], v[16:19], 0
    v_mfma_f32_16x16x32_bf16 v[40:43], v[8:11], v[20:23], 0
    v_mfma_f32_16x16x32_bf16 v[44:47], v[8:11], v[24:27], 0
    v_mfma_f32_16x16x32_bf16 v[48:51], v[8:11], v[28:31], 0
    v_mfma_f32_16x16x32_bf16 v[52:55], v[8:11], v[32:35], 0
    s_nop 3
    v_add_f32_dpp v36, v36, v36 row_ror:8 row_mask:0xf bank_mask:0x3
    v_add_f32_dpp v37, v37, v37 row_ror:8 row_mask:0xf bank_mask:0x3
    v_add_f32_dpp v38, v38, v38 row_ror:8 row_mask:0xf bank_mask:0x3
    v_add_f32_dpp v39, v39, v39 row_ror:8 row_mask:0xf bank_mask:0x3
    v_add_f32_dpp v36, v40, v40 row_ror:8 row_mask:0xf bank_mask:0xc
    v_add_f32_dpp v37, v41, v41 row_ror:8 row_mask:0xf bank_mask:0xc
    v_add_f32_dpp v38, v42, v42 row_ror:8 row_mask:0xf bank_mask:0xc
    v_add_f32_dpp v39, v43, v43 row_ror:8 row_mask:0xf bank_mask:0xc
    v_mul_f32 v36, v15, v36
    v_mul_f32 v37, v15, v37
    v_mul_f32 v38, v15, v38
    v_mul_f32 v39, v15, v39
    v_cvt_pk_bf16_f32 v36, v36, v37
    v_cvt_pk_bf16_f32 v37, v38, v39
    buffer_store_dwordx2 v[36:37], v7, s[12:15], 0 offen offset:0 sc1
    v_add_f32_dpp v44, v44, v44 row_ror:8 row_mask:0xf bank_mask:0x3
    v_add_f32_dpp v45, v45, v45 row_ror:8 row_mask:0xf bank_mask:0x3
    v_add_f32_dpp v46, v46, v46 row_ror:8 row_mask:0xf bank_mask:0x3
    v_add_f32_dpp v47, v47, v47 row_ror:8 row_mask:0xf bank_mask:0x3
    v_add_f32_dpp v44, v48, v48 row_ror:8 row_mask:0xf bank_mask:0xc
    v_add_f32_dpp v45, v49, v49 row_ror:8 row_mask:0xf bank_mask:0xc
    v_add_f32_dpp v46, v50, v50 row_ror:8 row_mask:0xf bank_mask:0xc
    v_add_f32_dpp v47, v51, v51 row_ror:8 row_mask:0xf bank_mask:0xc
    v_mul_f32 v44, v15, v44
    v_mul_f32 v45, v15, v45
    v_mul_f32 v46, v15, v46
    v_mul_f32 v47, v15, v47
    v_cvt_pk_bf16_f32 v44, v44, v45
    v_cvt_pk_bf16_f32 v45, v46, v47
    buffer_store_dwordx2 v[44:45], v7, s[12:15], 0 offen offset:256 sc1
    v_add_f32_dpp v52, v52, v52 row_ror:8 row_mask:0xf bank_mask:0xf
    v_add_f32_dpp v53, v53, v53 row_ror:8 row_mask:0xf bank_mask:0xf
    v_add_f32_dpp v54, v54, v54 row_ror:8 row_mask:0xf bank_mask:0xf
    v_add_f32_dpp v55, v55, v55 row_ror:8 row_mask:0xf bank_mask:0xf
    v_mul_f32 v52, v15, v52
    v_mul_f32 v53, v15, v53
    v_mul_f32 v54, v15, v54
    v_mul_f32 v55, v15, v55
    v_cvt_pk_bf16_f32 v52, v52, v53
    v_cvt_pk_bf16_f32 v53, v54, v55
    s_mov_b32 exec_lo, 0x00ff00ff
    s_mov_b32 exec_hi, 0x00ff00ff
    buffer_store_dwordx2 v[52:53], v7, s[12:15], s62 offen offset:512 sc1
    s_mov_b64 exec, -1
L_tl_end:
L_k1_end:
    s_endpgm
L_code_end:
    s_endpgm
.section .rodata,"a"
.p2align 6
.amdhsa_kernel gated_mix__linear_attn_block__dense_activation_mish__prompt_kernel
  .amdhsa_next_free_vgpr 256
  .amdhsa_next_free_sgpr 102
  .amdhsa_accum_offset 112
  .amdhsa_group_segment_fixed_size 0
  .amdhsa_kernarg_size 88
  .amdhsa_user_sgpr_count 2
  .amdhsa_user_sgpr_kernarg_segment_ptr 1
  .amdhsa_system_sgpr_workgroup_id_x 1
.end_amdhsa_kernel
```
